```python
import torch

def _softmax(x, axis=-1):
    return torch.softmax(x, dim=axis)
def _gelu(x):
    return torch.nn.functional.gelu(x, approximate="tanh")
def _silu(x):
    return torch.nn.functional.silu(x)
def _sigmoid(x):
    return torch.sigmoid(x)
def _layernorm(x, axis=-1, eps=1e-5):
    m = x.mean(dim=axis, keepdim=True)
    v = x.var(dim=axis, keepdim=True, unbiased=False)
    return (x - m) / torch.sqrt(v + eps)
def _scatter_add(tgt, idx, src, axis=0):
    return tgt.clone().index_add_(axis, idx, src)
def _segment_sum(src, seg, n):
    out = torch.zeros((n,) + src.shape[1:], dtype=src.dtype)
    return out.index_add_(0, seg, src)
def _pad(x, pw):
    flat = tuple(v for pair in reversed(pw) for v in pair)
    return torch.nn.functional.pad(x, flat)

kernel_name = 'sequential_preLN__sliding_block__geglu_ffn__prompt'

def setup_inputs():

    _w = (lambda a: (lambda t: t.to(torch.bfloat16) if t.is_floating_point() else t)(torch.as_tensor(a)))
    def _A_setup():
        B, S, D = 1, 2048, 640
        return {
            "x": _w((lambda *s: torch.randn(*s, dtype=torch.bfloat16) * 0.05)(B, S, D)),
            "wqkv": _w((lambda *s: torch.randn(*s, dtype=torch.bfloat16) * 0.05)(D, 3 * D)),
            "wo": _w((lambda *s: torch.randn(*s, dtype=torch.bfloat16) * 0.05)(D, D)),
        }
    _A_in = _A_setup()

    def _B_setup():
        B, S, D, F = 1, 2048, 640, 1728
        return {
            "x": _w((lambda *s: torch.randn(*s, dtype=torch.bfloat16) * 0.05)(B, S, D)),
            "w_gate": _w((lambda *s: torch.randn(*s, dtype=torch.bfloat16) * 0.05)(D, F)),
            "w_up": _w((lambda *s: torch.randn(*s, dtype=torch.bfloat16) * 0.05)(D, F)),
            "w_down": _w((lambda *s: torch.randn(*s, dtype=torch.bfloat16) * 0.05)(F, D)),
        }
    _B_in = _B_setup()

    return {
        "A_x": _A_in["x"],
        "A_wqkv": _A_in["wqkv"],
        "A_wo": _A_in["wo"],
        "B_x": _B_in["x"],
        "B_w_gate": _B_in["w_gate"],
        "B_w_up": _B_in["w_up"],
        "B_w_down": _B_in["w_down"],
    }

def reference(A_x, A_wqkv, A_wo, B_x, B_w_gate, B_w_up, B_w_down):
    def _A_ref(x, wqkv, wo):
        B, S, D = x.shape
        H = 32; Dh = D // H; W = 256
        qkv = (lambda x, *d: x.permute(*d))((x @ wqkv).reshape(B, S, 3, H, Dh), 2, 0, 3, 1, 4)
        q, k, v = qkv[0], qkv[1], qkv[2]
        scores = torch.einsum("bhqd,bhkd->bhqk", q, k) * (Dh ** -0.5)
        idx = torch.arange(S)
        mask = (idx[:, None] - idx[None, :] >= 0) & (idx[:, None] - idx[None, :] < W)
        scores = torch.where(mask[None, None], scores, -1e9)
        p = _softmax(scores, axis=-1)
        o = torch.einsum("bhqk,bhkd->bhqd", p, v)
        return (lambda x, *d: x.permute(*d))(o, 0, 2, 1, 3).reshape(B, S, D) @ wo

    def _B_ref(x, w_gate, w_up, w_down):
        return (_gelu(x @ w_gate) * (x @ w_up)) @ w_down

    x = A_x
    h = x + _A_ref(_layernorm(x, axis=-1), A_wqkv, A_wo)
    h2 = h + _B_ref(_layernorm(h, axis=-1), B_w_gate, B_w_up, B_w_down)
    return h2
```

```asm
; @launch grid=(256,1,1) block=(512,1,1) lds=163840
.amdgcn_target "amdgcn-amd-amdhsa--gfx950"
.text
.globl sequential_preLN__sliding_block__geglu_ffn__prompt_kernel
.p2align 8
.type sequential_preLN__sliding_block__geglu_ffn__prompt_kernel,@function
sequential_preLN__sliding_block__geglu_ffn__prompt_kernel:
    s_cmp_ge_u32 s2, 256
    s_cbranch_scc1 L_done
    s_load_dwordx4 s[4:7], s[0:1], 0
    s_load_dwordx4 s[8:11], s[0:1], 64
    s_load_dwordx2 s[66:67], s[0:1], 16
    s_load_dwordx4 s[68:71], s[0:1], 32
    s_load_dwordx2 s[72:73], s[0:1], 48
    s_memrealtime s[92:93]
    s_and_b32 s14, s2, 7
    s_lshr_b32 s15, s2, 3
    s_lshr_b32 s16, s14, 1
    s_lshr_b32 s17, s15, 3
    s_lshl_b32 s17, s17, 2
    s_add_u32 s16, s16, s17
    s_and_b32 s17, s14, 1
    s_lshl_b32 s17, s17, 3
    s_and_b32 s18, s15, 7
    s_add_u32 s17, s17, s18
    v_lshrrev_b32 v1, 6, v0
    v_and_b32 v0, 63, v0
    v_readfirstlane_b32 s94, v1
    s_lshl_b32 s50, s16, 7
    s_lshl_b32 s14, s17, 3
    s_add_u32 s50, s50, s14
    s_and_b32 s19, s94, 3
    v_lshrrev_b32 v26, 3, v0
    s_lshl_b32 s14, s19, 5
    v_add_u32 v26, s14, v26
    v_mul_u32_u24 v26, 1280, v26
    v_and_b32 v27, 7, v0
    v_lshrrev_b32 v28, 4, v0
    v_xor_b32 v29, v27, v28
    v_xor_b32 v30, 4, v29
    v_lshl_add_u32 v2, v29, 4, v26
    v_lshl_add_u32 v3, v30, 4, v26
    v_add_u32 v3, 10240, v3
    v_add_u32 v4, 20480, v2
    v_add_u32 v5, 20480, v3
    s_lshl_b32 s14, s19, 4
    v_add_u32 v26, s14, v28
    v_mul_u32_u24 v26, 3840, v26
    v_and_b32 v27, 15, v0
    v_lshlrev_b32 v29, 2, v28
    v_xor_b32 v27, v27, v29
    v_lshl_add_u32 v6, v27, 4, v26
    v_add_u32 v7, 15360, v6
    v_add_u32 v8, 30720, v6
    v_add_u32 v9, 46080, v6
    s_mul_i32 s14, s16, 163840
    s_lshl_b32 s15, s17, 8
    s_lshl_b32 s44, s19, 12
    s_add_u32 s18, s16, s17
    s_sub_u32 s39, s18, 10
    s_cmp_ge_u32 s18, 10
    s_cselect_b32 s18, s39, s18
    s_sub_u32 s39, s18, 10
    s_cmp_ge_u32 s18, 10
    s_cselect_b32 s18, s39, s18
    s_lshl_b32 s45, s18, 7
    s_mul_i32 s46, s18, 245760
    s_cmp_eq_u32 s17, 15
    s_cselect_b32 s39, 0, s94
    s_cmp_lt_u32 s39, 4
    s_waitcnt lgkmcnt(0)
    s_cbranch_scc1 L_p1_notL
    s_or_b32 s39, s2, s19
    s_cmp_lg_u32 s39, 0
    s_cbranch_scc1 L_p1_notok
    s_or_b32 s92, s92, 1
    v_mov_b32 v20, s92
    v_mov_b32 v21, s93
    v_mov_b32 v22, 0
    s_mov_b64 exec, 1
    global_store_dwordx2 v22, v[20:21], s[8:9] sc1
    s_mov_b64 exec, -1
    L_p1_notok:
    s_add_u32 s20, s4, s14
    s_addc_u32 s21, s5, 0
    s_mov_b32 s22, 163840
    s_mov_b32 s23, 0x00020000
    s_add_u32 s40, s6, s15
    s_addc_u32 s41, s7, 0
    s_mov_b32 s42, 0
    s_mov_b32 s43, 0x00020000
    s_sub_u32 s42, 2457600, s15
    s_add_u32 m0, s44, 65536
    s_nop 0
    buffer_load_dwordx4 v2, s[20:23], s45 offen lds
    s_add_u32 m0, s44, 81920
    s_nop 0
    buffer_load_dwordx4 v6, s[40:43], s46 offen lds
    s_add_u32 m0, s44, 66560
    s_nop 0
    buffer_load_dwordx4 v3, s[20:23], s45 offen lds
    s_add_u32 m0, s44, 82944
    s_nop 0
    buffer_load_dwordx4 v7, s[40:43], s46 offen lds
    s_add_u32 m0, s44, 67584
    s_nop 0
    buffer_load_dwordx4 v4, s[20:23], s45 offen lds
    s_add_u32 m0, s44, 83968
    s_nop 0
    buffer_load_dwordx4 v8, s[40:43], s46 offen lds
    s_add_u32 m0, s44, 68608
    s_nop 0
    buffer_load_dwordx4 v5, s[20:23], s45 offen lds
    s_add_u32 m0, s44, 84992
    s_nop 0
    buffer_load_dwordx4 v9, s[40:43], s46 offen lds
    s_add_u32 s45, s45, 128
    s_add_u32 s46, s46, 245760
    s_cmp_eq_u32 s45, 1280
    s_cselect_b32 s45, 0, s45
    s_cselect_b32 s46, 0, s46
    s_add_u32 m0, s44, 98304
    s_nop 0
    buffer_load_dwordx4 v2, s[20:23], s45 offen lds
    s_add_u32 m0, s44, 114688
    s_nop 0
    buffer_load_dwordx4 v6, s[40:43], s46 offen lds
    s_add_u32 m0, s44, 99328
    s_nop 0
    buffer_load_dwordx4 v3, s[20:23], s45 offen lds
    s_add_u32 m0, s44, 115712
    s_nop 0
    buffer_load_dwordx4 v7, s[40:43], s46 offen lds
    s_add_u32 m0, s44, 100352
    s_nop 0
    buffer_load_dwordx4 v4, s[20:23], s45 offen lds
    s_add_u32 m0, s44, 116736
    s_nop 0
    buffer_load_dwordx4 v8, s[40:43], s46 offen lds
    s_add_u32 m0, s44, 101376
    s_nop 0
    buffer_load_dwordx4 v5, s[20:23], s45 offen lds
    s_add_u32 m0, s44, 117760
    s_nop 0
    buffer_load_dwordx4 v9, s[40:43], s46 offen lds
    s_add_u32 s45, s45, 128
    s_add_u32 s46, s46, 245760
    s_cmp_eq_u32 s45, 1280
    s_cselect_b32 s45, 0, s45
    s_cselect_b32 s46, 0, s46
    s_mov_b32 s88, s10
    s_mov_b32 s89, s11
    s_mov_b32 s90, 36700160
    s_mov_b32 s91, 0x00020000
    s_mov_b32 s84, s8
    s_mov_b32 s85, s9
    s_mov_b32 s86, 256
    s_mov_b32 s87, 0x00020000
    s_and_b32 s14, s2, 7
    s_mul_i32 s14, s14, 69888
    s_add_u32 s96, s10, s14
    s_addc_u32 s97, s11, 0
    s_mov_b32 s98, 36700160
    s_mov_b32 s99, 0x00020000
    v_and_b32 v32, 31, v0
    v_lshrrev_b32 v27, 5, v0
    v_lshrrev_b32 v28, 1, v32
    v_and_b32 v28, 7, v28
    s_lshl_b32 s47, s19, 5
    v_add_u32 v34, s47, v32
    v_lshlrev_b32 v29, 7, v34
    v_add_u32 v29, 65536, v29
    v_add_u32 v31, 0, v27
    v_xor_b32 v31, v31, v28
    v_lshl_add_u32 v10, v31, 4, v29
    v_add_u32 v31, 2, v27
    v_xor_b32 v31, v31, v28
    v_lshl_add_u32 v11, v31, 4, v29
    v_add_u32 v31, 4, v27
    v_xor_b32 v31, v31, v28
    v_lshl_add_u32 v12, v31, 4, v29
    v_add_u32 v31, 6, v27
    v_xor_b32 v31, v31, v28
    v_lshl_add_u32 v13, v31, 4, v29
    v_bfe_u32 v26, v0, 2, 2
    v_and_b32 v28, 3, v0
    v_bfe_u32 v29, v0, 4, 1
    v_lshl_add_u32 v30, v27, 3, v26
    v_lshlrev_b32 v30, 8, v30
    v_add_u32 v30, 81920, v30
    v_lshlrev_b32 v31, 3, v28
    v_add_u32 v30, v30, v31
    v_lshl_add_u32 v30, v29, 5, v30
    v_xor_b32 v31, s19, v26
    v_lshl_add_u32 v35, v31, 6, v30
    v_mov_b32 v14, 0
    v_mov_b32 v15, 0
    v_mov_b32 v16, 0
    v_mov_b32 v17, 0
    v_mov_b32 v18, 0
    v_mov_b32 v19, 0
    v_and_b32 v26, 15, v0
    v_min_u32 v26, 9, v26
    s_lshl_b32 s14, s16, 7
    s_lshl_b32 s15, s17, 3
    v_lshl_add_u32 v28, v26, 3, s14
    v_lshl_add_u32 v29, v26, 7, s15
    v_cmp_gt_u32 vcc, 16, v0
    s_mov_b32 s37, 0xffff0000
    s_mul_i32 s52, s16, 10240
    s_add_u32 s52, s52, 34078720
    v_cndmask_b32 v24, v29, v28, vcc
    s_mul_i32 s53, s17, 5120
    s_add_u32 s53, s53, 34340864
    s_lshl_b32 s14, s17, 10
    s_add_u32 s54, s52, s14
    s_cmp_lt_u32 s17, 10
    s_cselect_b32 s54, s54, 1073741824
    s_lshl_b32 s14, s16, 9
    s_add_u32 s55, s53, s14
    s_cmp_lt_u32 s16, 10
    s_cselect_b32 s55, s55, 1073741824
    s_lshl_b32 s14, s19, 11
    s_add_u32 s49, s14, 34635776
    s_add_u32 s51, s49, s50
    s_waitcnt vmcnt(8)
    s_barrier
    v_mov_b32 v22, 0
    buffer_load_dwordx2 v[20:21], v22, s[84:87], 0 offen sc1
    ds_read_b128 v[48:51], v10
    ds_read_b128 v[52:55], v11
    ds_read_b128 v[56:59], v12
    ds_read_b128 v[60:63], v13
    ds_read_b64_tr_b16 v[64:65], v35 offset:0
    ds_read_b64_tr_b16 v[66:67], v35 offset:1024
    ds_read_b64_tr_b16 v[68:69], v35 offset:4096
    ds_read_b64_tr_b16 v[70:71], v35 offset:5120
    ds_read_b64_tr_b16 v[72:73], v35 offset:8192
    ds_read_b64_tr_b16 v[74:75], v35 offset:9216
    ds_read_b64_tr_b16 v[76:77], v35 offset:12288
    ds_read_b64_tr_b16 v[78:79], v35 offset:13312
    s_add_u32 m0, s44, 131072
    s_nop 0
    buffer_load_dwordx4 v2, s[20:23], s45 offen lds
    s_add_u32 m0, s44, 147456
    s_nop 0
    buffer_load_dwordx4 v6, s[40:43], s46 offen lds
    s_add_u32 m0, s44, 132096
    s_nop 0
    buffer_load_dwordx4 v3, s[20:23], s45 offen lds
    s_add_u32 m0, s44, 148480
    s_nop 0
    buffer_load_dwordx4 v7, s[40:43], s46 offen lds
    s_add_u32 m0, s44, 133120
    s_nop 0
    buffer_load_dwordx4 v4, s[20:23], s45 offen lds
    s_add_u32 m0, s44, 149504
    s_nop 0
    buffer_load_dwordx4 v8, s[40:43], s46 offen lds
    s_add_u32 m0, s44, 134144
    s_nop 0
    buffer_load_dwordx4 v5, s[20:23], s45 offen lds
    s_add_u32 m0, s44, 150528
    s_nop 0
    buffer_load_dwordx4 v9, s[40:43], s46 offen lds
    s_add_u32 s45, s45, 128
    s_add_u32 s46, s46, 245760
    s_cmp_eq_u32 s45, 1280
    s_cselect_b32 s45, 0, s45
    s_cselect_b32 s46, 0, s46
    s_waitcnt lgkmcnt(0)
    s_add_u32 m0, s44, 0
    v_lshlrev_b32 v26, 16, v48
    buffer_load_dwordx4 v2, s[20:23], s45 offen lds
    v_and_b32 v27, s37, v48
    v_add_f32 v14, v14, v26
    v_add_f32 v15, v15, v27
    v_fmac_f32 v16, v26, v26
    v_fmac_f32 v17, v27, v27
    v_lshlrev_b32 v28, 16, v49
    v_and_b32 v29, s37, v49
    v_add_f32 v14, v14, v28
    v_add_f32 v15, v15, v29
    v_fmac_f32 v16, v28, v28
    v_fmac_f32 v17, v29, v29
    s_add_u32 m0, s44, 16384
    v_lshlrev_b32 v26, 16, v50
    buffer_load_dwordx4 v6, s[40:43], s46 offen lds
    v_and_b32 v27, s37, v50
    v_add_f32 v14, v14, v26
    v_add_f32 v15, v15, v27
    v_fmac_f32 v16, v26, v26
    v_fmac_f32 v17, v27, v27
    v_lshlrev_b32 v28, 16, v51
    v_and_b32 v29, s37, v51
    v_add_f32 v14, v14, v28
    v_add_f32 v15, v15, v29
    v_fmac_f32 v16, v28, v28
    v_fmac_f32 v17, v29, v29
    s_add_u32 m0, s44, 1024
    v_lshlrev_b32 v26, 16, v52
    buffer_load_dwordx4 v3, s[20:23], s45 offen lds
    v_and_b32 v27, s37, v52
    v_add_f32 v14, v14, v26
    v_add_f32 v15, v15, v27
    v_fmac_f32 v16, v26, v26
    v_fmac_f32 v17, v27, v27
    v_lshlrev_b32 v28, 16, v53
    v_and_b32 v29, s37, v53
    v_add_f32 v14, v14, v28
    v_add_f32 v15, v15, v29
    v_fmac_f32 v16, v28, v28
    v_fmac_f32 v17, v29, v29
    s_add_u32 m0, s44, 17408
    v_lshlrev_b32 v26, 16, v54
    buffer_load_dwordx4 v7, s[40:43], s46 offen lds
    v_and_b32 v27, s37, v54
    v_add_f32 v14, v14, v26
    v_add_f32 v15, v15, v27
    v_fmac_f32 v16, v26, v26
    v_fmac_f32 v17, v27, v27
    v_lshlrev_b32 v28, 16, v55
    v_and_b32 v29, s37, v55
    v_add_f32 v14, v14, v28
    v_add_f32 v15, v15, v29
    v_fmac_f32 v16, v28, v28
    v_fmac_f32 v17, v29, v29
    s_add_u32 m0, s44, 2048
    v_lshlrev_b32 v26, 16, v64
    buffer_load_dwordx4 v4, s[20:23], s45 offen lds
    v_and_b32 v27, s37, v64
    v_add_f32 v18, v18, v26
    v_add_f32 v19, v19, v27
    v_lshlrev_b32 v28, 16, v65
    v_and_b32 v29, s37, v65
    v_add_f32 v18, v18, v28
    v_add_f32 v19, v19, v29
    s_add_u32 m0, s44, 18432
    v_lshlrev_b32 v26, 16, v66
    buffer_load_dwordx4 v8, s[40:43], s46 offen lds
    v_and_b32 v27, s37, v66
    v_add_f32 v18, v18, v26
    v_add_f32 v19, v19, v27
    v_lshlrev_b32 v28, 16, v67
    v_and_b32 v29, s37, v67
    v_add_f32 v18, v18, v28
    v_add_f32 v19, v19, v29
    s_add_u32 m0, s44, 3072
    v_lshlrev_b32 v26, 16, v68
    buffer_load_dwordx4 v5, s[20:23], s45 offen lds
    v_and_b32 v27, s37, v68
    v_add_f32 v18, v18, v26
    v_add_f32 v19, v19, v27
    v_lshlrev_b32 v28, 16, v69
    v_and_b32 v29, s37, v69
    v_add_f32 v18, v18, v28
    v_add_f32 v19, v19, v29
    s_add_u32 m0, s44, 19456
    v_lshlrev_b32 v26, 16, v70
    buffer_load_dwordx4 v9, s[40:43], s46 offen lds
    v_and_b32 v27, s37, v70
    v_add_f32 v18, v18, v26
    v_add_f32 v19, v19, v27
    v_lshlrev_b32 v28, 16, v71
    v_and_b32 v29, s37, v71
    v_add_f32 v18, v18, v28
    v_add_f32 v19, v19, v29
    s_add_u32 s45, s45, 128
    s_add_u32 s46, s46, 245760
    s_cmp_eq_u32 s45, 1280
    s_cselect_b32 s45, 0, s45
    s_cselect_b32 s46, 0, s46
    s_waitcnt vmcnt(16)
    s_barrier
    s_add_u32 m0, s44, 32768
    v_lshlrev_b32 v26, 16, v56
    buffer_load_dwordx4 v2, s[20:23], s45 offen lds
    v_and_b32 v27, s37, v56
    v_add_f32 v14, v14, v26
    v_add_f32 v15, v15, v27
    v_fmac_f32 v16, v26, v26
    v_fmac_f32 v17, v27, v27
    v_lshlrev_b32 v28, 16, v57
    v_and_b32 v29, s37, v57
    v_add_f32 v14, v14, v28
    v_add_f32 v15, v15, v29
    v_fmac_f32 v16, v28, v28
    v_fmac_f32 v17, v29, v29
    s_add_u32 m0, s44, 49152
    v_lshlrev_b32 v26, 16, v58
    buffer_load_dwordx4 v6, s[40:43], s46 offen lds
    v_and_b32 v27, s37, v58
    v_add_f32 v14, v14, v26
    v_add_f32 v15, v15, v27
    v_fmac_f32 v16, v26, v26
    v_fmac_f32 v17, v27, v27
    v_lshlrev_b32 v28, 16, v59
    v_and_b32 v29, s37, v59
    v_add_f32 v14, v14, v28
    v_add_f32 v15, v15, v29
    v_fmac_f32 v16, v28, v28
    v_fmac_f32 v17, v29, v29
    s_add_u32 m0, s44, 33792
    v_lshlrev_b32 v26, 16, v60
    buffer_load_dwordx4 v3, s[20:23], s45 offen lds
    v_and_b32 v27, s37, v60
    v_add_f32 v14, v14, v26
    v_add_f32 v15, v15, v27
    v_fmac_f32 v16, v26, v26
    v_fmac_f32 v17, v27, v27
    v_lshlrev_b32 v28, 16, v61
    v_and_b32 v29, s37, v61
    v_add_f32 v14, v14, v28
    v_add_f32 v15, v15, v29
    v_fmac_f32 v16, v28, v28
    v_fmac_f32 v17, v29, v29
    s_add_u32 m0, s44, 50176
    v_lshlrev_b32 v26, 16, v62
    buffer_load_dwordx4 v7, s[40:43], s46 offen lds
    v_and_b32 v27, s37, v62
    v_add_f32 v14, v14, v26
    v_add_f32 v15, v15, v27
    v_fmac_f32 v16, v26, v26
    v_fmac_f32 v17, v27, v27
    v_lshlrev_b32 v28, 16, v63
    v_and_b32 v29, s37, v63
    v_add_f32 v14, v14, v28
    v_add_f32 v15, v15, v29
    v_fmac_f32 v16, v28, v28
    v_fmac_f32 v17, v29, v29
    s_add_u32 m0, s44, 34816
    v_lshlrev_b32 v26, 16, v72
    buffer_load_dwordx4 v4, s[20:23], s45 offen lds
    v_and_b32 v27, s37, v72
    v_add_f32 v18, v18, v26
    v_add_f32 v19, v19, v27
    v_lshlrev_b32 v28, 16, v73
    v_and_b32 v29, s37, v73
    v_add_f32 v18, v18, v28
    v_add_f32 v19, v19, v29
    s_add_u32 m0, s44, 51200
    v_lshlrev_b32 v26, 16, v74
    buffer_load_dwordx4 v8, s[40:43], s46 offen lds
    v_and_b32 v27, s37, v74
    v_add_f32 v18, v18, v26
    v_add_f32 v19, v19, v27
    v_lshlrev_b32 v28, 16, v75
    v_and_b32 v29, s37, v75
    v_add_f32 v18, v18, v28
    v_add_f32 v19, v19, v29
    s_add_u32 m0, s44, 35840
    v_lshlrev_b32 v26, 16, v76
    buffer_load_dwordx4 v5, s[20:23], s45 offen lds
    v_and_b32 v27, s37, v76
    v_add_f32 v18, v18, v26
    v_add_f32 v19, v19, v27
    v_lshlrev_b32 v28, 16, v77
    v_and_b32 v29, s37, v77
    v_add_f32 v18, v18, v28
    v_add_f32 v19, v19, v29
    s_add_u32 m0, s44, 52224
    v_lshlrev_b32 v26, 16, v78
    buffer_load_dwordx4 v9, s[40:43], s46 offen lds
    v_and_b32 v27, s37, v78
    v_add_f32 v18, v18, v26
    v_add_f32 v19, v19, v27
    v_lshlrev_b32 v28, 16, v79
    v_and_b32 v29, s37, v79
    v_add_f32 v18, v18, v28
    v_add_f32 v19, v19, v29
    s_add_u32 s45, s45, 128
    s_add_u32 s46, s46, 245760
    s_cmp_eq_u32 s45, 1280
    s_cselect_b32 s45, 0, s45
    s_cselect_b32 s46, 0, s46
    s_waitcnt vmcnt(16)
    s_barrier
    v_add_f32 v14, v14, v15
    v_add_f32 v15, v16, v17
    v_add_f32 v16, v18, v19
    v_mov_b32 v26, v14
    v_mov_b32 v27, v15
    v_mov_b32 v28, v16
    s_nop 0
    v_permlane32_swap_b32 v14, v26
    v_permlane32_swap_b32 v15, v27
    v_permlane32_swap_b32 v16, v28
    v_lshlrev_b32 v29, 3, v34
    v_lshlrev_b32 v30, 2, v34
    v_add_f32 v14, v14, v26
    v_add_f32 v15, v15, v27
    v_add_f32 v16, v16, v28
    s_mov_b32 exec_hi, 0
    buffer_store_dwordx2 v[14:15], v29, s[88:91], s54 offen sc1
    buffer_store_dword v16, v30, s[88:91], s55 offen sc1
    s_mov_b32 exec_hi, -1
    s_add_u32 m0, s44, 65536
    s_nop 0
    buffer_load_dwordx4 v2, s[20:23], s45 offen lds
    s_add_u32 m0, s44, 81920
    s_nop 0
    buffer_load_dwordx4 v6, s[40:43], s46 offen lds
    s_add_u32 m0, s44, 66560
    s_nop 0
    buffer_load_dwordx4 v3, s[20:23], s45 offen lds
    s_add_u32 m0, s44, 82944
    s_nop 0
    buffer_load_dwordx4 v7, s[40:43], s46 offen lds
    s_add_u32 m0, s44, 67584
    s_nop 0
    buffer_load_dwordx4 v4, s[20:23], s45 offen lds
    s_add_u32 m0, s44, 83968
    s_nop 0
    buffer_load_dwordx4 v8, s[40:43], s46 offen lds
    s_add_u32 m0, s44, 68608
    s_nop 0
    buffer_load_dwordx4 v5, s[20:23], s45 offen lds
    s_add_u32 m0, s44, 84992
    s_nop 0
    buffer_load_dwordx4 v9, s[40:43], s46 offen lds
    s_add_u32 s45, s45, 128
    s_add_u32 s46, s46, 245760
    s_cmp_eq_u32 s45, 1280
    s_cselect_b32 s45, 0, s45
    s_cselect_b32 s46, 0, s46
    s_waitcnt vmcnt(8)
    s_barrier
    s_mov_b32 s48, 16384
    v_mov_b32 v22, 0
L_tok1:
    v_readfirstlane_b32 s92, v20
    v_readfirstlane_b32 s93, v21
    s_sub_u32 s48, s48, 1
    s_cbranch_scc1 L_tok1_ok
    s_cmp_lg_u32 s92, 0
    s_cbranch_scc1 L_tok1_ok
    s_sleep 1
    buffer_load_dwordx2 v[20:21], v22, s[84:87], 0 offen sc1
    s_waitcnt vmcnt(0)
    s_branch L_tok1
L_tok1_ok:
    v_mov_b32 v20, s92
    v_mov_b32 v21, s93
    v_mbcnt_lo_u32_b32 v22, -1, 0
    v_mul_u32_u24 v22, 69888, v22
    s_mov_b64 exec, 255
    buffer_store_dwordx2 v[20:21], v22, s[88:91], s51 offen sc1
    s_mov_b64 exec, -1
    s_add_u32 m0, s44, 98304
    s_nop 0
    buffer_load_dwordx4 v2, s[20:23], s45 offen lds
    s_add_u32 m0, s44, 114688
    s_nop 0
    buffer_load_dwordx4 v6, s[40:43], s46 offen lds
    s_add_u32 m0, s44, 99328
    s_nop 0
    buffer_load_dwordx4 v3, s[20:23], s45 offen lds
    s_add_u32 m0, s44, 115712
    s_nop 0
    buffer_load_dwordx4 v7, s[40:43], s46 offen lds
    s_add_u32 m0, s44, 100352
    s_nop 0
    buffer_load_dwordx4 v4, s[20:23], s45 offen lds
    s_add_u32 m0, s44, 116736
    s_nop 0
    buffer_load_dwordx4 v8, s[40:43], s46 offen lds
    s_add_u32 m0, s44, 101376
    s_nop 0
    buffer_load_dwordx4 v5, s[20:23], s45 offen lds
    s_add_u32 m0, s44, 117760
    s_nop 0
    buffer_load_dwordx4 v9, s[40:43], s46 offen lds
    s_add_u32 s45, s45, 128
    s_add_u32 s46, s46, 245760
    s_cmp_eq_u32 s45, 1280
    s_cselect_b32 s45, 0, s45
    s_cselect_b32 s46, 0, s46
    s_waitcnt vmcnt(16)
    s_barrier
    s_add_u32 m0, s44, 131072
    s_nop 0
    buffer_load_dwordx4 v2, s[20:23], s45 offen lds
    s_add_u32 m0, s44, 147456
    s_nop 0
    buffer_load_dwordx4 v6, s[40:43], s46 offen lds
    s_add_u32 m0, s44, 132096
    s_nop 0
    buffer_load_dwordx4 v3, s[20:23], s45 offen lds
    s_add_u32 m0, s44, 148480
    s_nop 0
    buffer_load_dwordx4 v7, s[40:43], s46 offen lds
    s_add_u32 m0, s44, 133120
    s_nop 0
    buffer_load_dwordx4 v4, s[20:23], s45 offen lds
    s_add_u32 m0, s44, 149504
    s_nop 0
    buffer_load_dwordx4 v8, s[40:43], s46 offen lds
    s_add_u32 m0, s44, 134144
    s_nop 0
    buffer_load_dwordx4 v5, s[20:23], s45 offen lds
    s_add_u32 m0, s44, 150528
    s_nop 0
    buffer_load_dwordx4 v9, s[40:43], s46 offen lds
    s_add_u32 s45, s45, 128
    s_add_u32 s46, s46, 245760
    s_cmp_eq_u32 s45, 1280
    s_cselect_b32 s45, 0, s45
    s_cselect_b32 s46, 0, s46
    s_waitcnt vmcnt(16)
    s_barrier
    s_add_u32 m0, s44, 0
    s_nop 0
    buffer_load_dwordx4 v2, s[20:23], s45 offen lds
    s_add_u32 m0, s44, 16384
    s_nop 0
    buffer_load_dwordx4 v6, s[40:43], s46 offen lds
    s_add_u32 m0, s44, 1024
    s_nop 0
    buffer_load_dwordx4 v3, s[20:23], s45 offen lds
    s_add_u32 m0, s44, 17408
    s_nop 0
    buffer_load_dwordx4 v7, s[40:43], s46 offen lds
    s_add_u32 m0, s44, 2048
    s_nop 0
    buffer_load_dwordx4 v4, s[20:23], s45 offen lds
    s_add_u32 m0, s44, 18432
    s_nop 0
    buffer_load_dwordx4 v8, s[40:43], s46 offen lds
    s_add_u32 m0, s44, 3072
    s_nop 0
    buffer_load_dwordx4 v5, s[20:23], s45 offen lds
    s_add_u32 m0, s44, 19456
    s_nop 0
    buffer_load_dwordx4 v9, s[40:43], s46 offen lds
    s_add_u32 s45, s45, 128
    s_add_u32 s46, s46, 245760
    s_cmp_eq_u32 s45, 1280
    s_cselect_b32 s45, 0, s45
    s_cselect_b32 s46, 0, s46
    s_waitcnt vmcnt(16)
    s_barrier
    s_add_u32 m0, s44, 32768
    s_nop 0
    buffer_load_dwordx4 v2, s[20:23], s45 offen lds
    s_add_u32 m0, s44, 49152
    s_nop 0
    buffer_load_dwordx4 v6, s[40:43], s46 offen lds
    s_add_u32 m0, s44, 33792
    s_nop 0
    buffer_load_dwordx4 v3, s[20:23], s45 offen lds
    s_add_u32 m0, s44, 50176
    s_nop 0
    buffer_load_dwordx4 v7, s[40:43], s46 offen lds
    s_add_u32 m0, s44, 34816
    s_nop 0
    buffer_load_dwordx4 v4, s[20:23], s45 offen lds
    s_add_u32 m0, s44, 51200
    s_nop 0
    buffer_load_dwordx4 v8, s[40:43], s46 offen lds
    s_add_u32 m0, s44, 35840
    s_nop 0
    buffer_load_dwordx4 v5, s[20:23], s45 offen lds
    s_add_u32 m0, s44, 52224
    s_nop 0
    buffer_load_dwordx4 v9, s[40:43], s46 offen lds
    s_add_u32 s45, s45, 128
    s_add_u32 s46, s46, 245760
    s_cmp_eq_u32 s45, 1280
    s_cselect_b32 s45, 0, s45
    s_cselect_b32 s46, 0, s46
    s_waitcnt vmcnt(16)
    s_barrier
    s_mov_b32 s14, s49
    buffer_load_dwordx2 v[20:21], v24, s[96:99], s14 offen sc1
    v_lshrrev_b32 v27, 5, v0
    v_mul_u32_u24 v26, 5120, v27
    v_lshl_add_u32 v26, v34, 3, v26
    v_mul_u32_u24 v27, 2560, v27
    v_lshl_add_u32 v27, v34, 2, v27
    s_waitcnt vmcnt(0)
    v_cmp_ne_u64 vcc, s[92:93], v[20:21]
    s_lshl_b32 s56, s2, 3
    s_lshl_b32 s15, s19, 1
    s_add_u32 s56, s56, s15
    s_mov_b32 s80, 65536
    s_cmp_eq_u64 vcc, 0
    s_cbranch_scc1 L_p1_fsok
    s_mov_b32 s48, 16384
L_poll2:
    buffer_load_dwordx2 v[20:21], v24, s[96:99], s14 offen offset:0 sc1
    s_waitcnt vmcnt(0)
    v_cmp_ne_u64 vcc, s[92:93], v[20:21]
    s_sub_u32 s48, s48, 1
    s_cbranch_scc1 L_poll2_ok
    s_cmp_eq_u64 vcc, 0
    s_cbranch_scc1 L_poll2_ok
    s_sleep 1
    s_branch L_poll2
L_poll2_ok:
L_p1_fsok:
    s_add_u32 s14, s52, 4096
    buffer_load_dwordx2 v[48:49], v26, s[88:91], s52 offen offset:0 sc1
    buffer_load_dwordx2 v[50:51], v26, s[88:91], s52 offen offset:1024 sc1
    buffer_load_dwordx2 v[52:53], v26, s[88:91], s52 offen offset:2048 sc1
    buffer_load_dwordx2 v[54:55], v26, s[88:91], s52 offen offset:3072 sc1
    buffer_load_dwordx2 v[56:57], v26, s[88:91], s14 offen sc1
    buffer_load_dword v58, v27, s[88:91], s53 offen offset:0 sc1
    buffer_load_dword v59, v27, s[88:91], s53 offen offset:512 sc1
    buffer_load_dword v60, v27, s[88:91], s53 offen offset:1024 sc1
    buffer_load_dword v61, v27, s[88:91], s53 offen offset:1536 sc1
    buffer_load_dword v62, v27, s[88:91], s53 offen offset:2048 sc1
    s_barrier
    s_cmp_lg_u32 s19, 0
    s_cbranch_scc1 L_p1_nopk
    s_mov_b32 s27, 0x00020000
    s_mov_b32 s31, 0x00020000
    s_cmp_lt_u32 s2, 200
    s_cbranch_scc1 L_pka_c
    s_cmp_ge_u32 s2, 1280
    s_cbranch_scc1 L_pka_b
    s_sub_u32 s38, s2, 200
    s_mul_i32 s75, s38, 2428
    s_lshr_b32 s75, s75, 16
    s_mul_i32 s76, s75, 27
    s_sub_u32 s76, s38, s76
    s_mov_b32 s24, s68
    s_mov_b32 s25, s69
    s_mov_b32 s26, 2211840
    s_mov_b32 s28, s70
    s_mov_b32 s29, s71
    s_mov_b32 s30, 2211840
    s_mul_i32 s32, s75, 55296
    s_lshl_b32 s36, s76, 7
    s_add_u32 s32, s32, s36
    s_add_u32 s33, s32, 13824
    s_mov_b32 s34, s32
    s_mov_b32 s35, s33
    s_mov_b32 s36, 3456
    s_mov_b32 s37, 4
    s_mov_b32 s79, 1
    s_mov_b32 s78, 40960
    s_mov_b32 s77, 25165824
    s_branch L_pka_go
    L_pka_b:
    s_sub_u32 s38, s2, 1280
    s_mul_i32 s75, s38, 6554
    s_lshr_b32 s75, s75, 16
    s_mul_i32 s76, s75, 10
    s_sub_u32 s76, s38, s76
    s_mov_b32 s24, s72
    s_mov_b32 s25, s73
    s_cmp_lt_u32 s38, 540
    s_cselect_b32 s26, 2211840, 0
    s_cselect_b32 s77, 30408704, 1073741824
    s_mul_i32 s32, s75, 7
    s_sub_u32 s33, s32, 110
    s_cmp_ge_u32 s75, 16
    s_cselect_b32 s34, s33, s32
    s_sub_u32 s33, s32, 213
    s_cmp_ge_u32 s75, 31
    s_cselect_b32 s34, s33, s34
    s_add_u32 s35, s34, 1
    s_lshl_b32 s33, s32, 1
    s_sub_u32 s33, s33, 638
    s_add_u32 s36, s33, 7
    s_min_u32 s36, s36, 107
    s_cmp_ge_u32 s75, 46
    s_cselect_b32 s34, s33, s34
    s_cselect_b32 s35, s36, s35
    s_mul_i32 s32, s34, 20480
    s_add_u32 s33, s32, 10240
    s_mul_i32 s34, s35, 20480
    s_add_u32 s35, s34, 10240
    s_mov_b32 s78, 55296
    s_branch L_pka_d
    L_pka_c:
    s_mul_i32 s75, s2, 6554
    s_lshr_b32 s75, s75, 16
    s_mul_i32 s76, s75, 10
    s_sub_u32 s76, s2, s76
    s_mov_b32 s24, s66
    s_mov_b32 s25, s67
    s_mov_b32 s26, 819200
    s_mov_b32 s77, 33030144
    s_mul_i32 s36, s75, 52
    s_lshr_b32 s36, s36, 8
    s_mul_i32 s37, s36, 5
    s_sub_u32 s37, s75, s37
    s_mul_i32 s38, s36, 204800
    s_mul_i32 s39, s37, 51200
    s_add_u32 s32, s38, s39
    s_add_u32 s33, s32, 10240
    s_add_u32 s34, s32, 30720
    s_add_u32 s35, s32, 40960
    s_cmp_lt_u32 s37, 4
    s_cbranch_scc1 L_pka_e
    s_add_u32 s32, s38, 20480
    s_add_u32 s33, s32, 102400
    s_add_u32 s34, s32, 51200
    s_add_u32 s35, s32, 153600
    L_pka_e:
    s_mov_b32 s78, 20480
    L_pka_d:
    s_mov_b32 s28, s24
    s_mov_b32 s29, s25
    s_mov_b32 s30, s26
    s_lshl_b32 s36, s76, 7
    s_add_u32 s32, s32, s36
    s_add_u32 s33, s33, s36
    s_add_u32 s34, s34, s36
    s_add_u32 s35, s35, s36
    s_mov_b32 s36, 1280
    s_mov_b32 s37, 0
    s_mov_b32 s79, 0
    L_pka_go:
    v_lshrrev_b32 v28, 3, v0
    v_lshrrev_b32 v29, 5, v0
    v_mul_u32_u24 v30, s37, v29
    v_add_u32 v28, v28, v30
    v_mul_u32_u24 v28, s36, v28
    v_and_b32 v30, 7, v0
    v_lshl_add_u32 v28, v30, 4, v28
    s_mov_b32 m0, s80
    s_lshl_b32 s76, s76, 2
    buffer_load_dwordx4 v28, s[24:27], s32 offen lds
    s_add_u32 m0, s80, 1024
    s_mul_i32 s76, s76, s78
    buffer_load_dwordx4 v28, s[24:27], s33 offen lds
    s_add_u32 m0, s80, 2048
    s_lshl_b32 s75, s75, 10
    buffer_load_dwordx4 v28, s[28:31], s34 offen lds
    s_add_u32 m0, s80, 3072
    s_add_u32 s77, s77, s76
    buffer_load_dwordx4 v28, s[28:31], s35 offen lds
    s_add_u32 s77, s77, s75
L_p1_nopk:
    s_barrier
    s_cmp_lg_u32 s19, 0
    s_cbranch_scc1 L_p1_w0
    s_waitcnt vmcnt(4)
    s_branch L_p1_w1
L_p1_w0:
    s_waitcnt vmcnt(0)
L_p1_w1:
    v_add_f32 v48, v48, v50
    v_add_f32 v49, v49, v51
    v_add_f32 v58, v58, v59
    v_add_f32 v48, v48, v52
    v_add_f32 v49, v49, v53
    v_add_f32 v58, v58, v60
    v_add_f32 v48, v48, v54
    v_add_f32 v49, v49, v55
    v_add_f32 v58, v58, v61
    v_add_f32 v48, v48, v56
    v_add_f32 v49, v49, v57
    v_add_f32 v58, v58, v62
    v_mov_b32 v26, v48
    v_mov_b32 v27, v49
    v_mov_b32 v28, v58
    s_nop 0
    v_permlane32_swap_b32 v48, v26
    v_permlane32_swap_b32 v49, v27
    v_permlane32_swap_b32 v58, v28
    v_lshlrev_b32 v29, 3, v34
    v_lshlrev_b32 v30, 2, v34
    v_add_f32 v14, v48, v26
    v_add_f32 v15, v49, v27
    v_add_f32 v16, v58, v28
    v_mul_f32 v14, 0x3acccccd, v14
    v_mul_f32 v15, 0x3acccccd, v15
    v_fma_f32 v15, -v14, v14, v15
    v_max_f32 v15, 0, v15
    v_cvt_pk_bf16_f32 v14, v14, v14
    v_lshlrev_b32 v14, 16, v14
    v_cvt_pk_bf16_f32 v15, v15, v15
    v_lshlrev_b32 v15, 16, v15
    v_sub_f32 v14, 0, v14
    v_add_f32 v15, 0x3727c5ac, v15
    v_cvt_pk_bf16_f32 v15, v15, v15
    v_lshlrev_b32 v15, 16, v15
    v_sqrt_f32 v15, v15
    s_nop 0
    v_cvt_pk_bf16_f32 v15, v15, v15
    v_lshlrev_b32 v15, 16, v15
    v_rcp_f32 v15, v15
    s_cmp_lt_u32 s17, 5
    s_cselect_b32 s14, 0x3ea52b5c, 1.0
    v_mul_f32 v15, s14, v15
    v_add_u32 v30, 98304, v30
    v_add_u32 v29, 98304, v29
    ds_write_b32 v30, v16
    ds_write_b64 v29, v[14:15] offset:512
    s_waitcnt lgkmcnt(0)
    s_barrier
L_p1_packout:
    s_barrier
    s_branch L_p1_end
L_p1_notL:
    s_mov_b32 s88, s10
    s_mov_b32 s89, s11
    s_mov_b32 s90, 36700160
    s_mov_b32 s91, 0x00020000
    s_mov_b32 s84, s8
    s_mov_b32 s85, s9
    s_mov_b32 s86, 256
    s_mov_b32 s87, 0x00020000
    s_and_b32 s14, s2, 7
    s_mul_i32 s14, s14, 69888
    s_add_u32 s96, s10, s14
    s_addc_u32 s97, s11, 0
    s_mov_b32 s98, 36700160
    s_mov_b32 s99, 0x00020000
    s_cmp_eq_u32 s17, 15
    s_cbranch_scc1 L_p1_aux
    s_lshr_b32 s40, s94, 1
    s_and_b32 s41, s94, 1
    v_and_b32 v26, 31, v0
    v_lshrrev_b32 v27, 5, v0
    v_lshrrev_b32 v28, 1, v26
    v_and_b32 v28, 7, v28
    s_lshl_b32 s42, s40, 6
    v_add_u32 v29, s42, v26
    v_lshlrev_b32 v29, 7, v29
    v_add_u32 v29, 65536, v29
    v_add_u32 v31, 0, v27
    v_xor_b32 v31, v31, v28
    v_lshl_add_u32 v10, v31, 4, v29
    v_add_u32 v31, 2, v27
    v_xor_b32 v31, v31, v28
    v_lshl_add_u32 v11, v31, 4, v29
    v_add_u32 v31, 4, v27
    v_xor_b32 v31, v31, v28
    v_lshl_add_u32 v12, v31, 4, v29
    v_add_u32 v31, 6, v27
    v_xor_b32 v31, v31, v28
    v_lshl_add_u32 v13, v31, 4, v29
    v_bfe_u32 v26, v0, 2, 2
    v_and_b32 v28, 3, v0
    v_bfe_u32 v29, v0, 4, 1
    v_lshl_add_u32 v30, v27, 3, v26
    v_lshlrev_b32 v30, 8, v30
    v_add_u32 v30, 81920, v30
    v_lshlrev_b32 v31, 3, v28
    v_add_u32 v30, v30, v31
    v_lshl_add_u32 v30, v29, 5, v30
    s_lshl_b32 s44, s41, 1
    s_add_u32 s45, s44, 1
    v_xor_b32 v31, s44, v26
    v_lshl_add_u32 v18, v31, 6, v30
    v_xor_b32 v31, s45, v26
    v_lshl_add_u32 v19, v31, 6, v30
    s_mov_b32 s32, 0
    s_mov_b32 s38, 65536
    s_cmp_eq_u32 s94, 0
    s_cselect_b32 s46, 2, 100
    s_cselect_b32 s47, 3, 100
    s_lshr_b32 s20, s2, 3
    s_xor_b32 s21, s94, 1
    s_or_b32 s20, s20, s21
    s_cmp_lg_u32 s20, 0
    s_cbranch_scc1 L_cpe1
    s_getpc_b64 s[20:21]
    L_cp1:
    s_add_u32 s20, s20, L_p1_loop-L_cp1
    s_addc_u32 s21, s21, 0
    v_lshlrev_b32 v40, 7, v0
    v_min_u32 v42, L_p2_end-L_p1_loop, v40
    global_load_dword v41, v42, s[20:21]
    v_add_u32 v40, 8192, v40
    v_min_u32 v42, L_p2_end-L_p1_loop, v40
    global_load_dword v41, v42, s[20:21]
    v_add_u32 v40, 8192, v40
L_cpe1:
    v_mov_b32 v64, 0
    v_mov_b32 v65, 0
    v_mov_b32 v66, 0
    v_mov_b32 v67, 0
    v_mov_b32 v68, 0
    v_mov_b32 v69, 0
    v_mov_b32 v70, 0
    v_mov_b32 v71, 0
    v_mov_b32 v72, 0
    v_mov_b32 v73, 0
    v_mov_b32 v74, 0
    v_mov_b32 v75, 0
    v_mov_b32 v76, 0
    v_mov_b32 v77, 0
    v_mov_b32 v78, 0
    v_mov_b32 v79, 0
    v_mov_b32 v80, 0
    v_mov_b32 v81, 0
    v_mov_b32 v82, 0
    v_mov_b32 v83, 0
    v_mov_b32 v84, 0
    v_mov_b32 v85, 0
    v_mov_b32 v86, 0
    v_mov_b32 v87, 0
    v_mov_b32 v88, 0
    v_mov_b32 v89, 0
    v_mov_b32 v90, 0
    v_mov_b32 v91, 0
    v_mov_b32 v92, 0
    v_mov_b32 v93, 0
    v_mov_b32 v94, 0
    v_mov_b32 v95, 0
    v_mov_b32 v96, 0
    v_mov_b32 v97, 0
    v_mov_b32 v98, 0
    v_mov_b32 v99, 0
    v_mov_b32 v100, 0
    v_mov_b32 v101, 0
    v_mov_b32 v102, 0
    v_mov_b32 v103, 0
    v_mov_b32 v104, 0
    v_mov_b32 v105, 0
    v_mov_b32 v106, 0
    v_mov_b32 v107, 0
    v_mov_b32 v108, 0
    v_mov_b32 v109, 0
    v_mov_b32 v110, 0
    v_mov_b32 v111, 0
    v_mov_b32 v112, 0
    v_mov_b32 v113, 0
    v_mov_b32 v114, 0
    v_mov_b32 v115, 0
    v_mov_b32 v116, 0
    v_mov_b32 v117, 0
    v_mov_b32 v118, 0
    v_mov_b32 v119, 0
    v_mov_b32 v120, 0
    v_mov_b32 v121, 0
    v_mov_b32 v122, 0
    v_mov_b32 v123, 0
    v_mov_b32 v124, 0
    v_mov_b32 v125, 0
    v_mov_b32 v126, 0
    v_mov_b32 v127, 0
    s_barrier
    ds_read_b128 v[128:131], v10
    ds_read_b64_tr_b16 v[136:137], v18 offset:0
    ds_read_b64_tr_b16 v[138:139], v18 offset:1024
    ds_read_b128 v[132:135], v10 offset:4096
    ds_read_b64_tr_b16 v[140:141], v19 offset:0
    ds_read_b64_tr_b16 v[142:143], v19 offset:1024
L_p1_loop:
    s_add_u32 s39, s38, 32768
    s_cmp_eq_u32 s39, 163840
    s_cselect_b32 s39, 0, s39
    s_sub_u32 s33, s39, s38
    s_mov_b32 s38, s39
    s_waitcnt lgkmcnt(3)
    v_mfma_f32_32x32x16_bf16 v[64:79], v[136:139], v[128:131], v[64:79]
    ds_read_b128 v[144:147], v11
    ds_read_b64_tr_b16 v[152:153], v18 offset:4096
    s_waitcnt lgkmcnt(4)
    v_mfma_f32_32x32x16_bf16 v[80:95], v[136:139], v[132:135], v[80:95]
    ds_read_b64_tr_b16 v[154:155], v18 offset:5120
    ds_read_b128 v[148:151], v11 offset:4096
    s_waitcnt lgkmcnt(4)
    v_mfma_f32_32x32x16_bf16 v[96:111], v[140:143], v[128:131], v[96:111]
    ds_read_b64_tr_b16 v[156:157], v19 offset:4096
    ds_read_b64_tr_b16 v[158:159], v19 offset:5120
    v_mfma_f32_32x32x16_bf16 v[112:127], v[140:143], v[132:135], v[112:127]
    v_add_u32 v11, s33, v11
    v_add_u32 v10, s33, v10
    s_waitcnt lgkmcnt(3)
    v_mfma_f32_32x32x16_bf16 v[64:79], v[152:155], v[144:147], v[64:79]
    ds_read_b128 v[128:131], v12
    ds_read_b64_tr_b16 v[136:137], v18 offset:8192
    s_waitcnt lgkmcnt(4)
    v_mfma_f32_32x32x16_bf16 v[80:95], v[152:155], v[148:151], v[80:95]
    ds_read_b64_tr_b16 v[138:139], v18 offset:9216
    ds_read_b128 v[132:135], v12 offset:4096
    s_waitcnt lgkmcnt(4)
    v_mfma_f32_32x32x16_bf16 v[96:111], v[156:159], v[144:147], v[96:111]
    ds_read_b64_tr_b16 v[140:141], v19 offset:8192
    ds_read_b64_tr_b16 v[142:143], v19 offset:9216
    v_mfma_f32_32x32x16_bf16 v[112:127], v[156:159], v[148:151], v[112:127]
    v_add_u32 v12, s33, v12
    s_waitcnt lgkmcnt(3)
    v_mfma_f32_32x32x16_bf16 v[64:79], v[136:139], v[128:131], v[64:79]
    ds_read_b128 v[144:147], v13
    ds_read_b64_tr_b16 v[152:153], v18 offset:12288
    s_waitcnt lgkmcnt(4)
    v_mfma_f32_32x32x16_bf16 v[80:95], v[136:139], v[132:135], v[80:95]
    ds_read_b64_tr_b16 v[154:155], v18 offset:13312
    ds_read_b128 v[148:151], v13 offset:4096
    s_waitcnt lgkmcnt(4)
    v_mfma_f32_32x32x16_bf16 v[96:111], v[140:143], v[128:131], v[96:111]
    ds_read_b64_tr_b16 v[156:157], v19 offset:12288
    ds_read_b64_tr_b16 v[158:159], v19 offset:13312
    v_mfma_f32_32x32x16_bf16 v[112:127], v[140:143], v[132:135], v[112:127]
    v_add_u32 v13, s33, v13
    v_add_u32 v18, s33, v18
    v_add_u32 v19, s33, v19
    s_cmp_eq_u32 s32, 9
    s_cbranch_scc1 L_p1_nobar
    s_barrier
L_p1_nobar:
    s_waitcnt lgkmcnt(3)
    v_mfma_f32_32x32x16_bf16 v[64:79], v[152:155], v[144:147], v[64:79]
    ds_read_b128 v[128:131], v10
    ds_read_b64_tr_b16 v[136:137], v18 offset:0
    s_waitcnt lgkmcnt(4)
    v_mfma_f32_32x32x16_bf16 v[80:95], v[152:155], v[148:151], v[80:95]
    ds_read_b64_tr_b16 v[138:139], v18 offset:1024
    ds_read_b128 v[132:135], v10 offset:4096
    s_waitcnt lgkmcnt(4)
    v_mfma_f32_32x32x16_bf16 v[96:111], v[156:159], v[144:147], v[96:111]
    ds_read_b64_tr_b16 v[140:141], v19 offset:0
    ds_read_b64_tr_b16 v[142:143], v19 offset:1024
    v_mfma_f32_32x32x16_bf16 v[112:127], v[156:159], v[148:151], v[112:127]
    s_cmp_eq_u32 s32, s46
    s_cbranch_scc0 L_p1_c1
    v_mov_b32 v22, 0
    buffer_load_dwordx2 v[20:21], v22, s[84:87], 0 offen sc1
L_p1_c1:
    s_cmp_eq_u32 s32, s47
    s_cbranch_scc0 L_p1_c2
    s_waitcnt vmcnt(0)
    s_mov_b32 s48, 16384
    v_mov_b32 v22, 0
L_tok3:
    v_readfirstlane_b32 s92, v20
    v_readfirstlane_b32 s93, v21
    s_sub_u32 s48, s48, 1
    s_cbranch_scc1 L_tok3_ok
    s_cmp_lg_u32 s92, 0
    s_cbranch_scc1 L_tok3_ok
    s_sleep 1
    buffer_load_dwordx2 v[20:21], v22, s[84:87], 0 offen sc1
    s_waitcnt vmcnt(0)
    s_branch L_tok3
L_tok3_ok:
L_p1_c2:
    s_add_u32 s32, s32, 1
    s_cmp_lt_u32 s32, 10
    s_cbranch_scc1 L_p1_loop
    v_and_b32 v28, 31, v0
    v_add_u32 v29, s42, v28
    v_lshlrev_b32 v29, 3, v29
    v_add_u32 v29, 98304, v29
    v_lshrrev_b32 v32, 5, v0
    v_lshlrev_b32 v32, 4, v32
    s_lshl_b32 s14, s44, 7
    v_add_u32 v33, s14, v32
    v_add_u32 v33, 98304, v33
    v_lshlrev_b32 v35, 4, v0
    s_lshl_b32 s14, s16, 2
    s_lshl_b32 s15, s40, 1
    s_add_u32 s46, s14, s15
    s_mul_i32 s46, s46, 122880
    s_add_u32 s47, s46, 122880
    s_lshl_b32 s14, s17, 13
    s_lshl_b32 s15, s44, 11
    s_add_u32 s48, s14, s15
    s_add_u32 s49, s48, 2048
    s_add_u32 s51, s50, 34603008
    s_waitcnt lgkmcnt(0)
    s_barrier
    ds_read_b64 v[26:27], v29 offset:512
    ds_read_b64 v[36:37], v29 offset:768
    ds_read_b128 v[128:131], v33 offset:0
    ds_read_b128 v[132:135], v33 offset:32
    ds_read_b128 v[136:139], v33 offset:64
    ds_read_b128 v[140:143], v33 offset:96
    ds_read_b128 v[144:147], v33 offset:128
    ds_read_b128 v[148:151], v33 offset:160
    ds_read_b128 v[152:155], v33 offset:192
    ds_read_b128 v[156:159], v33 offset:224
    s_waitcnt lgkmcnt(4)
    v_pk_fma_f32 v[64:65], v[128:129], v[26:27], v[64:65] op_sel_hi:[1,0,1]
    v_pk_fma_f32 v[66:67], v[130:131], v[26:27], v[66:67] op_sel_hi:[1,0,1]
    v_pk_fma_f32 v[68:69], v[132:133], v[26:27], v[68:69] op_sel_hi:[1,0,1]
    v_pk_fma_f32 v[70:71], v[134:135], v[26:27], v[70:71] op_sel_hi:[1,0,1]
    v_pk_fma_f32 v[72:73], v[136:137], v[26:27], v[72:73] op_sel_hi:[1,0,1]
    v_pk_fma_f32 v[74:75], v[138:139], v[26:27], v[74:75] op_sel_hi:[1,0,1]
    v_pk_fma_f32 v[76:77], v[140:141], v[26:27], v[76:77] op_sel_hi:[1,0,1]
    v_pk_fma_f32 v[78:79], v[142:143], v[26:27], v[78:79] op_sel_hi:[1,0,1]
    v_pk_mul_f32 v[64:65], v[64:65], v[26:27] op_sel:[0,1] op_sel_hi:[1,1]
    v_pk_mul_f32 v[66:67], v[66:67], v[26:27] op_sel:[0,1] op_sel_hi:[1,1]
    v_pk_mul_f32 v[68:69], v[68:69], v[26:27] op_sel:[0,1] op_sel_hi:[1,1]
    v_pk_mul_f32 v[70:71], v[70:71], v[26:27] op_sel:[0,1] op_sel_hi:[1,1]
    v_pk_mul_f32 v[72:73], v[72:73], v[26:27] op_sel:[0,1] op_sel_hi:[1,1]
    v_pk_mul_f32 v[74:75], v[74:75], v[26:27] op_sel:[0,1] op_sel_hi:[1,1]
    v_pk_mul_f32 v[76:77], v[76:77], v[26:27] op_sel:[0,1] op_sel_hi:[1,1]
    v_pk_mul_f32 v[78:79], v[78:79], v[26:27] op_sel:[0,1] op_sel_hi:[1,1]
    v_cvt_pk_bf16_f32 v160, v64, v65
    v_cvt_pk_bf16_f32 v161, v66, v67
    v_cvt_pk_bf16_f32 v162, v68, v69
    v_cvt_pk_bf16_f32 v163, v70, v71
    v_cvt_pk_bf16_f32 v164, v72, v73
    v_cvt_pk_bf16_f32 v165, v74, v75
    v_cvt_pk_bf16_f32 v166, v76, v77
    v_cvt_pk_bf16_f32 v167, v78, v79
    s_add_u32 s14, s46, s48
    s_nop 0
    v_permlane32_swap_b32 v160, v162
    v_permlane32_swap_b32 v161, v163
    v_permlane32_swap_b32 v164, v166
    v_permlane32_swap_b32 v165, v167
    buffer_store_dwordx4 v[160:163], v35, s[88:91], s14 offen sc1
    buffer_store_dwordx4 v[164:167], v35, s[88:91], s14 offen offset:1024 sc1
    v_pk_fma_f32 v[80:81], v[128:129], v[36:37], v[80:81] op_sel_hi:[1,0,1]
    v_pk_fma_f32 v[82:83], v[130:131], v[36:37], v[82:83] op_sel_hi:[1,0,1]
    v_pk_fma_f32 v[84:85], v[132:133], v[36:37], v[84:85] op_sel_hi:[1,0,1]
    v_pk_fma_f32 v[86:87], v[134:135], v[36:37], v[86:87] op_sel_hi:[1,0,1]
    v_pk_fma_f32 v[88:89], v[136:137], v[36:37], v[88:89] op_sel_hi:[1,0,1]
    v_pk_fma_f32 v[90:91], v[138:139], v[36:37], v[90:91] op_sel_hi:[1,0,1]
    v_pk_fma_f32 v[92:93], v[140:141], v[36:37], v[92:93] op_sel_hi:[1,0,1]
    v_pk_fma_f32 v[94:95], v[142:143], v[36:37], v[94:95] op_sel_hi:[1,0,1]
    v_pk_mul_f32 v[80:81], v[80:81], v[36:37] op_sel:[0,1] op_sel_hi:[1,1]
    v_pk_mul_f32 v[82:83], v[82:83], v[36:37] op_sel:[0,1] op_sel_hi:[1,1]
    v_pk_mul_f32 v[84:85], v[84:85], v[36:37] op_sel:[0,1] op_sel_hi:[1,1]
    v_pk_mul_f32 v[86:87], v[86:87], v[36:37] op_sel:[0,1] op_sel_hi:[1,1]
    v_pk_mul_f32 v[88:89], v[88:89], v[36:37] op_sel:[0,1] op_sel_hi:[1,1]
    v_pk_mul_f32 v[90:91], v[90:91], v[36:37] op_sel:[0,1] op_sel_hi:[1,1]
    v_pk_mul_f32 v[92:93], v[92:93], v[36:37] op_sel:[0,1] op_sel_hi:[1,1]
    v_pk_mul_f32 v[94:95], v[94:95], v[36:37] op_sel:[0,1] op_sel_hi:[1,1]
    v_cvt_pk_bf16_f32 v168, v80, v81
    v_cvt_pk_bf16_f32 v169, v82, v83
    v_cvt_pk_bf16_f32 v170, v84, v85
    v_cvt_pk_bf16_f32 v171, v86, v87
    v_cvt_pk_bf16_f32 v172, v88, v89
    v_cvt_pk_bf16_f32 v173, v90, v91
    v_cvt_pk_bf16_f32 v174, v92, v93
    v_cvt_pk_bf16_f32 v175, v94, v95
    s_add_u32 s14, s47, s48
    s_nop 0
    v_permlane32_swap_b32 v168, v170
    v_permlane32_swap_b32 v169, v171
    v_permlane32_swap_b32 v172, v174
    v_permlane32_swap_b32 v173, v175
    buffer_store_dwordx4 v[168:171], v35, s[88:91], s14 offen sc1
    buffer_store_dwordx4 v[172:175], v35, s[88:91], s14 offen offset:1024 sc1
    s_waitcnt lgkmcnt(0)
    v_pk_fma_f32 v[96:97], v[144:145], v[26:27], v[96:97] op_sel_hi:[1,0,1]
    v_pk_fma_f32 v[98:99], v[146:147], v[26:27], v[98:99] op_sel_hi:[1,0,1]
    v_pk_fma_f32 v[100:101], v[148:149], v[26:27], v[100:101] op_sel_hi:[1,0,1]
    v_pk_fma_f32 v[102:103], v[150:151], v[26:27], v[102:103] op_sel_hi:[1,0,1]
    v_pk_fma_f32 v[104:105], v[152:153], v[26:27], v[104:105] op_sel_hi:[1,0,1]
    v_pk_fma_f32 v[106:107], v[154:155], v[26:27], v[106:107] op_sel_hi:[1,0,1]
    v_pk_fma_f32 v[108:109], v[156:157], v[26:27], v[108:109] op_sel_hi:[1,0,1]
    v_pk_fma_f32 v[110:111], v[158:159], v[26:27], v[110:111] op_sel_hi:[1,0,1]
    v_pk_mul_f32 v[96:97], v[96:97], v[26:27] op_sel:[0,1] op_sel_hi:[1,1]
    v_pk_mul_f32 v[98:99], v[98:99], v[26:27] op_sel:[0,1] op_sel_hi:[1,1]
    v_pk_mul_f32 v[100:101], v[100:101], v[26:27] op_sel:[0,1] op_sel_hi:[1,1]
    v_pk_mul_f32 v[102:103], v[102:103], v[26:27] op_sel:[0,1] op_sel_hi:[1,1]
    v_pk_mul_f32 v[104:105], v[104:105], v[26:27] op_sel:[0,1] op_sel_hi:[1,1]
    v_pk_mul_f32 v[106:107], v[106:107], v[26:27] op_sel:[0,1] op_sel_hi:[1,1]
    v_pk_mul_f32 v[108:109], v[108:109], v[26:27] op_sel:[0,1] op_sel_hi:[1,1]
    v_pk_mul_f32 v[110:111], v[110:111], v[26:27] op_sel:[0,1] op_sel_hi:[1,1]
    v_cvt_pk_bf16_f32 v160, v96, v97
    v_cvt_pk_bf16_f32 v161, v98, v99
    v_cvt_pk_bf16_f32 v162, v100, v101
    v_cvt_pk_bf16_f32 v163, v102, v103
    v_cvt_pk_bf16_f32 v164, v104, v105
    v_cvt_pk_bf16_f32 v165, v106, v107
    v_cvt_pk_bf16_f32 v166, v108, v109
    v_cvt_pk_bf16_f32 v167, v110, v111
    s_add_u32 s14, s46, s49
    s_nop 0
    v_permlane32_swap_b32 v160, v162
    v_permlane32_swap_b32 v161, v163
    v_permlane32_swap_b32 v164, v166
    v_permlane32_swap_b32 v165, v167
    buffer_store_dwordx4 v[160:163], v35, s[88:91], s14 offen sc1
    buffer_store_dwordx4 v[164:167], v35, s[88:91], s14 offen offset:1024 sc1
    v_pk_fma_f32 v[112:113], v[144:145], v[36:37], v[112:113] op_sel_hi:[1,0,1]
    v_pk_fma_f32 v[114:115], v[146:147], v[36:37], v[114:115] op_sel_hi:[1,0,1]
    v_pk_fma_f32 v[116:117], v[148:149], v[36:37], v[116:117] op_sel_hi:[1,0,1]
    v_pk_fma_f32 v[118:119], v[150:151], v[36:37], v[118:119] op_sel_hi:[1,0,1]
    v_pk_fma_f32 v[120:121], v[152:153], v[36:37], v[120:121] op_sel_hi:[1,0,1]
    v_pk_fma_f32 v[122:123], v[154:155], v[36:37], v[122:123] op_sel_hi:[1,0,1]
    v_pk_fma_f32 v[124:125], v[156:157], v[36:37], v[124:125] op_sel_hi:[1,0,1]
    v_pk_fma_f32 v[126:127], v[158:159], v[36:37], v[126:127] op_sel_hi:[1,0,1]
    v_pk_mul_f32 v[112:113], v[112:113], v[36:37] op_sel:[0,1] op_sel_hi:[1,1]
    v_pk_mul_f32 v[114:115], v[114:115], v[36:37] op_sel:[0,1] op_sel_hi:[1,1]
    v_pk_mul_f32 v[116:117], v[116:117], v[36:37] op_sel:[0,1] op_sel_hi:[1,1]
    v_pk_mul_f32 v[118:119], v[118:119], v[36:37] op_sel:[0,1] op_sel_hi:[1,1]
    v_pk_mul_f32 v[120:121], v[120:121], v[36:37] op_sel:[0,1] op_sel_hi:[1,1]
    v_pk_mul_f32 v[122:123], v[122:123], v[36:37] op_sel:[0,1] op_sel_hi:[1,1]
    v_pk_mul_f32 v[124:125], v[124:125], v[36:37] op_sel:[0,1] op_sel_hi:[1,1]
    v_pk_mul_f32 v[126:127], v[126:127], v[36:37] op_sel:[0,1] op_sel_hi:[1,1]
    v_cvt_pk_bf16_f32 v168, v112, v113
    v_cvt_pk_bf16_f32 v169, v114, v115
    v_cvt_pk_bf16_f32 v170, v116, v117
    v_cvt_pk_bf16_f32 v171, v118, v119
    v_cvt_pk_bf16_f32 v172, v120, v121
    v_cvt_pk_bf16_f32 v173, v122, v123
    v_cvt_pk_bf16_f32 v174, v124, v125
    v_cvt_pk_bf16_f32 v175, v126, v127
    s_add_u32 s14, s47, s49
    s_nop 0
    v_permlane32_swap_b32 v168, v170
    v_permlane32_swap_b32 v169, v171
    v_permlane32_swap_b32 v172, v174
    v_permlane32_swap_b32 v173, v175
    buffer_store_dwordx4 v[168:171], v35, s[88:91], s14 offen sc1
    buffer_store_dwordx4 v[172:175], v35, s[88:91], s14 offen offset:1024 sc1
    s_waitcnt vmcnt(0)
    s_branch L_p1_pub
L_p1_aux:
    s_sub_u32 s19, s94, 4
    s_cmp_lt_u32 s94, 4
    s_cbranch_scc1 L_p1_aux2
    s_lshl_b32 s80, s19, 12
    s_add_u32 s80, s80, 65536
    s_mul_i32 s81, s16, 3
    s_add_u32 s81, s81, s19
    s_add_u32 s81, s81, 1791
    s_cmp_eq_u32 s19, 0
    s_cselect_b32 s81, s2, s81
    s_mov_b32 s27, 0x00020000
    s_mov_b32 s31, 0x00020000
    s_cmp_lt_u32 s81, 200
    s_cbranch_scc1 L_pkc_c
    s_cmp_ge_u32 s81, 1280
    s_cbranch_scc1 L_pkc_b
    s_sub_u32 s38, s81, 200
    s_mul_i32 s75, s38, 2428
    s_lshr_b32 s75, s75, 16
    s_mul_i32 s76, s75, 27
    s_sub_u32 s76, s38, s76
    s_mov_b32 s24, s68
    s_mov_b32 s25, s69
    s_mov_b32 s26, 2211840
    s_mov_b32 s28, s70
    s_mov_b32 s29, s71
    s_mov_b32 s30, 2211840
    s_mul_i32 s32, s75, 55296
    s_lshl_b32 s36, s76, 7
    s_add_u32 s32, s32, s36
    s_add_u32 s33, s32, 13824
    s_mov_b32 s34, s32
    s_mov_b32 s35, s33
    s_mov_b32 s36, 3456
    s_mov_b32 s37, 4
    s_mov_b32 s79, 1
    s_mov_b32 s78, 40960
    s_mov_b32 s77, 25165824
    s_branch L_pkc_go
    L_pkc_b:
    s_sub_u32 s38, s81, 1280
    s_mul_i32 s75, s38, 6554
    s_lshr_b32 s75, s75, 16
    s_mul_i32 s76, s75, 10
    s_sub_u32 s76, s38, s76
    s_mov_b32 s24, s72
    s_mov_b32 s25, s73
    s_cmp_lt_u32 s38, 540
    s_cselect_b32 s26, 2211840, 0
    s_cselect_b32 s77, 30408704, 1073741824
    s_mul_i32 s32, s75, 7
    s_sub_u32 s33, s32, 110
    s_cmp_ge_u32 s75, 16
    s_cselect_b32 s34, s33, s32
    s_sub_u32 s33, s32, 213
    s_cmp_ge_u32 s75, 31
    s_cselect_b32 s34, s33, s34
    s_add_u32 s35, s34, 1
    s_lshl_b32 s33, s32, 1
    s_sub_u32 s33, s33, 638
    s_add_u32 s36, s33, 7
    s_min_u32 s36, s36, 107
    s_cmp_ge_u32 s75, 46
    s_cselect_b32 s34, s33, s34
    s_cselect_b32 s35, s36, s35
    s_mul_i32 s32, s34, 20480
    s_add_u32 s33, s32, 10240
    s_mul_i32 s34, s35, 20480
    s_add_u32 s35, s34, 10240
    s_mov_b32 s78, 55296
    s_branch L_pkc_d
    L_pkc_c:
    s_mul_i32 s75, s81, 6554
    s_lshr_b32 s75, s75, 16
    s_mul_i32 s76, s75, 10
    s_sub_u32 s76, s81, s76
    s_mov_b32 s24, s66
    s_mov_b32 s25, s67
    s_mov_b32 s26, 819200
    s_mov_b32 s77, 33030144
    s_mul_i32 s36, s75, 52
    s_lshr_b32 s36, s36, 8
    s_mul_i32 s37, s36, 5
    s_sub_u32 s37, s75, s37
    s_mul_i32 s38, s36, 204800
    s_mul_i32 s39, s37, 51200
    s_add_u32 s32, s38, s39
    s_add_u32 s33, s32, 10240
    s_add_u32 s34, s32, 30720
    s_add_u32 s35, s32, 40960
    s_cmp_lt_u32 s37, 4
    s_cbranch_scc1 L_pkc_e
    s_add_u32 s32, s38, 20480
    s_add_u32 s33, s32, 102400
    s_add_u32 s34, s32, 51200
    s_add_u32 s35, s32, 153600
    L_pkc_e:
    s_mov_b32 s78, 20480
    L_pkc_d:
    s_mov_b32 s28, s24
    s_mov_b32 s29, s25
    s_mov_b32 s30, s26
    s_lshl_b32 s36, s76, 7
    s_add_u32 s32, s32, s36
    s_add_u32 s33, s33, s36
    s_add_u32 s34, s34, s36
    s_add_u32 s35, s35, s36
    s_mov_b32 s36, 1280
    s_mov_b32 s37, 0
    s_mov_b32 s79, 0
    L_pkc_go:
    v_lshrrev_b32 v28, 3, v0
    v_lshrrev_b32 v29, 5, v0
    v_mul_u32_u24 v30, s37, v29
    v_add_u32 v28, v28, v30
    v_mul_u32_u24 v28, s36, v28
    v_and_b32 v30, 7, v0
    v_lshl_add_u32 v28, v30, 4, v28
    s_mov_b32 m0, s80
    s_lshl_b32 s76, s76, 2
    buffer_load_dwordx4 v28, s[24:27], s32 offen lds
    s_add_u32 m0, s80, 1024
    s_mul_i32 s76, s76, s78
    buffer_load_dwordx4 v28, s[24:27], s33 offen lds
    s_add_u32 m0, s80, 2048
    s_lshl_b32 s75, s75, 10
    buffer_load_dwordx4 v28, s[28:31], s34 offen lds
    s_add_u32 m0, s80, 3072
    s_add_u32 s77, s77, s76
    buffer_load_dwordx4 v28, s[28:31], s35 offen lds
    s_add_u32 s77, s77, s75
L_p1_aux2:
    v_mov_b32 v22, 0
    buffer_load_dwordx2 v[20:21], v22, s[84:87], 0 offen sc1
    s_waitcnt vmcnt(0)
    s_mov_b32 s48, 16384
    v_mov_b32 v22, 0
L_tok4:
    v_readfirstlane_b32 s92, v20
    v_readfirstlane_b32 s93, v21
    s_sub_u32 s48, s48, 1
    s_cbranch_scc1 L_tok4_ok
    s_cmp_lg_u32 s92, 0
    s_cbranch_scc1 L_tok4_ok
    s_sleep 1
    buffer_load_dwordx2 v[20:21], v22, s[84:87], 0 offen sc1
    s_waitcnt vmcnt(0)
    s_branch L_tok4
L_tok4_ok:
    s_cmp_lt_u32 s94, 5
    s_cbranch_scc1 L_p1_aux3
    s_lshl_b32 s39, s79, 1
    s_lshl_b32 s38, 512, s39
    s_lshr_b32 s39, 2048, s39
    v_lshrrev_b32 v29, 5, v0
    v_mul_u32_u24 v26, s39, v29
    v_bfe_u32 v30, v0, 4, 1
    v_mul_u32_u24 v30, s38, v30
    v_add3_u32 v26, v26, v30, s80
    v_bfe_u32 v30, v0, 2, 2
    v_lshl_add_u32 v26, v30, 7, v26
    v_and_b32 v30, 3, v0
    v_lshl_add_u32 v26, v30, 3, v26
    v_lshlrev_b32 v27, 4, v0
    ds_read_b64_tr_b16 v[48:49], v26 offset:0
    ds_read_b64_tr_b16 v[50:51], v26 offset:1024
    ds_read_b64_tr_b16 v[52:53], v26 offset:32
    ds_read_b64_tr_b16 v[54:55], v26 offset:1056
    ds_read_b64_tr_b16 v[56:57], v26 offset:64
    ds_read_b64_tr_b16 v[58:59], v26 offset:1088
    ds_read_b64_tr_b16 v[60:61], v26 offset:96
    ds_read_b64_tr_b16 v[62:63], v26 offset:1120
    s_sub_u32 s38, s77, 25165824
    s_lshr_b32 s38, s38, 3
    s_add_u32 s38, s38, 35651584
    s_cmp_eq_u32 s79, 1
    s_cselect_b32 s38, s38, 1073741824
    s_mov_b32 s39, 0xffff0000
    v_lshlrev_b32 v28, 2, v0
    s_waitcnt lgkmcnt(6)
    buffer_store_dwordx4 v[48:51], v27, s[88:91], s77 offen sc1
    s_add_u32 s77, s77, s78
    s_waitcnt lgkmcnt(4)
    buffer_store_dwordx4 v[52:55], v27, s[88:91], s77 offen sc1
    s_add_u32 s77, s77, s78
    s_waitcnt lgkmcnt(2)
    buffer_store_dwordx4 v[56:59], v27, s[88:91], s77 offen sc1
    s_add_u32 s77, s77, s78
    s_waitcnt lgkmcnt(0)
    buffer_store_dwordx4 v[60:63], v27, s[88:91], s77 offen sc1
    s_add_u32 s77, s77, s78
    v_lshlrev_b32 v36, 16, v48
    v_and_b32 v37, s39, v48
    v_lshlrev_b32 v29, 16, v49
    v_and_b32 v30, s39, v49
    v_add_f32 v36, v36, v29
    v_add_f32 v37, v37, v30
    v_lshlrev_b32 v29, 16, v50
    v_and_b32 v30, s39, v50
    v_add_f32 v36, v36, v29
    v_add_f32 v37, v37, v30
    v_lshlrev_b32 v29, 16, v51
    v_and_b32 v30, s39, v51
    v_add_f32 v36, v36, v29
    v_add_f32 v37, v37, v30
    v_add_f32 v36, v36, v37
    v_mov_b32 v37, v36
    s_nop 1
    v_permlane32_swap_b32 v36, v37
    s_nop 1
    v_add_f32 v36, v36, v37
    s_mov_b32 exec_hi, 0
    buffer_store_dword v36, v28, s[88:91], s38 offen sc1
    s_mov_b32 exec_hi, -1
    s_add_u32 s38, s38, 5120
    v_lshlrev_b32 v38, 16, v52
    v_and_b32 v39, s39, v52
    v_lshlrev_b32 v29, 16, v53
    v_and_b32 v30, s39, v53
    v_add_f32 v38, v38, v29
    v_add_f32 v39, v39, v30
    v_lshlrev_b32 v29, 16, v54
    v_and_b32 v30, s39, v54
    v_add_f32 v38, v38, v29
    v_add_f32 v39, v39, v30
    v_lshlrev_b32 v29, 16, v55
    v_and_b32 v30, s39, v55
    v_add_f32 v38, v38, v29
    v_add_f32 v39, v39, v30
    v_add_f32 v38, v38, v39
    v_mov_b32 v39, v38
    s_nop 1
    v_permlane32_swap_b32 v38, v39
    s_nop 1
    v_add_f32 v38, v38, v39
    s_mov_b32 exec_hi, 0
    buffer_store_dword v38, v28, s[88:91], s38 offen sc1
    s_mov_b32 exec_hi, -1
    s_add_u32 s38, s38, 5120
    v_lshlrev_b32 v36, 16, v56
    v_and_b32 v37, s39, v56
    v_lshlrev_b32 v29, 16, v57
    v_and_b32 v30, s39, v57
    v_add_f32 v36, v36, v29
    v_add_f32 v37, v37, v30
    v_lshlrev_b32 v29, 16, v58
    v_and_b32 v30, s39, v58
    v_add_f32 v36, v36, v29
    v_add_f32 v37, v37, v30
    v_lshlrev_b32 v29, 16, v59
    v_and_b32 v30, s39, v59
    v_add_f32 v36, v36, v29
    v_add_f32 v37, v37, v30
    v_add_f32 v36, v36, v37
    v_mov_b32 v37, v36
    s_nop 1
    v_permlane32_swap_b32 v36, v37
    s_nop 1
    v_add_f32 v36, v36, v37
    s_mov_b32 exec_hi, 0
    buffer_store_dword v36, v28, s[88:91], s38 offen sc1
    s_mov_b32 exec_hi, -1
    s_add_u32 s38, s38, 5120
    v_lshlrev_b32 v38, 16, v60
    v_and_b32 v39, s39, v60
    v_lshlrev_b32 v29, 16, v61
    v_and_b32 v30, s39, v61
    v_add_f32 v38, v38, v29
    v_add_f32 v39, v39, v30
    v_lshlrev_b32 v29, 16, v62
    v_and_b32 v30, s39, v62
    v_add_f32 v38, v38, v29
    v_add_f32 v39, v39, v30
    v_lshlrev_b32 v29, 16, v63
    v_and_b32 v30, s39, v63
    v_add_f32 v38, v38, v29
    v_add_f32 v39, v39, v30
    v_add_f32 v38, v38, v39
    v_mov_b32 v39, v38
    s_nop 1
    v_permlane32_swap_b32 v38, v39
    s_nop 1
    v_add_f32 v38, v38, v39
    s_mov_b32 exec_hi, 0
    buffer_store_dword v38, v28, s[88:91], s38 offen sc1
    s_mov_b32 exec_hi, -1
    s_add_u32 s38, s38, 5120
L_p1_aux3:
    s_barrier
    s_branch L_p1_end
L_p1_pub:
    s_barrier
    s_cmp_lg_u32 s94, 0
    s_cbranch_scc1 L_p1_end
    v_mov_b32 v2, s92
    v_mov_b32 v3, s93
    v_mbcnt_lo_u32_b32 v4, -1, 0
    v_mul_u32_u24 v4, 69888, v4
    s_mov_b64 exec, 255
    buffer_store_dwordx2 v[2:3], v4, s[88:91], s51 offen sc1
    s_mov_b64 exec, -1
L_p1_end:
    s_and_b32 s4, s2, 7
    s_lshl_b32 s4, s4, 2
    s_bfe_u32 s5, s2, 0x20003
    s_add_u32 s4, s4, s5
    s_lshr_b32 s5, s2, 5
    s_lshr_b32 s6, s4, 1
    s_and_b32 s7, s4, 1
    s_mov_b32 s8, s94
    s_mul_i32 s9, s7, 1536
    v_mov_b32 v78, 0x1e000
    v_add_u32 v72, 0, v0
    v_cmp_le_u32 vcc, 96, v72
    v_subrev_u32 v73, 96, v72
    s_nop 0
    v_cndmask_b32 v72, v72, v73, vcc
    v_cndmask_b32 v74, 0, v78, vcc
    v_mul_u32_u24 v73, 43, v72
    v_lshrrev_b32 v73, 9, v73
    v_mul_u32_u24 v75, 12, v73
    v_sub_u32 v75, v72, v75
    v_lshrrev_b32 v76, 2, v75
    v_and_b32 v75, 3, v75
    v_lshl_add_u32 v75, v73, 2, v75
    v_lshl_add_u32 v74, v75, 4, v74
    v_cmp_eq_u32 vcc, 2, v76
    v_lshlrev_b32 v76, 9, v76
    v_add_u32 v77, s9, v76
    v_cndmask_b32 v76, v77, v76, vcc
    v_add_u32 v5, v74, v76
    v_add_u32 v72, 64, v0
    v_cmp_le_u32 vcc, 96, v72
    v_subrev_u32 v73, 96, v72
    s_nop 0
    v_cndmask_b32 v72, v72, v73, vcc
    v_cndmask_b32 v74, 0, v78, vcc
    v_mul_u32_u24 v73, 43, v72
    v_lshrrev_b32 v73, 9, v73
    v_mul_u32_u24 v75, 12, v73
    v_sub_u32 v75, v72, v75
    v_lshrrev_b32 v76, 2, v75
    v_and_b32 v75, 3, v75
    v_lshl_add_u32 v75, v73, 2, v75
    v_lshl_add_u32 v74, v75, 4, v74
    v_cmp_eq_u32 vcc, 2, v76
    v_lshlrev_b32 v76, 9, v76
    v_add_u32 v77, s9, v76
    v_cndmask_b32 v76, v77, v76, vcc
    v_add_u32 v6, v74, v76
    v_add_u32 v72, 128, v0
    v_cmp_le_u32 vcc, 96, v72
    v_subrev_u32 v73, 96, v72
    s_nop 0
    v_cndmask_b32 v72, v72, v73, vcc
    v_cndmask_b32 v74, 0, v78, vcc
    v_mul_u32_u24 v73, 43, v72
    v_lshrrev_b32 v73, 9, v73
    v_mul_u32_u24 v75, 12, v73
    v_sub_u32 v75, v72, v75
    v_lshrrev_b32 v76, 2, v75
    v_and_b32 v75, 3, v75
    v_lshl_add_u32 v75, v73, 2, v75
    v_lshl_add_u32 v74, v75, 4, v74
    v_cmp_eq_u32 vcc, 2, v76
    v_lshlrev_b32 v76, 9, v76
    v_add_u32 v77, s9, v76
    v_cndmask_b32 v76, v77, v76, vcc
    v_add_u32 v7, v74, v76
    s_lshl_b32 s10, s5, 3
    s_lshl_b32 s11, s8, 1
    s_add_u32 s14, s10, s11
    s_sub_u32 s15, s14, 8
    s_cmp_lt_u32 s14, 8
    s_cselect_b32 s14, s14, s15
    s_mul_i32 s14, s14, 122880
    s_mul_i32 s15, s6, 2560
    s_add_u32 s14, s14, s15
    s_add_u32 s16, s14, 40960
    s_add_u32 s17, s14, 81920
    s_mul_i32 s18, s8, 3072
    s_add_u32 s19, s10, s8
    s_mul_i32 s28, s19, 122880
    s_add_u32 s28, s28, s15
    s_add_u32 s29, s28, s9
    s_lshl_b32 s30, s7, 3
    s_add_u32 s28, s28, s30
    s_add_u32 s28, s28, 1024
    v_lshlrev_b32 v72, 4, v0
    v_cmp_gt_u32 vcc, 32, v0
    v_mov_b32 v95, 1073741824
    v_mov_b32 v76, 0x3F803F80
    v_mov_b32 v94, v72
    v_cndmask_b32 v95, v95, v72, vcc
    s_mov_b32 s20, s28
    s_mov_b32 s21, s29
    s_cmp_ge_u32 s8, 4
    s_cbranch_scc1 L_p2_notok
    v_mov_b32 v92, 0
    buffer_load_dwordx2 v[90:91], v92, s[84:87], 0 offen sc1
L_p2_notok:
    s_cmp_ge_u32 s8, 4
    s_cbranch_scc1 L_p2_nopk
    s_lshl_b32 s81, s2, 2
    s_add_u32 s81, s81, s8
    s_add_u32 s81, s81, 256
    s_lshl_b32 s80, s8, 12
    s_add_u32 s80, s80, 147456
    s_mov_b32 s27, 0x00020000
    s_mov_b32 s31, 0x00020000
    s_cmp_lt_u32 s81, 200
    s_cbranch_scc1 L_pk2_c
    s_cmp_ge_u32 s81, 1280
    s_cbranch_scc1 L_pk2_b
    s_sub_u32 s38, s81, 200
    s_mul_i32 s75, s38, 2428
    s_lshr_b32 s75, s75, 16
    s_mul_i32 s76, s75, 27
    s_sub_u32 s76, s38, s76
    s_mov_b32 s24, s68
    s_mov_b32 s25, s69
    s_mov_b32 s26, 2211840
    s_mov_b32 s28, s70
    s_mov_b32 s29, s71
    s_mov_b32 s30, 2211840
    s_mul_i32 s32, s75, 55296
    s_lshl_b32 s36, s76, 7
    s_add_u32 s32, s32, s36
    s_add_u32 s33, s32, 13824
    s_mov_b32 s34, s32
    s_mov_b32 s35, s33
    s_mov_b32 s36, 3456
    s_mov_b32 s37, 4
    s_mov_b32 s79, 1
    s_mov_b32 s78, 40960
    s_mov_b32 s77, 25165824
    s_branch L_pk2_go
    L_pk2_b:
    s_sub_u32 s38, s81, 1280
    s_mul_i32 s75, s38, 6554
    s_lshr_b32 s75, s75, 16
    s_mul_i32 s76, s75, 10
    s_sub_u32 s76, s38, s76
    s_mov_b32 s24, s72
    s_mov_b32 s25, s73
    s_cmp_lt_u32 s38, 540
    s_cselect_b32 s26, 2211840, 0
    s_cselect_b32 s77, 30408704, 1073741824
    s_mul_i32 s32, s75, 7
    s_sub_u32 s33, s32, 110
    s_cmp_ge_u32 s75, 16
    s_cselect_b32 s34, s33, s32
    s_sub_u32 s33, s32, 213
    s_cmp_ge_u32 s75, 31
    s_cselect_b32 s34, s33, s34
    s_add_u32 s35, s34, 1
    s_lshl_b32 s33, s32, 1
    s_sub_u32 s33, s33, 638
    s_add_u32 s36, s33, 7
    s_min_u32 s36, s36, 107
    s_cmp_ge_u32 s75, 46
    s_cselect_b32 s34, s33, s34
    s_cselect_b32 s35, s36, s35
    s_mul_i32 s32, s34, 20480
    s_add_u32 s33, s32, 10240
    s_mul_i32 s34, s35, 20480
    s_add_u32 s35, s34, 10240
    s_mov_b32 s78, 55296
    s_branch L_pk2_d
    L_pk2_c:
    s_mul_i32 s75, s81, 6554
    s_lshr_b32 s75, s75, 16
    s_mul_i32 s76, s75, 10
    s_sub_u32 s76, s81, s76
    s_mov_b32 s24, s66
    s_mov_b32 s25, s67
    s_mov_b32 s26, 819200
    s_mov_b32 s77, 33030144
    s_mul_i32 s36, s75, 52
    s_lshr_b32 s36, s36, 8
    s_mul_i32 s37, s36, 5
    s_sub_u32 s37, s75, s37
    s_mul_i32 s38, s36, 204800
    s_mul_i32 s39, s37, 51200
    s_add_u32 s32, s38, s39
    s_add_u32 s33, s32, 10240
    s_add_u32 s34, s32, 30720
    s_add_u32 s35, s32, 40960
    s_cmp_lt_u32 s37, 4
    s_cbranch_scc1 L_pk2_e
    s_add_u32 s32, s38, 20480
    s_add_u32 s33, s32, 102400
    s_add_u32 s34, s32, 51200
    s_add_u32 s35, s32, 153600
    L_pk2_e:
    s_mov_b32 s78, 20480
    L_pk2_d:
    s_mov_b32 s28, s24
    s_mov_b32 s29, s25
    s_mov_b32 s30, s26
    s_lshl_b32 s36, s76, 7
    s_add_u32 s32, s32, s36
    s_add_u32 s33, s33, s36
    s_add_u32 s34, s34, s36
    s_add_u32 s35, s35, s36
    s_mov_b32 s36, 1280
    s_mov_b32 s37, 0
    s_mov_b32 s79, 0
    L_pk2_go:
    v_lshrrev_b32 v86, 3, v0
    v_lshrrev_b32 v87, 5, v0
    v_mul_u32_u24 v88, s37, v87
    v_add_u32 v86, v86, v88
    v_mul_u32_u24 v86, s36, v86
    v_and_b32 v88, 7, v0
    v_lshl_add_u32 v86, v88, 4, v86
    s_mov_b32 m0, s80
    s_lshl_b32 s76, s76, 2
    buffer_load_dwordx4 v86, s[24:27], s32 offen lds
    s_add_u32 m0, s80, 1024
    s_mul_i32 s76, s76, s78
    buffer_load_dwordx4 v86, s[24:27], s33 offen lds
    s_add_u32 m0, s80, 2048
    s_lshl_b32 s75, s75, 10
    buffer_load_dwordx4 v86, s[28:31], s34 offen lds
    s_add_u32 m0, s80, 3072
    s_add_u32 s77, s77, s76
    buffer_load_dwordx4 v86, s[28:31], s35 offen lds
    s_add_u32 s77, s77, s75
L_p2_nopk:
    v_mov_b32 v77, 0x3F803F80
    v_mov_b32 v78, 0x3F803F80
    v_mov_b32 v79, 0x3F803F80
    s_lshl_b32 s30, s8, 11
    v_add_u32 v73, s30, v72
    ds_write_b128 v73, v[76:79] offset:49152
    ds_write_b128 v73, v[76:79] offset:50176
    v_mov_b32 v74, 0x3F80
    v_cmp_gt_u32 vcc, 32, v0
    v_mov_b32 v15, 0
    s_nop 0
    v_cndmask_b32 v14, 0, v74, vcc
    v_mov_b32 v23, 0
    v_mov_b32 v31, 0
    v_mov_b32 v39, 0
    v_and_b32 v72, 31, v0
    v_lshrrev_b32 v73, 5, v0
    v_lshrrev_b32 v74, 2, v72
    v_mul_u32_u24 v74, 192, v74
    v_and_b32 v75, 3, v0
    v_lshl_add_u32 v74, v75, 4, v74
    s_mul_i32 s30, s8, 1536
    v_add_u32 v74, s30, v74
    v_lshl_add_u32 v2, v73, 6, v74
    s_lshl_b32 s31, s7, 3
    s_add_u32 s31, s31, 128
    v_add_u32 v3, s31, v74
    v_bfe_u32 v76, v0, 2, 2
    v_mul_u32_u24 v77, 192, v73
    v_lshl_add_u32 v77, v76, 4, v77
    s_add_u32 s30, s30, 24576
    v_add_u32 v77, s30, v77
    v_lshrrev_b32 v78, 1, v75
    v_lshlrev_b32 v78, 6, v78
    v_and_b32 v79, 1, v75
    v_lshl_add_u32 v78, v79, 3, v78
    v_add_u32 v78, v77, v78
    v_add_u32 v79, s31, v77
    v_mov_b32 v80, 49152
    v_cmp_eq_u32 vcc, 0, v75
    v_bfe_u32 v81, v0, 4, 1
    s_nop 0
    v_cndmask_b32 v79, v80, v79, vcc
    v_cmp_eq_u32 vcc, 0, v81
    v_lshlrev_b32 v82, 2, v73
    v_sub_u32 v82, v72, v82
    v_cndmask_b32 v4, v79, v78, vcc
    v_cmp_gt_i32 s[32:33], 0, v82
    v_cmp_gt_i32 s[34:35], 1, v82
    v_cmp_gt_i32 s[36:37], 2, v82
    v_cmp_gt_i32 s[38:39], 3, v82
    v_cmp_gt_i32 s[40:41], 8, v82
    v_cmp_gt_i32 s[42:43], 9, v82
    v_cmp_gt_i32 s[44:45], 10, v82
    v_cmp_gt_i32 s[46:47], 11, v82
    v_cmp_gt_i32 s[48:49], 16, v82
    v_cmp_gt_i32 s[50:51], 17, v82
    v_cmp_gt_i32 s[52:53], 18, v82
    v_cmp_gt_i32 s[54:55], 19, v82
    v_cmp_gt_i32 s[56:57], 24, v82
    v_cmp_gt_i32 s[58:59], 25, v82
    v_cmp_gt_i32 s[60:61], 26, v82
    v_cmp_gt_i32 s[62:63], 27, v82
    v_mov_b32 v72, 0xffff
    v_mov_b32 v73, 0xffff0000
    v_cndmask_b32 v56, 0, v72, s[32:33]
    v_cndmask_b32 v74, 0, v73, s[34:35]
    v_or_b32 v56, v56, v74
    v_cndmask_b32 v57, 0, v72, s[36:37]
    v_cndmask_b32 v74, 0, v73, s[38:39]
    v_or_b32 v57, v57, v74
    v_cndmask_b32 v58, 0, v72, s[40:41]
    v_cndmask_b32 v74, 0, v73, s[42:43]
    v_or_b32 v58, v58, v74
    v_cndmask_b32 v59, 0, v72, s[44:45]
    v_cndmask_b32 v74, 0, v73, s[46:47]
    v_or_b32 v59, v59, v74
    v_cndmask_b32 v60, 0, v72, s[48:49]
    v_cndmask_b32 v74, 0, v73, s[50:51]
    v_or_b32 v60, v60, v74
    v_cndmask_b32 v61, 0, v72, s[52:53]
    v_cndmask_b32 v74, 0, v73, s[54:55]
    v_or_b32 v61, v61, v74
    v_cndmask_b32 v62, 0, v72, s[56:57]
    v_cndmask_b32 v74, 0, v73, s[58:59]
    v_or_b32 v62, v62, v74
    v_cndmask_b32 v63, 0, v72, s[60:61]
    v_cndmask_b32 v74, 0, v73, s[62:63]
    v_or_b32 v63, v63, v74
    s_mov_b32 s64, 0x3ea52b5c
    s_lshl_b32 s65, s2, 3
    s_add_u32 s65, s65, 34607104
    s_lshr_b32 s24, s2, 3
    s_xor_b32 s25, s94, 6
    s_or_b32 s24, s24, s25
    s_cmp_lg_u32 s24, 0
    s_cbranch_scc1 L_cpe2
    s_getpc_b64 s[24:25]
    L_cp2:
    s_add_u32 s24, s24, L_p2_end-L_cp2
    s_addc_u32 s25, s25, 0
    v_lshlrev_b32 v84, 7, v0
    v_min_u32 v86, L_p4_end-L_p2_end, v84
    global_load_dword v85, v86, s[24:25]
    v_add_u32 v84, 8192, v84
    v_min_u32 v86, L_p4_end-L_p2_end, v84
    global_load_dword v85, v86, s[24:25]
    v_add_u32 v84, 8192, v84
    v_min_u32 v86, L_p4_end-L_p2_end, v84
    global_load_dword v85, v86, s[24:25]
    v_add_u32 v84, 8192, v84
L_cpe2:
    s_cmp_lg_u32 s8, 7
    s_cbranch_scc1 L_p2_nopoll
    v_and_b32 v84, 15, v0
    v_min_u32 v84, 14, v84
    v_lshrrev_b32 v85, 4, v0
    s_lshl_b32 s10, s5, 1
    v_add_u32 v85, s10, v85
    v_subrev_u32 v85, 2, v85
    v_max_i32 v85, 0, v85
    v_lshlrev_b32 v85, 7, v85
    v_lshl_add_u32 v84, v84, 3, v85
    s_mov_b32 s10, 34603008
    s_mov_b32 s11, 16384
    buffer_load_dwordx2 v[86:87], v84, s[96:99], s10 offen sc1
    s_sleep 2
L_poll5:
    buffer_load_dwordx2 v[88:89], v84, s[96:99], s10 offen sc1
    s_waitcnt vmcnt(1)
    v_cmp_ne_u64 vcc, s[92:93], v[86:87]
    s_sub_u32 s11, s11, 1
    s_cbranch_scc1 L_poll5_ok
    s_cmp_eq_u64 vcc, 0
    s_cbranch_scc1 L_poll5_ok
    s_sleep 0
    buffer_load_dwordx2 v[86:87], v84, s[96:99], s10 offen sc1
    s_waitcnt vmcnt(1)
    v_cmp_ne_u64 vcc, s[92:93], v[88:89]
    s_sub_u32 s11, s11, 1
    s_cbranch_scc1 L_poll5_ok
    s_cmp_eq_u64 vcc, 0
    s_cbranch_scc1 L_poll5_ok
    s_sleep 0
    s_branch L_poll5
L_poll5_ok:
L_p2_nopoll:
    s_barrier
    s_add_u32 m0, s18, 0
    s_nop 0
    buffer_load_dwordx4 v5, s[88:91], s16 offen sc1 lds
    s_add_u32 m0, s18, 1024
    s_nop 0
    buffer_load_dwordx4 v6, s[88:91], s16 offen sc1 lds
    s_add_u32 m0, s18, 2048
    s_nop 0
    buffer_load_dwordx4 v7, s[88:91], s16 offen sc1 lds
    buffer_load_dwordx4 v[8:11], v94, s[88:91], s21 offen sc1
    buffer_load_dwordx2 v[12:13], v95, s[88:91], s20 offen sc1
    s_add_u32 m0, s18, 24576
    s_nop 0
    buffer_load_dwordx4 v5, s[88:91], s17 offen sc1 lds
    s_add_u32 m0, s18, 25600
    s_nop 0
    buffer_load_dwordx4 v6, s[88:91], s17 offen sc1 lds
    s_add_u32 m0, s18, 26624
    s_nop 0
    buffer_load_dwordx4 v7, s[88:91], s17 offen sc1 lds
    s_cmp_lg_u32 s8, 4
    s_cbranch_scc1 L_p2_nopk1
    s_waitcnt vmcnt(8)
    s_mov_b64 s[22:23], s[38:39]
    s_lshl_b32 s39, s79, 1
    s_lshl_b32 s38, 512, s39
    s_lshr_b32 s39, 2048, s39
    v_lshrrev_b32 v75, 5, v0
    v_mul_u32_u24 v72, s39, v75
    v_bfe_u32 v76, v0, 4, 1
    v_mul_u32_u24 v76, s38, v76
    v_add3_u32 v72, v72, v76, s80
    v_bfe_u32 v76, v0, 2, 2
    v_lshl_add_u32 v72, v76, 7, v72
    v_and_b32 v76, 3, v0
    v_lshl_add_u32 v72, v76, 3, v72
    v_lshlrev_b32 v73, 4, v0
    ds_read_b64_tr_b16 v[96:97], v72 offset:0
    ds_read_b64_tr_b16 v[98:99], v72 offset:1024
    ds_read_b64_tr_b16 v[100:101], v72 offset:32
    ds_read_b64_tr_b16 v[102:103], v72 offset:1056
    ds_read_b64_tr_b16 v[104:105], v72 offset:64
    ds_read_b64_tr_b16 v[106:107], v72 offset:1088
    ds_read_b64_tr_b16 v[108:109], v72 offset:96
    ds_read_b64_tr_b16 v[110:111], v72 offset:1120
    s_sub_u32 s38, s77, 25165824
    s_lshr_b32 s38, s38, 3
    s_add_u32 s38, s38, 35651584
    s_cmp_eq_u32 s79, 1
    s_cselect_b32 s38, s38, 1073741824
    s_mov_b32 s39, 0xffff0000
    v_lshlrev_b32 v74, 2, v0
    s_waitcnt lgkmcnt(6)
    buffer_store_dwordx4 v[96:99], v73, s[88:91], s77 offen sc1
    s_add_u32 s77, s77, s78
    s_waitcnt lgkmcnt(4)
    buffer_store_dwordx4 v[100:103], v73, s[88:91], s77 offen sc1
    s_add_u32 s77, s77, s78
    s_waitcnt lgkmcnt(2)
    buffer_store_dwordx4 v[104:107], v73, s[88:91], s77 offen sc1
    s_add_u32 s77, s77, s78
    s_waitcnt lgkmcnt(0)
    buffer_store_dwordx4 v[108:111], v73, s[88:91], s77 offen sc1
    s_add_u32 s77, s77, s78
    v_lshlrev_b32 v82, 16, v96
    v_and_b32 v83, s39, v96
    v_lshlrev_b32 v75, 16, v97
    v_and_b32 v76, s39, v97
    v_add_f32 v82, v82, v75
    v_add_f32 v83, v83, v76
    v_lshlrev_b32 v75, 16, v98
    v_and_b32 v76, s39, v98
    v_add_f32 v82, v82, v75
    v_add_f32 v83, v83, v76
    v_lshlrev_b32 v75, 16, v99
    v_and_b32 v76, s39, v99
    v_add_f32 v82, v82, v75
    v_add_f32 v83, v83, v76
    v_add_f32 v82, v82, v83
    v_mov_b32 v83, v82
    s_nop 1
    v_permlane32_swap_b32 v82, v83
    s_nop 1
    v_add_f32 v82, v82, v83
    s_mov_b32 exec_hi, 0
    buffer_store_dword v82, v74, s[88:91], s38 offen sc1
    s_mov_b32 exec_hi, -1
    s_add_u32 s38, s38, 5120
    v_lshlrev_b32 v84, 16, v100
    v_and_b32 v85, s39, v100
    v_lshlrev_b32 v75, 16, v101
    v_and_b32 v76, s39, v101
    v_add_f32 v84, v84, v75
    v_add_f32 v85, v85, v76
    v_lshlrev_b32 v75, 16, v102
    v_and_b32 v76, s39, v102
    v_add_f32 v84, v84, v75
    v_add_f32 v85, v85, v76
    v_lshlrev_b32 v75, 16, v103
    v_and_b32 v76, s39, v103
    v_add_f32 v84, v84, v75
    v_add_f32 v85, v85, v76
    v_add_f32 v84, v84, v85
    v_mov_b32 v85, v84
    s_nop 1
    v_permlane32_swap_b32 v84, v85
    s_nop 1
    v_add_f32 v84, v84, v85
    s_mov_b32 exec_hi, 0
    buffer_store_dword v84, v74, s[88:91], s38 offen sc1
    s_mov_b32 exec_hi, -1
    s_add_u32 s38, s38, 5120
    v_lshlrev_b32 v82, 16, v104
    v_and_b32 v83, s39, v104
    v_lshlrev_b32 v75, 16, v105
    v_and_b32 v76, s39, v105
    v_add_f32 v82, v82, v75
    v_add_f32 v83, v83, v76
    v_lshlrev_b32 v75, 16, v106
    v_and_b32 v76, s39, v106
    v_add_f32 v82, v82, v75
    v_add_f32 v83, v83, v76
    v_lshlrev_b32 v75, 16, v107
    v_and_b32 v76, s39, v107
    v_add_f32 v82, v82, v75
    v_add_f32 v83, v83, v76
    v_add_f32 v82, v82, v83
    v_mov_b32 v83, v82
    s_nop 1
    v_permlane32_swap_b32 v82, v83
    s_nop 1
    v_add_f32 v82, v82, v83
    s_mov_b32 exec_hi, 0
    buffer_store_dword v82, v74, s[88:91], s38 offen sc1
    s_mov_b32 exec_hi, -1
    s_add_u32 s38, s38, 5120
    v_lshlrev_b32 v84, 16, v108
    v_and_b32 v85, s39, v108
    v_lshlrev_b32 v75, 16, v109
    v_and_b32 v76, s39, v109
    v_add_f32 v84, v84, v75
    v_add_f32 v85, v85, v76
    v_lshlrev_b32 v75, 16, v110
    v_and_b32 v76, s39, v110
    v_add_f32 v84, v84, v75
    v_add_f32 v85, v85, v76
    v_lshlrev_b32 v75, 16, v111
    v_and_b32 v76, s39, v111
    v_add_f32 v84, v84, v75
    v_add_f32 v85, v85, v76
    v_add_f32 v84, v84, v85
    v_mov_b32 v85, v84
    s_nop 1
    v_permlane32_swap_b32 v84, v85
    s_nop 1
    v_add_f32 v84, v84, v85
    s_mov_b32 exec_hi, 0
    buffer_store_dword v84, v74, s[88:91], s38 offen sc1
    s_mov_b32 exec_hi, -1
    s_add_u32 s38, s38, 5120
    s_mov_b64 s[38:39], s[22:23]
    s_waitcnt vmcnt(8) lgkmcnt(0)
    s_branch L_p2_tk1
L_p2_nopk1:
    s_waitcnt vmcnt(0) lgkmcnt(0)
L_p2_tk1:
    s_cmp_ge_u32 s8, 4
    s_cbranch_scc1 L_p2_tk2
    s_mov_b32 s11, 16384
    v_mov_b32 v92, 0
L_tok6:
    v_readfirstlane_b32 s92, v90
    v_readfirstlane_b32 s93, v91
    s_sub_u32 s11, s11, 1
    s_cbranch_scc1 L_tok6_ok
    s_cmp_lg_u32 s92, 0
    s_cbranch_scc1 L_tok6_ok
    s_sleep 1
    buffer_load_dwordx2 v[90:91], v92, s[84:87], 0 offen sc1
    s_waitcnt vmcnt(0)
    s_branch L_tok6
L_tok6_ok:
L_p2_tk2:
    s_barrier
    s_cmp_ge_u32 s8, 4
    s_cbranch_scc1 L_p2_nopk2
    s_mov_b64 s[22:23], s[38:39]
    s_lshl_b32 s39, s79, 1
    s_lshl_b32 s38, 512, s39
    s_lshr_b32 s39, 2048, s39
    v_lshrrev_b32 v75, 5, v0
    v_mul_u32_u24 v72, s39, v75
    v_bfe_u32 v76, v0, 4, 1
    v_mul_u32_u24 v76, s38, v76
    v_add3_u32 v72, v72, v76, s80
    v_bfe_u32 v76, v0, 2, 2
    v_lshl_add_u32 v72, v76, 7, v72
    v_and_b32 v76, 3, v0
    v_lshl_add_u32 v72, v76, 3, v72
    v_lshlrev_b32 v73, 4, v0
    ds_read_b64_tr_b16 v[96:97], v72 offset:0
    ds_read_b64_tr_b16 v[98:99], v72 offset:1024
    ds_read_b64_tr_b16 v[100:101], v72 offset:32
    ds_read_b64_tr_b16 v[102:103], v72 offset:1056
    ds_read_b64_tr_b16 v[104:105], v72 offset:64
    ds_read_b64_tr_b16 v[106:107], v72 offset:1088
    ds_read_b64_tr_b16 v[108:109], v72 offset:96
    ds_read_b64_tr_b16 v[110:111], v72 offset:1120
    s_sub_u32 s38, s77, 25165824
    s_lshr_b32 s38, s38, 3
    s_add_u32 s38, s38, 35651584
    s_cmp_eq_u32 s79, 1
    s_cselect_b32 s38, s38, 1073741824
    s_mov_b32 s39, 0xffff0000
    v_lshlrev_b32 v74, 2, v0
    s_waitcnt lgkmcnt(6)
    buffer_store_dwordx4 v[96:99], v73, s[88:91], s77 offen sc1
    s_add_u32 s77, s77, s78
    s_waitcnt lgkmcnt(4)
    buffer_store_dwordx4 v[100:103], v73, s[88:91], s77 offen sc1
    s_add_u32 s77, s77, s78
    s_waitcnt lgkmcnt(2)
    buffer_store_dwordx4 v[104:107], v73, s[88:91], s77 offen sc1
    s_add_u32 s77, s77, s78
    s_waitcnt lgkmcnt(0)
    buffer_store_dwordx4 v[108:111], v73, s[88:91], s77 offen sc1
    s_add_u32 s77, s77, s78
    v_lshlrev_b32 v82, 16, v96
    v_and_b32 v83, s39, v96
    v_lshlrev_b32 v75, 16, v97
    v_and_b32 v76, s39, v97
    v_add_f32 v82, v82, v75
    v_add_f32 v83, v83, v76
    v_lshlrev_b32 v75, 16, v98
    v_and_b32 v76, s39, v98
    v_add_f32 v82, v82, v75
    v_add_f32 v83, v83, v76
    v_lshlrev_b32 v75, 16, v99
    v_and_b32 v76, s39, v99
    v_add_f32 v82, v82, v75
    v_add_f32 v83, v83, v76
    v_add_f32 v82, v82, v83
    v_mov_b32 v83, v82
    s_nop 1
    v_permlane32_swap_b32 v82, v83
    s_nop 1
    v_add_f32 v82, v82, v83
    s_mov_b32 exec_hi, 0
    buffer_store_dword v82, v74, s[88:91], s38 offen sc1
    s_mov_b32 exec_hi, -1
    s_add_u32 s38, s38, 5120
    v_lshlrev_b32 v84, 16, v100
    v_and_b32 v85, s39, v100
    v_lshlrev_b32 v75, 16, v101
    v_and_b32 v76, s39, v101
    v_add_f32 v84, v84, v75
    v_add_f32 v85, v85, v76
    v_lshlrev_b32 v75, 16, v102
    v_and_b32 v76, s39, v102
    v_add_f32 v84, v84, v75
    v_add_f32 v85, v85, v76
    v_lshlrev_b32 v75, 16, v103
    v_and_b32 v76, s39, v103
    v_add_f32 v84, v84, v75
    v_add_f32 v85, v85, v76
    v_add_f32 v84, v84, v85
    v_mov_b32 v85, v84
    s_nop 1
    v_permlane32_swap_b32 v84, v85
    s_nop 1
    v_add_f32 v84, v84, v85
    s_mov_b32 exec_hi, 0
    buffer_store_dword v84, v74, s[88:91], s38 offen sc1
    s_mov_b32 exec_hi, -1
    s_add_u32 s38, s38, 5120
    v_lshlrev_b32 v82, 16, v104
    v_and_b32 v83, s39, v104
    v_lshlrev_b32 v75, 16, v105
    v_and_b32 v76, s39, v105
    v_add_f32 v82, v82, v75
    v_add_f32 v83, v83, v76
    v_lshlrev_b32 v75, 16, v106
    v_and_b32 v76, s39, v106
    v_add_f32 v82, v82, v75
    v_add_f32 v83, v83, v76
    v_lshlrev_b32 v75, 16, v107
    v_and_b32 v76, s39, v107
    v_add_f32 v82, v82, v75
    v_add_f32 v83, v83, v76
    v_add_f32 v82, v82, v83
    v_mov_b32 v83, v82
    s_nop 1
    v_permlane32_swap_b32 v82, v83
    s_nop 1
    v_add_f32 v82, v82, v83
    s_mov_b32 exec_hi, 0
    buffer_store_dword v82, v74, s[88:91], s38 offen sc1
    s_mov_b32 exec_hi, -1
    s_add_u32 s38, s38, 5120
    v_lshlrev_b32 v84, 16, v108
    v_and_b32 v85, s39, v108
    v_lshlrev_b32 v75, 16, v109
    v_and_b32 v76, s39, v109
    v_add_f32 v84, v84, v75
    v_add_f32 v85, v85, v76
    v_lshlrev_b32 v75, 16, v110
    v_and_b32 v76, s39, v110
    v_add_f32 v84, v84, v75
    v_add_f32 v85, v85, v76
    v_lshlrev_b32 v75, 16, v111
    v_and_b32 v76, s39, v111
    v_add_f32 v84, v84, v75
    v_add_f32 v85, v85, v76
    v_add_f32 v84, v84, v85
    v_mov_b32 v85, v84
    s_nop 1
    v_permlane32_swap_b32 v84, v85
    s_nop 1
    v_add_f32 v84, v84, v85
    s_mov_b32 exec_hi, 0
    buffer_store_dword v84, v74, s[88:91], s38 offen sc1
    s_mov_b32 exec_hi, -1
    s_add_u32 s38, s38, 5120
    s_mov_b64 s[38:39], s[22:23]
L_p2_nopk2:
    ds_read_b128 v[16:19], v2 offset:0
    ds_read_b64 v[20:21], v3 offset:0
    s_cmp_lt_u32 s19, 8
    s_cselect_b32 s30, 0xf149, 0
    v_mov_b32 v22, s30
    ds_read_b128 v[24:27], v2 offset:12288
    ds_read_b64 v[28:29], v3 offset:12288
    s_cmp_lt_u32 s19, 0
    s_cselect_b32 s30, 0xf149, 0
    v_mov_b32 v30, s30
    ds_read_b128 v[32:35], v2 offset:1536
    ds_read_b64 v[36:37], v3 offset:1536
    s_cmp_lt_u32 s19, 7
    s_cselect_b32 s30, 0xf149, 0
    v_mov_b32 v38, s30
    s_waitcnt lgkmcnt(4)
    v_mfma_f32_32x32x16_bf16 v[96:111], v[16:19], v[8:11], 0
    v_mfma_f32_32x32x16_bf16 v[96:111], v[20:23], v[12:15], v[96:111]
    ds_read_b128 v[16:19], v2 offset:3072
    ds_read_b64 v[20:21], v3 offset:3072
    s_cmp_lt_u32 s19, 6
    s_cselect_b32 s30, 0xf149, 0
    v_mov_b32 v22, s30
    s_waitcnt lgkmcnt(4)
    v_mfma_f32_32x32x16_bf16 v[224:239], v[24:27], v[8:11], 0
    v_mfma_f32_32x32x16_bf16 v[224:239], v[28:31], v[12:15], v[224:239]
    ds_read_b128 v[24:27], v2 offset:4608
    ds_read_b64 v[28:29], v3 offset:4608
    s_cmp_lt_u32 s19, 5
    s_cselect_b32 s30, 0xf149, 0
    v_mov_b32 v30, s30
    s_waitcnt lgkmcnt(4)
    v_mfma_f32_32x32x16_bf16 v[112:127], v[32:35], v[8:11], 0
    v_mfma_f32_32x32x16_bf16 v[112:127], v[36:39], v[12:15], v[112:127]
    ds_read_b128 v[32:35], v2 offset:6144
    ds_read_b64 v[36:37], v3 offset:6144
    s_cmp_lt_u32 s19, 4
    s_cselect_b32 s30, 0xf149, 0
    v_mov_b32 v38, s30
    s_waitcnt lgkmcnt(4)
    v_mfma_f32_32x32x16_bf16 v[128:143], v[16:19], v[8:11], 0
    v_mfma_f32_32x32x16_bf16 v[128:143], v[20:23], v[12:15], v[128:143]
    ds_read_b128 v[16:19], v2 offset:7680
    ds_read_b64 v[20:21], v3 offset:7680
    s_cmp_lt_u32 s19, 3
    s_cselect_b32 s30, 0xf149, 0
    v_mov_b32 v22, s30
    v_cndmask_b32 v96, v224, v96, s[32:33]
    v_cndmask_b32 v97, v225, v97, s[34:35]
    v_cndmask_b32 v98, v226, v98, s[36:37]
    v_cndmask_b32 v99, v227, v99, s[38:39]
    v_cndmask_b32 v100, v228, v100, s[40:41]
    v_cndmask_b32 v101, v229, v101, s[42:43]
    v_cndmask_b32 v102, v230, v102, s[44:45]
    v_cndmask_b32 v103, v231, v103, s[46:47]
    v_cndmask_b32 v104, v232, v104, s[48:49]
    v_cndmask_b32 v105, v233, v105, s[50:51]
    v_cndmask_b32 v106, v234, v106, s[52:53]
    v_cndmask_b32 v107, v235, v107, s[54:55]
    v_cndmask_b32 v108, v236, v108, s[56:57]
    v_cndmask_b32 v109, v237, v109, s[58:59]
    v_cndmask_b32 v110, v238, v110, s[60:61]
    v_cndmask_b32 v111, v239, v111, s[62:63]
    s_waitcnt lgkmcnt(4)
    v_mfma_f32_32x32x16_bf16 v[144:159], v[24:27], v[8:11], 0
    v_mfma_f32_32x32x16_bf16 v[144:159], v[28:31], v[12:15], v[144:159]
    ds_read_b128 v[24:27], v2 offset:9216
    ds_read_b64 v[28:29], v3 offset:9216
    s_cmp_lt_u32 s19, 2
    s_cselect_b32 s30, 0xf149, 0
    v_mov_b32 v30, s30
    v_max_f32 v72, v96, v97
    v_max3_f32 v72, v98, v99, v72
    v_max3_f32 v72, v100, v101, v72
    v_max3_f32 v72, v102, v103, v72
    v_max3_f32 v72, v104, v105, v72
    v_max3_f32 v72, v106, v107, v72
    v_max3_f32 v72, v108, v109, v72
    v_max3_f32 v72, v110, v111, v72
    s_waitcnt lgkmcnt(4)
    v_mfma_f32_32x32x16_bf16 v[160:175], v[32:35], v[8:11], 0
    v_mfma_f32_32x32x16_bf16 v[160:175], v[36:39], v[12:15], v[160:175]
    ds_read_b128 v[32:35], v2 offset:10752
    ds_read_b64 v[36:37], v3 offset:10752
    s_cmp_lt_u32 s19, 1
    s_cselect_b32 s30, 0xf149, 0
    v_mov_b32 v38, s30
    v_max3_f32 v72, v112, v113, v72
    v_max3_f32 v72, v114, v115, v72
    v_max3_f32 v72, v116, v117, v72
    v_max3_f32 v72, v118, v119, v72
    v_max3_f32 v72, v120, v121, v72
    v_max3_f32 v72, v122, v123, v72
    v_max3_f32 v72, v124, v125, v72
    v_max3_f32 v72, v126, v127, v72
    s_waitcnt lgkmcnt(4)
    v_mfma_f32_32x32x16_bf16 v[176:191], v[16:19], v[8:11], 0
    v_mfma_f32_32x32x16_bf16 v[176:191], v[20:23], v[12:15], v[176:191]
    v_max3_f32 v72, v128, v129, v72
    v_max3_f32 v72, v130, v131, v72
    v_max3_f32 v72, v132, v133, v72
    v_max3_f32 v72, v134, v135, v72
    v_max3_f32 v72, v136, v137, v72
    v_max3_f32 v72, v138, v139, v72
    v_max3_f32 v72, v140, v141, v72
    v_max3_f32 v72, v142, v143, v72
    s_waitcnt lgkmcnt(2)
    v_mfma_f32_32x32x16_bf16 v[192:207], v[24:27], v[8:11], 0
    v_mfma_f32_32x32x16_bf16 v[192:207], v[28:31], v[12:15], v[192:207]
    v_max3_f32 v72, v144, v145, v72
    v_max3_f32 v72, v146, v147, v72
    v_max3_f32 v72, v148, v149, v72
    v_max3_f32 v72, v150, v151, v72
    v_max3_f32 v72, v152, v153, v72
    v_max3_f32 v72, v154, v155, v72
    v_max3_f32 v72, v156, v157, v72
    v_max3_f32 v72, v158, v159, v72
    s_waitcnt lgkmcnt(0)
    v_mfma_f32_32x32x16_bf16 v[208:223], v[32:35], v[8:11], 0
    v_mfma_f32_32x32x16_bf16 v[208:223], v[36:39], v[12:15], v[208:223]
    v_max3_f32 v72, v160, v161, v72
    v_max3_f32 v72, v162, v163, v72
    v_max3_f32 v72, v164, v165, v72
    v_max3_f32 v72, v166, v167, v72
    v_max3_f32 v72, v168, v169, v72
    v_max3_f32 v72, v170, v171, v72
    v_max3_f32 v72, v172, v173, v72
    v_max3_f32 v72, v174, v175, v72
    ds_read_b64_tr_b16 v[40:41], v4 offset:1536
    ds_read_b64_tr_b16 v[42:43], v4 offset:1920
    ds_read_b64_tr_b16 v[44:45], v4 offset:2304
    ds_read_b64_tr_b16 v[46:47], v4 offset:2688
    v_max3_f32 v72, v176, v177, v72
    v_max3_f32 v72, v178, v179, v72
    v_max3_f32 v72, v180, v181, v72
    v_max3_f32 v72, v182, v183, v72
    v_max3_f32 v72, v184, v185, v72
    v_max3_f32 v72, v186, v187, v72
    v_max3_f32 v72, v188, v189, v72
    v_max3_f32 v72, v190, v191, v72
    v_max3_f32 v72, v192, v193, v72
    v_max3_f32 v72, v194, v195, v72
    v_max3_f32 v72, v196, v197, v72
    v_max3_f32 v72, v198, v199, v72
    v_max3_f32 v72, v200, v201, v72
    v_max3_f32 v72, v202, v203, v72
    v_max3_f32 v72, v204, v205, v72
    v_max3_f32 v72, v206, v207, v72
    v_max3_f32 v72, v208, v209, v72
    v_max3_f32 v72, v210, v211, v72
    v_max3_f32 v72, v212, v213, v72
    v_max3_f32 v72, v214, v215, v72
    v_max3_f32 v72, v216, v217, v72
    v_max3_f32 v72, v218, v219, v72
    v_max3_f32 v72, v220, v221, v72
    v_max3_f32 v72, v222, v223, v72
    v_mov_b32 v73, v72
    v_mov_b32 v24, 0x3F803F80
    v_mov_b32 v25, 0
    v_permlane32_swap_b32 v72, v73
    v_mov_b32 v26, 0
    v_mov_b32 v27, 0
    v_max_f32 v72, v72, v73
    v_sub_f32 v72, 0, v72
    v_cvt_pk_bf16_f32 v73, v72, v72
    v_lshlrev_b32 v73, 16, v73
    v_sub_f32 v73, v72, v73
    v_cvt_pk_bf16_f32 v32, v72, v73
    v_cmp_gt_u32 vcc, 32, v0
    v_mov_b32 v33, 0
    v_mov_b32 v34, 0
    v_mov_b32 v35, 0
    v_cndmask_b32 v32, 0, v32, vcc
    s_nop 1
    v_mfma_f32_32x32x16_bf16 v[112:127], v[24:27], v[32:35], v[112:127]
    v_mfma_f32_32x32x16_bf16 v[128:143], v[24:27], v[32:35], v[128:143]
    s_cmp_lg_u32 s8, 4
    s_cbranch_scc1 L_p2_nofp
    s_waitcnt vmcnt(0)
    v_mov_b32 v76, s92
    v_mov_b32 v77, s93
    v_mbcnt_lo_u32_b32 v78, -1, 0
    v_mul_u32_u24 v78, 69888, v78
    s_mov_b64 exec, 255
    buffer_store_dwordx2 v[76:77], v78, s[88:91], s65 offen sc1
    s_mov_b64 exec, -1
L_p2_nofp:
    s_nop 10
    v_mfma_f32_32x32x16_bf16 v[144:159], v[24:27], v[32:35], v[144:159]
    v_exp_f32 v112, v112
    v_exp_f32 v113, v113
    v_exp_f32 v114, v114
    v_exp_f32 v115, v115
    v_exp_f32 v116, v116
    v_exp_f32 v117, v117
    v_exp_f32 v118, v118
    v_exp_f32 v119, v119
    v_exp_f32 v120, v120
    v_exp_f32 v121, v121
    v_exp_f32 v122, v122
    v_exp_f32 v123, v123
    v_exp_f32 v124, v124
    v_cvt_pk_bf16_f32 v112, v112, v113
    v_exp_f32 v125, v125
    v_cvt_pk_bf16_f32 v113, v114, v115
    v_exp_f32 v126, v126
    v_cvt_pk_bf16_f32 v114, v116, v117
    v_exp_f32 v127, v127
    v_cvt_pk_bf16_f32 v115, v118, v119
    ds_read_b64_tr_b16 v[48:49], v4 offset:3072
    ds_read_b64_tr_b16 v[50:51], v4 offset:3456
    ds_read_b64_tr_b16 v[52:53], v4 offset:3840
    ds_read_b64_tr_b16 v[54:55], v4 offset:4224
    v_cvt_pk_bf16_f32 v116, v120, v121
    v_cvt_pk_bf16_f32 v117, v122, v123
    v_cvt_pk_bf16_f32 v118, v124, v125
    v_cvt_pk_bf16_f32 v119, v126, v127
    v_mfma_f32_32x32x16_bf16 v[160:175], v[24:27], v[32:35], v[160:175]
    v_exp_f32 v128, v128
    v_exp_f32 v129, v129
    v_exp_f32 v130, v130
    v_exp_f32 v131, v131
    v_exp_f32 v132, v132
    v_exp_f32 v133, v133
    s_waitcnt lgkmcnt(4)
    v_mfma_f32_32x32x16_bf16 v[240:255], v[40:43], v[112:115], 0
    v_exp_f32 v134, v134
    v_exp_f32 v135, v135
    v_exp_f32 v136, v136
    v_exp_f32 v137, v137
    v_exp_f32 v138, v138
    v_mfma_f32_32x32x16_bf16 v[240:255], v[44:47], v[116:119], v[240:255]
    v_exp_f32 v139, v139
    v_exp_f32 v140, v140
    v_cvt_pk_bf16_f32 v128, v128, v129
    v_exp_f32 v141, v141
    v_cvt_pk_bf16_f32 v129, v130, v131
    v_exp_f32 v142, v142
    v_cvt_pk_bf16_f32 v130, v132, v133
    v_exp_f32 v143, v143
    v_cvt_pk_bf16_f32 v131, v134, v135
    ds_read_b64_tr_b16 v[40:41], v4 offset:4608
    ds_read_b64_tr_b16 v[42:43], v4 offset:4992
    ds_read_b64_tr_b16 v[44:45], v4 offset:5376
    ds_read_b64_tr_b16 v[46:47], v4 offset:5760
    v_cvt_pk_bf16_f32 v132, v136, v137
    v_cvt_pk_bf16_f32 v133, v138, v139
    v_cvt_pk_bf16_f32 v134, v140, v141
    v_cvt_pk_bf16_f32 v135, v142, v143
    v_mfma_f32_32x32x16_bf16 v[176:191], v[24:27], v[32:35], v[176:191]
    v_exp_f32 v144, v144
    v_exp_f32 v145, v145
    v_exp_f32 v146, v146
    v_exp_f32 v147, v147
    v_exp_f32 v148, v148
    v_exp_f32 v149, v149
    s_waitcnt lgkmcnt(4)
    v_mfma_f32_32x32x16_bf16 v[240:255], v[48:51], v[128:131], v[240:255]
    v_exp_f32 v150, v150
    v_exp_f32 v151, v151
    v_exp_f32 v152, v152
    v_exp_f32 v153, v153
    v_exp_f32 v154, v154
    v_mfma_f32_32x32x16_bf16 v[240:255], v[52:55], v[132:135], v[240:255]
    v_exp_f32 v155, v155
    v_exp_f32 v156, v156
    v_cvt_pk_bf16_f32 v144, v144, v145
    v_exp_f32 v157, v157
    v_cvt_pk_bf16_f32 v145, v146, v147
    v_exp_f32 v158, v158
    v_cvt_pk_bf16_f32 v146, v148, v149
    v_exp_f32 v159, v159
    v_cvt_pk_bf16_f32 v147, v150, v151
    ds_read_b64_tr_b16 v[48:49], v4 offset:6144
    ds_read_b64_tr_b16 v[50:51], v4 offset:6528
    ds_read_b64_tr_b16 v[52:53], v4 offset:6912
    ds_read_b64_tr_b16 v[54:55], v4 offset:7296
    v_cvt_pk_bf16_f32 v148, v152, v153
    v_cvt_pk_bf16_f32 v149, v154, v155
    v_cvt_pk_bf16_f32 v150, v156, v157
    v_cvt_pk_bf16_f32 v151, v158, v159
    v_mfma_f32_32x32x16_bf16 v[192:207], v[24:27], v[32:35], v[192:207]
    v_exp_f32 v160, v160
    v_exp_f32 v161, v161
    v_exp_f32 v162, v162
    v_exp_f32 v163, v163
    v_exp_f32 v164, v164
    v_exp_f32 v165, v165
    s_waitcnt lgkmcnt(4)
    v_mfma_f32_32x32x16_bf16 v[240:255], v[40:43], v[144:147], v[240:255]
    v_exp_f32 v166, v166
    v_exp_f32 v167, v167
    v_exp_f32 v168, v168
    v_exp_f32 v169, v169
    v_exp_f32 v170, v170
    v_mfma_f32_32x32x16_bf16 v[240:255], v[44:47], v[148:151], v[240:255]
    v_exp_f32 v171, v171
    v_exp_f32 v172, v172
    v_cvt_pk_bf16_f32 v160, v160, v161
    v_exp_f32 v173, v173
    v_cvt_pk_bf16_f32 v161, v162, v163
    v_exp_f32 v174, v174
    v_cvt_pk_bf16_f32 v162, v164, v165
    v_exp_f32 v175, v175
    v_cvt_pk_bf16_f32 v163, v166, v167
    ds_read_b64_tr_b16 v[40:41], v4 offset:7680
    ds_read_b64_tr_b16 v[42:43], v4 offset:8064
    ds_read_b64_tr_b16 v[44:45], v4 offset:8448
    ds_read_b64_tr_b16 v[46:47], v4 offset:8832
    v_cvt_pk_bf16_f32 v164, v168, v169
    v_cvt_pk_bf16_f32 v165, v170, v171
    v_cvt_pk_bf16_f32 v166, v172, v173
    v_cvt_pk_bf16_f32 v167, v174, v175
    v_mfma_f32_32x32x16_bf16 v[208:223], v[24:27], v[32:35], v[208:223]
    v_exp_f32 v176, v176
    v_exp_f32 v177, v177
    v_exp_f32 v178, v178
    v_exp_f32 v179, v179
    v_exp_f32 v180, v180
    v_exp_f32 v181, v181
    s_waitcnt lgkmcnt(4)
    v_mfma_f32_32x32x16_bf16 v[240:255], v[48:51], v[160:163], v[240:255]
    v_exp_f32 v182, v182
    v_exp_f32 v183, v183
    v_exp_f32 v184, v184
    v_exp_f32 v185, v185
    v_exp_f32 v186, v186
    v_mfma_f32_32x32x16_bf16 v[240:255], v[52:55], v[164:167], v[240:255]
    v_exp_f32 v187, v187
    v_exp_f32 v188, v188
    v_cvt_pk_bf16_f32 v176, v176, v177
    v_exp_f32 v189, v189
    v_cvt_pk_bf16_f32 v177, v178, v179
    v_exp_f32 v190, v190
    v_cvt_pk_bf16_f32 v178, v180, v181
    v_exp_f32 v191, v191
    v_cvt_pk_bf16_f32 v179, v182, v183
    ds_read_b64_tr_b16 v[48:49], v4 offset:9216
    ds_read_b64_tr_b16 v[50:51], v4 offset:9600
    ds_read_b64_tr_b16 v[52:53], v4 offset:9984
    ds_read_b64_tr_b16 v[54:55], v4 offset:10368
    v_cvt_pk_bf16_f32 v180, v184, v185
    v_cvt_pk_bf16_f32 v181, v186, v187
    v_cvt_pk_bf16_f32 v182, v188, v189
    v_cvt_pk_bf16_f32 v183, v190, v191
    s_cmp_lg_u32 s8, 7
    s_cbranch_scc1 L_p2_nofl
    v_lshlrev_b32 v16, 3, v0
    s_mov_b32 s14, 34607104
    buffer_load_dwordx2 v[8:9], v16, s[96:99], s14 offen offset:0 sc1
    buffer_load_dwordx2 v[10:11], v16, s[96:99], s14 offen offset:512 sc1
    buffer_load_dwordx2 v[12:13], v16, s[96:99], s14 offen offset:1024 sc1
    buffer_load_dwordx2 v[14:15], v16, s[96:99], s14 offen offset:1536 sc1
L_p2_nofl:
    v_mfma_f32_32x32x16_bf16 v[96:111], v[24:27], v[32:35], v[96:111]
    v_exp_f32 v192, v192
    v_exp_f32 v193, v193
    v_exp_f32 v194, v194
    v_exp_f32 v195, v195
    v_exp_f32 v196, v196
    v_exp_f32 v197, v197
    s_waitcnt lgkmcnt(4)
    v_mfma_f32_32x32x16_bf16 v[240:255], v[40:43], v[176:179], v[240:255]
    v_exp_f32 v198, v198
    v_exp_f32 v199, v199
    v_exp_f32 v200, v200
    v_exp_f32 v201, v201
    v_exp_f32 v202, v202
    v_mfma_f32_32x32x16_bf16 v[240:255], v[44:47], v[180:183], v[240:255]
    v_exp_f32 v203, v203
    v_exp_f32 v204, v204
    v_cvt_pk_bf16_f32 v192, v192, v193
    v_exp_f32 v205, v205
    v_cvt_pk_bf16_f32 v193, v194, v195
    v_exp_f32 v206, v206
    v_cvt_pk_bf16_f32 v194, v196, v197
    v_exp_f32 v207, v207
    v_cvt_pk_bf16_f32 v195, v198, v199
    ds_read_b64_tr_b16 v[40:41], v4 offset:10752
    ds_read_b64_tr_b16 v[42:43], v4 offset:11136
    ds_read_b64_tr_b16 v[44:45], v4 offset:11520
    ds_read_b64_tr_b16 v[46:47], v4 offset:11904
    v_cvt_pk_bf16_f32 v196, v200, v201
    v_cvt_pk_bf16_f32 v197, v202, v203
    v_cvt_pk_bf16_f32 v198, v204, v205
    v_cvt_pk_bf16_f32 v199, v206, v207
    v_exp_f32 v208, v208
    v_exp_f32 v209, v209
    v_exp_f32 v210, v210
    v_exp_f32 v211, v211
    v_exp_f32 v212, v212
    v_exp_f32 v213, v213
    s_waitcnt lgkmcnt(4)
    v_mfma_f32_32x32x16_bf16 v[240:255], v[48:51], v[192:195], v[240:255]
    v_exp_f32 v214, v214
    v_exp_f32 v215, v215
    v_exp_f32 v216, v216
    v_exp_f32 v217, v217
    v_exp_f32 v218, v218
    v_mfma_f32_32x32x16_bf16 v[240:255], v[52:55], v[196:199], v[240:255]
    v_exp_f32 v219, v219
    v_exp_f32 v220, v220
    v_cvt_pk_bf16_f32 v208, v208, v209
    v_exp_f32 v221, v221
    v_cvt_pk_bf16_f32 v209, v210, v211
    v_exp_f32 v222, v222
    v_cvt_pk_bf16_f32 v210, v212, v213
    v_exp_f32 v223, v223
    v_cvt_pk_bf16_f32 v211, v214, v215
    ds_read_b64_tr_b16 v[48:49], v4 offset:0
    ds_read_b64_tr_b16 v[50:51], v4 offset:384
    ds_read_b64_tr_b16 v[52:53], v4 offset:768
    ds_read_b64_tr_b16 v[54:55], v4 offset:1152
    v_cvt_pk_bf16_f32 v212, v216, v217
    v_cvt_pk_bf16_f32 v213, v218, v219
    v_cvt_pk_bf16_f32 v214, v220, v221
    v_cvt_pk_bf16_f32 v215, v222, v223
    v_exp_f32 v96, v96
    v_exp_f32 v97, v97
    v_exp_f32 v98, v98
    v_exp_f32 v99, v99
    v_exp_f32 v100, v100
    v_exp_f32 v101, v101
    s_waitcnt lgkmcnt(4)
    v_mfma_f32_32x32x16_bf16 v[240:255], v[40:43], v[208:211], v[240:255]
    v_exp_f32 v102, v102
    v_exp_f32 v103, v103
    v_exp_f32 v104, v104
    v_exp_f32 v105, v105
    v_exp_f32 v106, v106
    v_mfma_f32_32x32x16_bf16 v[240:255], v[44:47], v[212:215], v[240:255]
    v_exp_f32 v107, v107
    v_exp_f32 v108, v108
    v_cvt_pk_bf16_f32 v96, v96, v97
    v_exp_f32 v109, v109
    v_cvt_pk_bf16_f32 v97, v98, v99
    v_exp_f32 v110, v110
    v_cvt_pk_bf16_f32 v98, v100, v101
    v_exp_f32 v111, v111
    v_cvt_pk_bf16_f32 v99, v102, v103
    ds_read_b64_tr_b16 v[40:41], v4 offset:12288
    ds_read_b64_tr_b16 v[42:43], v4 offset:12672
    ds_read_b64_tr_b16 v[44:45], v4 offset:13056
    ds_read_b64_tr_b16 v[46:47], v4 offset:13440
    v_cvt_pk_bf16_f32 v100, v104, v105
    v_cvt_pk_bf16_f32 v101, v106, v107
    v_cvt_pk_bf16_f32 v102, v108, v109
    v_cvt_pk_bf16_f32 v103, v110, v111
    v_bfi_b32 v64, v56, 0, v96
    v_and_b32 v96, v56, v96
    v_bfi_b32 v65, v57, 0, v97
    v_and_b32 v97, v57, v97
    v_bfi_b32 v66, v58, 0, v98
    v_and_b32 v98, v58, v98
    v_bfi_b32 v67, v59, 0, v99
    v_and_b32 v99, v59, v99
    v_bfi_b32 v68, v60, 0, v100
    v_and_b32 v100, v60, v100
    v_bfi_b32 v69, v61, 0, v101
    v_and_b32 v101, v61, v101
    v_bfi_b32 v70, v62, 0, v102
    v_and_b32 v102, v62, v102
    v_bfi_b32 v71, v63, 0, v103
    v_and_b32 v103, v63, v103
    s_nop 1
    s_waitcnt lgkmcnt(0)
    v_mfma_f32_32x32x16_bf16 v[240:255], v[48:51], v[96:99], v[240:255]
    v_mfma_f32_32x32x16_bf16 v[240:255], v[52:55], v[100:103], v[240:255]
    v_mfma_f32_32x32x16_bf16 v[240:255], v[40:43], v[64:67], v[240:255]
    v_mfma_f32_32x32x16_bf16 v[240:255], v[44:47], v[68:71], v[240:255]
    v_bfe_u32 v76, v0, 4, 1
    s_lshl_b32 s30, s19, 1
    v_add_u32 v76, s30, v76
    v_mul_u32_u24 v76, 20480, v76
    v_and_b32 v77, 15, v0
    v_lshl_add_u32 v79, v77, 4, v76
    v_lshl_add_u32 v76, v77, 3, v76
    v_lshrrev_b32 v77, 5, v0
    v_lshl_add_u32 v77, v77, 8, v79
    v_cmp_gt_u32 vcc, 32, v0
    v_mov_b32 v78, 1073741824
    s_lshr_b32 s30, s6, 2
    s_mul_i32 s30, s30, 5
    v_cndmask_b32 v76, v78, v76, vcc
    s_and_b32 s31, s6, 3
    s_add_u32 s31, s30, s31
    s_lshl_b32 s31, s31, 10
    s_lshl_b32 s28, s7, 9
    s_add_u32 s31, s31, s28
    s_add_u32 s31, s31, 8388608
    s_add_u32 s30, s30, 4
    s_lshl_b32 s30, s30, 10
    s_and_b32 s28, s4, 7
    s_lshl_b32 s28, s28, 7
    s_add_u32 s30, s30, s28
    s_add_u32 s30, s30, 8388608
    s_lshl_b32 s65, s5, 5
    s_add_u32 s65, s65, s4
    s_lshl_b32 s65, s65, 3
    s_add_u32 s65, s65, 34611200
    v_rcp_f32 v80, v252
    s_nop 0
    v_mul_f32 v240, v240, v80
    v_mul_f32 v241, v241, v80
    v_mul_f32 v242, v242, v80
    v_mul_f32 v243, v243, v80
    v_mul_f32 v244, v244, v80
    v_mul_f32 v245, v245, v80
    v_mul_f32 v246, v246, v80
    v_mul_f32 v247, v247, v80
    v_mul_f32 v248, v248, v80
    v_mul_f32 v249, v249, v80
    v_mul_f32 v250, v250, v80
    v_mul_f32 v251, v251, v80
    v_cvt_pk_bf16_f32 v84, v240, v241
    v_cvt_pk_bf16_f32 v85, v242, v243
    v_cvt_pk_bf16_f32 v86, v244, v245
    v_cvt_pk_bf16_f32 v87, v246, v247
    v_cvt_pk_bf16_f32 v88, v248, v249
    v_cvt_pk_bf16_f32 v89, v250, v251
    buffer_store_dwordx4 v[84:87], v77, s[88:91], s31 offen sc1
    buffer_store_dwordx2 v[88:89], v76, s[88:91], s30 offen sc1
L_p2_e0:
    s_cmp_lg_u32 s8, 7
    s_cbranch_scc1 L_p2_e2
    s_waitcnt vmcnt(2)
    v_cmp_ne_u64 s[20:21], s[92:93], v[8:9]
    v_cmp_ne_u64 s[22:23], s[92:93], v[10:11]
    v_cmp_ne_u64 s[24:25], s[92:93], v[12:13]
    v_cmp_ne_u64 s[26:27], s[92:93], v[14:15]
    v_mov_b32 v16, 146432
    s_nop 0
    s_or_b64 s[20:21], s[20:21], s[22:23]
    s_or_b64 s[24:25], s[24:25], s[26:27]
    s_or_b64 s[20:21], s[20:21], s[24:25]
    s_cmp_eq_u64 s[20:21], 0
    s_cselect_b32 s14, 1, 0
    v_mov_b32 v17, s14
    ds_write_b32 v16, v17
L_p2_e2:
    s_waitcnt vmcnt(0) lgkmcnt(0)
L_p2_e1:
    s_barrier
    s_cmp_lg_u32 s8, 0
    s_cbranch_scc1 L_p2_end
    v_mov_b32 v2, s92
    v_mov_b32 v3, s93
    v_mbcnt_lo_u32_b32 v4, -1, 0
    v_mul_u32_u24 v4, 69888, v4
    s_mov_b64 exec, 255
    buffer_store_dwordx2 v[2:3], v4, s[88:91], s65 offen sc1
    s_mov_b64 exec, -1
    s_lshl_b32 s65, s2, 3
    s_add_u32 s65, s65, 34627584
    v_mov_b32 v2, s92
    v_mov_b32 v3, s93
    v_mbcnt_lo_u32_b32 v4, -1, 0
    v_mul_u32_u24 v4, 69888, v4
    s_mov_b64 exec, 255
    buffer_store_dwordx2 v[2:3], v4, s[88:91], s65 offen sc1
    s_mov_b64 exec, -1
L_p2_end:
    s_load_dwordx2 s[4:5], s[0:1], 0
    s_and_b32 s14, s2, 7
    s_lshr_b32 s15, s2, 3
    s_lshr_b32 s16, s14, 1
    s_lshl_b32 s16, s16, 3
    s_lshr_b32 s17, s15, 2
    s_add_u32 s16, s16, s17
    s_and_b32 s17, s14, 1
    s_lshl_b32 s17, s17, 2
    s_and_b32 s18, s15, 3
    s_add_u32 s17, s17, s18
    s_mov_b32 s19, s94
    v_lshlrev_b32 v2, 4, v0
    v_mov_b32 v12, 146432
    ds_read_b32 v13, v12
    s_mul_i32 s34, s19, 5120
    s_mul_i32 s42, s17, 102400
    s_lshl_b32 s14, s19, 10
    s_add_u32 s42, s42, s14
    s_add_u32 s42, s42, 33030144
    s_mov_b32 s32, s19
    s_waitcnt lgkmcnt(0)
    v_readfirstlane_b32 s14, v13
    s_cmp_eq_u32 s14, 1
    s_cbranch_scc1 L_p3_wl
    v_lshlrev_b32 v12, 3, v0
    s_mov_b32 s14, 34607104
    s_mov_b32 s15, 16384
L_poll7:
    buffer_load_dwordx2 v[14:15], v12, s[96:99], s14 offen offset:0 sc1
    buffer_load_dwordx2 v[16:17], v12, s[96:99], s14 offen offset:512 sc1
    buffer_load_dwordx2 v[18:19], v12, s[96:99], s14 offen offset:1024 sc1
    buffer_load_dwordx2 v[20:21], v12, s[96:99], s14 offen offset:1536 sc1
    s_waitcnt vmcnt(0)
    v_xor_b32 v16, s92, v16
    v_xor_b32 v17, s93, v17
    v_or_b32 v16, v16, v17
    v_cmp_ne_u32 vcc, 0, v16
    s_nop 1
    v_cndmask_b32 v14, v14, 0, vcc
    v_xor_b32 v18, s92, v18
    v_xor_b32 v19, s93, v19
    v_or_b32 v18, v18, v19
    v_cmp_ne_u32 vcc, 0, v18
    s_nop 1
    v_cndmask_b32 v14, v14, 0, vcc
    v_xor_b32 v20, s92, v20
    v_xor_b32 v21, s93, v21
    v_or_b32 v20, v20, v21
    v_cmp_ne_u32 vcc, 0, v20
    s_nop 1
    v_cndmask_b32 v14, v14, 0, vcc
    v_cmp_ne_u64 vcc, s[92:93], v[14:15]
    s_sub_u32 s15, s15, 1
    s_cbranch_scc1 L_poll7_ok
    s_cmp_eq_u64 vcc, 0
    s_cbranch_scc1 L_poll7_ok
    s_sleep 1
    s_branch L_poll7
L_poll7_ok:
L_p3_wl:
    s_add_u32 m0, s34, 0
    s_add_u32 s14, s42, 0
    buffer_load_dwordx4 v2, s[88:91], s14 offen sc1 lds
    s_add_u32 m0, s34, 1024
    s_add_u32 s14, s42, 20480
    buffer_load_dwordx4 v2, s[88:91], s14 offen sc1 lds
    s_add_u32 m0, s34, 2048
    s_add_u32 s14, s42, 40960
    buffer_load_dwordx4 v2, s[88:91], s14 offen sc1 lds
    s_add_u32 m0, s34, 3072
    s_add_u32 s14, s42, 61440
    buffer_load_dwordx4 v2, s[88:91], s14 offen sc1 lds
    s_add_u32 m0, s34, 4096
    s_add_u32 s14, s42, 81920
    buffer_load_dwordx4 v2, s[88:91], s14 offen sc1 lds
    s_add_u32 s34, s34, 40960
    s_add_u32 s42, s42, 8192
    s_add_u32 s32, s32, 8
    s_cmp_lt_u32 s32, 20
    s_cbranch_scc1 L_p3_wl
    s_cmp_lt_u32 s19, 4
    s_cbranch_scc1 L_p3_C
    s_waitcnt lgkmcnt(0)
    s_mov_b32 s28, s4
    s_mov_b32 s29, s5
    s_mov_b32 s30, 2621440
    s_mov_b32 s31, 0x00020000
    v_and_b32 v12, 7, v0
    v_lshrrev_b32 v13, 3, v0
    s_lshl_b32 s14, s19, 3
    v_add_u32 v14, s14, v12
    v_mul_u32_u24 v5, 336, v14
    v_lshl_add_u32 v5, v13, 5, v5
    v_add_u32 v5, 102400, v5
    v_mul_u32_u24 v7, 1280, v14
    v_lshl_add_u32 v7, v13, 4, v7
    v_lshlrev_b32 v9, 9, v13
    v_lshl_add_u32 v9, v12, 4, v9
    v_lshlrev_b32 v10, 3, v0
    v_cmp_gt_u32 vcc, 16, v0
    v_mov_b32 v15, 1073741824
    s_mul_i32 s14, s16, 81920
    s_mul_i32 s15, s17, 160
    s_add_u32 s14, s14, s15
    v_cndmask_b32 v8, v15, v7, vcc
    buffer_load_dwordx4 v[24:27], v7, s[28:31], s14 offen
    buffer_load_dwordx4 v[28:31], v8, s[28:31], s14 offen offset:128
    s_cmp_lt_u32 s19, 6
    s_cbranch_scc1 L_p3_nopk
    s_sub_u32 s81, s19, 6
    s_lshl_b32 s80, s81, 12
    s_add_u32 s80, s80, 147456
    s_lshl_b32 s81, s81, 8
    s_add_u32 s81, s81, s2
    s_add_u32 s81, s81, 1280
    s_mov_b32 s27, 0x00020000
    s_mov_b32 s31, 0x00020000
    s_cmp_lt_u32 s81, 200
    s_cbranch_scc1 L_pk3_c
    s_cmp_ge_u32 s81, 1280
    s_cbranch_scc1 L_pk3_b
    s_sub_u32 s38, s81, 200
    s_mul_i32 s75, s38, 2428
    s_lshr_b32 s75, s75, 16
    s_mul_i32 s76, s75, 27
    s_sub_u32 s76, s38, s76
    s_mov_b32 s24, s68
    s_mov_b32 s25, s69
    s_mov_b32 s26, 2211840
    s_mov_b32 s28, s70
    s_mov_b32 s29, s71
    s_mov_b32 s30, 2211840
    s_mul_i32 s32, s75, 55296
    s_lshl_b32 s36, s76, 7
    s_add_u32 s32, s32, s36
    s_add_u32 s33, s32, 13824
    s_mov_b32 s34, s32
    s_mov_b32 s35, s33
    s_mov_b32 s36, 3456
    s_mov_b32 s37, 4
    s_mov_b32 s79, 1
    s_mov_b32 s78, 40960
    s_mov_b32 s77, 25165824
    s_branch L_pk3_go
    L_pk3_b:
    s_sub_u32 s38, s81, 1280
    s_mul_i32 s75, s38, 6554
    s_lshr_b32 s75, s75, 16
    s_mul_i32 s76, s75, 10
    s_sub_u32 s76, s38, s76
    s_mov_b32 s24, s72
    s_mov_b32 s25, s73
    s_cmp_lt_u32 s38, 540
    s_cselect_b32 s26, 2211840, 0
    s_cselect_b32 s77, 30408704, 1073741824
    s_mul_i32 s32, s75, 7
    s_sub_u32 s33, s32, 110
    s_cmp_ge_u32 s75, 16
    s_cselect_b32 s34, s33, s32
    s_sub_u32 s33, s32, 213
    s_cmp_ge_u32 s75, 31
    s_cselect_b32 s34, s33, s34
    s_add_u32 s35, s34, 1
    s_lshl_b32 s33, s32, 1
    s_sub_u32 s33, s33, 638
    s_add_u32 s36, s33, 7
    s_min_u32 s36, s36, 107
    s_cmp_ge_u32 s75, 46
    s_cselect_b32 s34, s33, s34
    s_cselect_b32 s35, s36, s35
    s_mul_i32 s32, s34, 20480
    s_add_u32 s33, s32, 10240
    s_mul_i32 s34, s35, 20480
    s_add_u32 s35, s34, 10240
    s_mov_b32 s78, 55296
    s_branch L_pk3_d
    L_pk3_c:
    s_mul_i32 s75, s81, 6554
    s_lshr_b32 s75, s75, 16
    s_mul_i32 s76, s75, 10
    s_sub_u32 s76, s81, s76
    s_mov_b32 s24, s66
    s_mov_b32 s25, s67
    s_mov_b32 s26, 819200
    s_mov_b32 s77, 33030144
    s_mul_i32 s36, s75, 52
    s_lshr_b32 s36, s36, 8
    s_mul_i32 s37, s36, 5
    s_sub_u32 s37, s75, s37
    s_mul_i32 s38, s36, 204800
    s_mul_i32 s39, s37, 51200
    s_add_u32 s32, s38, s39
    s_add_u32 s33, s32, 10240
    s_add_u32 s34, s32, 30720
    s_add_u32 s35, s32, 40960
    s_cmp_lt_u32 s37, 4
    s_cbranch_scc1 L_pk3_e
    s_add_u32 s32, s38, 20480
    s_add_u32 s33, s32, 102400
    s_add_u32 s34, s32, 51200
    s_add_u32 s35, s32, 153600
    L_pk3_e:
    s_mov_b32 s78, 20480
    L_pk3_d:
    s_mov_b32 s28, s24
    s_mov_b32 s29, s25
    s_mov_b32 s30, s26
    s_lshl_b32 s36, s76, 7
    s_add_u32 s32, s32, s36
    s_add_u32 s33, s33, s36
    s_add_u32 s34, s34, s36
    s_add_u32 s35, s35, s36
    s_mov_b32 s36, 1280
    s_mov_b32 s37, 0
    s_mov_b32 s79, 0
    L_pk3_go:
    v_lshrrev_b32 v14, 3, v0
    v_lshrrev_b32 v15, 5, v0
    v_mul_u32_u24 v16, s37, v15
    v_add_u32 v14, v14, v16
    v_mul_u32_u24 v14, s36, v14
    v_and_b32 v16, 7, v0
    v_lshl_add_u32 v14, v16, 4, v14
    s_mov_b32 m0, s80
    s_lshl_b32 s76, s76, 2
    buffer_load_dwordx4 v14, s[24:27], s32 offen lds
    s_add_u32 m0, s80, 1024
    s_mul_i32 s76, s76, s78
    buffer_load_dwordx4 v14, s[24:27], s33 offen lds
    s_add_u32 m0, s80, 2048
    s_lshl_b32 s75, s75, 10
    buffer_load_dwordx4 v14, s[28:31], s34 offen lds
    s_add_u32 m0, s80, 3072
    s_add_u32 s77, s77, s76
    buffer_load_dwordx4 v14, s[28:31], s35 offen lds
    s_add_u32 s77, s77, s75
    s_waitcnt vmcnt(6)
    s_branch L_p3_pk2
L_p3_nopk:
    s_waitcnt vmcnt(2)
L_p3_pk2:
    s_barrier
    v_lshlrev_b32 v12, 3, v0
    s_mov_b32 s14, 34627584
    buffer_load_dwordx2 v[112:113], v12, s[96:99], s14 offen offset:0 sc1
    buffer_load_dwordx2 v[114:115], v12, s[96:99], s14 offen offset:512 sc1
    buffer_load_dwordx2 v[116:117], v12, s[96:99], s14 offen offset:1024 sc1
    buffer_load_dwordx2 v[118:119], v12, s[96:99], s14 offen offset:1536 sc1
    s_lshr_b32 s20, s2, 3
    s_xor_b32 s21, s94, 6
    s_or_b32 s20, s20, s21
    s_cmp_lg_u32 s20, 0
    s_cbranch_scc1 L_cpe3
    s_getpc_b64 s[20:21]
    L_cp3:
    s_add_u32 s20, s20, L_p3_end-L_cp3
    s_addc_u32 s21, s21, 0
    v_lshlrev_b32 v124, 7, v0
    v_min_u32 v126, L_p4_end-L_p3_end, v124
    global_load_dword v125, v126, s[20:21]
    v_add_u32 v124, 8192, v124
    v_min_u32 v126, L_p4_end-L_p3_end, v124
    global_load_dword v125, v126, s[20:21]
    v_add_u32 v124, 8192, v124
L_cpe3:
    s_mov_b64 s[36:37], s[16:17]
    s_and_b32 s14, s2, 7
    s_lshr_b32 s15, s2, 3
    s_lshr_b32 s16, s14, 2
    s_lshl_b32 s16, s16, 3
    s_lshr_b32 s17, s15, 2
    s_add_u32 s16, s16, s17
    s_and_b32 s17, s14, 3
    s_lshl_b32 s17, s17, 2
    s_and_b32 s18, s15, 3
    s_add_u32 s17, s17, s18
    s_and_b32 s18, s94, 1
    s_mul_i32 s15, s17, 7
    s_add_u32 s14, s15, s18
    s_min_u32 s48, s14, 107
    s_add_u32 s14, s14, 2
    s_min_u32 s49, s14, 107
    s_add_u32 s14, s14, 2
    s_min_u32 s50, s14, 107
    s_add_u32 s14, s15, 6
    s_min_u32 s51, s14, 107
    s_mul_i32 s48, s48, 40960
    s_mul_i32 s49, s49, 40960
    s_mul_i32 s50, s50, 40960
    s_mul_i32 s51, s51, 40960
    s_add_u32 s48, s48, 25165824
    s_add_u32 s49, s49, 25165824
    s_add_u32 s50, s50, 25165824
    s_add_u32 s51, s51, 25165824
    s_lshl_b32 s52, s18, 10
    s_add_u32 s51, s51, s52
    s_mov_b32 s53, 1024
    s_mov_b32 s54, 0
    s_mov_b64 s[16:17], s[36:37]
    s_waitcnt vmcnt(0)
    v_cmp_ne_u64 s[20:21], s[92:93], v[112:113]
    v_cmp_ne_u64 s[22:23], s[92:93], v[114:115]
    v_cmp_ne_u64 s[24:25], s[92:93], v[116:117]
    v_cmp_ne_u64 s[26:27], s[92:93], v[118:119]
    s_nop 1
    s_or_b64 s[20:21], s[20:21], s[22:23]
    s_or_b64 s[24:25], s[24:25], s[26:27]
    s_or_b64 s[20:21], s[20:21], s[24:25]
    s_cmp_eq_u64 s[20:21], 0
    s_cselect_b32 s83, 1, 0
    s_barrier
    s_cmp_lt_u32 s19, 6
    s_cselect_b32 s14, s83, 0
    s_cmp_eq_u32 s14, 0
    s_cbranch_scc1 L_p3_epi2
L_p4w_1:
    s_add_u32 m0, s52, 0
    s_add_u32 s54, s54, 1
    buffer_load_dwordx4 v2, s[88:91], s48 offen sc1 lds
    s_add_u32 m0, s52, 2048
    s_add_u32 s48, s48, s53
    buffer_load_dwordx4 v2, s[88:91], s48 offen sc1 lds
    s_add_u32 m0, s52, 4096
    s_add_u32 s48, s48, s53
    buffer_load_dwordx4 v2, s[88:91], s48 offen sc1 lds
    s_add_u32 m0, s52, 6144
    s_add_u32 s48, s48, s53
    buffer_load_dwordx4 v2, s[88:91], s48 offen sc1 lds
    s_add_u32 s48, s48, s53
    s_add_u32 s52, s52, 8192
    s_and_b32 s52, s52, 131071
    s_cmp_eq_u32 s54, 10
    s_cselect_b32 s48, s49, s48
    s_cmp_eq_u32 s54, 20
    s_cselect_b32 s48, s50, s48
    s_cmp_eq_u32 s54, 30
    s_cselect_b32 s48, s51, s48
    s_cselect_b32 s53, 2048, s53
    s_cmp_lt_u32 s54, 4
    s_cbranch_scc1 L_p4w_1
    s_branch L_p3_epi2
L_p3_C:
    s_waitcnt lgkmcnt(0)
    s_mov_b32 s28, s4
    s_mov_b32 s29, s5
    s_mov_b32 s30, 2621440
    s_mov_b32 s31, 0x00020000
    v_and_b32 v12, 7, v0
    v_lshrrev_b32 v13, 3, v0
    s_lshl_b32 s14, s19, 3
    v_add_u32 v14, s14, v12
    v_mul_u32_u24 v5, 336, v14
    v_lshl_add_u32 v5, v13, 5, v5
    v_add_u32 v5, 102400, v5
    v_mul_u32_u24 v7, 1280, v14
    v_lshl_add_u32 v7, v13, 4, v7
    v_lshlrev_b32 v9, 9, v13
    v_lshl_add_u32 v9, v12, 4, v9
    v_lshlrev_b32 v10, 3, v0
    v_cmp_gt_u32 vcc, 16, v0
    v_mov_b32 v15, 1073741824
    s_mul_i32 s14, s16, 81920
    s_mul_i32 s15, s17, 160
    s_add_u32 s14, s14, s15
    v_cndmask_b32 v8, v15, v7, vcc
    buffer_load_dwordx4 v[24:27], v7, s[28:31], s14 offen
    buffer_load_dwordx4 v[28:31], v8, s[28:31], s14 offen offset:128
    s_and_b32 s40, s19, 1
    s_lshr_b32 s41, s19, 1
    s_mul_i32 s14, s41, 51200
    v_add_u32 v3, s14, v2
    s_lshl_b32 s14, s16, 2
    s_lshl_b32 s15, s40, 1
    s_add_u32 s14, s14, s15
    s_mul_i32 s42, s14, 20480
    s_mul_i32 s15, s41, 10240
    s_add_u32 s42, s42, s15
    s_add_u32 s42, s42, 8388608
    v_and_b32 v12, 31, v0
    v_lshlrev_b32 v12, 3, v12
    s_lshr_b32 s14, s16, 2
    s_lshl_b32 s14, s14, 8
    s_add_u32 s14, s14, 34611200
    s_lshl_b32 s43, s2, 3
    s_add_u32 s43, s43, 34627584
    s_mov_b32 s15, 16384
    buffer_load_dwordx2 v[14:15], v12, s[96:99], s14 offen sc1
    s_sleep 2
L_poll8:
    buffer_load_dwordx2 v[16:17], v12, s[96:99], s14 offen sc1
    s_waitcnt vmcnt(1)
    v_cmp_ne_u64 vcc, s[92:93], v[14:15]
    s_sub_u32 s15, s15, 1
    s_cbranch_scc1 L_poll8_ok
    s_cmp_eq_u64 vcc, 0
    s_cbranch_scc1 L_poll8_ok
    s_sleep 0
    buffer_load_dwordx2 v[14:15], v12, s[96:99], s14 offen sc1
    s_waitcnt vmcnt(1)
    v_cmp_ne_u64 vcc, s[92:93], v[16:17]
    s_sub_u32 s15, s15, 1
    s_cbranch_scc1 L_poll8_ok
    s_cmp_eq_u64 vcc, 0
    s_cbranch_scc1 L_poll8_ok
    s_sleep 0
    s_branch L_poll8
L_poll8_ok:
    v_lshlrev_b32 v4, 3, v0
    s_add_u32 s14, s42, 0
    buffer_load_dwordx4 v[112:115], v2, s[88:91], s14 offen offset:0 sc1
    s_add_u32 s14, s42, 20480
    buffer_load_dwordx4 v[116:119], v2, s[88:91], s14 offen offset:0 sc1
    s_add_u32 s14, s42, 0
    buffer_load_dwordx4 v[120:123], v2, s[88:91], s14 offen offset:1024 sc1
    s_add_u32 s14, s42, 20480
    buffer_load_dwordx4 v[124:127], v2, s[88:91], s14 offen offset:1024 sc1
    s_add_u32 s14, s42, 0
    buffer_load_dwordx4 v[128:131], v2, s[88:91], s14 offen offset:2048 sc1
    s_add_u32 s14, s42, 20480
    buffer_load_dwordx4 v[132:135], v2, s[88:91], s14 offen offset:2048 sc1
    s_add_u32 s14, s42, 0
    buffer_load_dwordx4 v[136:139], v2, s[88:91], s14 offen offset:3072 sc1
    s_add_u32 s14, s42, 20480
    buffer_load_dwordx4 v[140:143], v2, s[88:91], s14 offen offset:3072 sc1
    s_add_u32 s14, s42, 4096
    buffer_load_dwordx2 v[144:145], v4, s[88:91], s14 offen offset:0 sc1
    buffer_load_dwordx2 v[146:147], v4, s[88:91], s14 offen offset:512 sc1
    s_add_u32 s14, s42, 24576
    buffer_load_dwordx2 v[148:149], v4, s[88:91], s14 offen offset:0 sc1
    buffer_load_dwordx2 v[150:151], v4, s[88:91], s14 offen offset:512 sc1
    s_barrier
    ds_read_b128 v[72:75], v3 offset:0
    ds_read_b128 v[76:79], v3 offset:1024
    ds_read_b128 v[80:83], v3 offset:2048
    ds_read_b128 v[84:87], v3 offset:3072
    ds_read_b128 v[88:91], v3 offset:4096
    s_waitcnt vmcnt(10)
    s_waitcnt lgkmcnt(4)
    v_mfma_f32_16x16x32_bf16 v[32:35], v[72:75], v[112:115], 0
    v_mfma_f32_16x16x32_bf16 v[36:39], v[72:75], v[116:119], 0
    ds_read_b128 v[72:75], v3 offset:5120
    s_add_u32 s14, s42, 4096
    buffer_load_dwordx4 v[152:155], v2, s[88:91], s14 offen offset:1024 sc1
    s_add_u32 s14, s42, 24576
    buffer_load_dwordx4 v[156:159], v2, s[88:91], s14 offen offset:1024 sc1
    s_waitcnt lgkmcnt(4)
    v_mfma_f32_16x16x32_bf16 v[40:43], v[76:79], v[112:115], 0
    v_mfma_f32_16x16x32_bf16 v[44:47], v[76:79], v[116:119], 0
    ds_read_b128 v[76:79], v3 offset:6144
    s_waitcnt lgkmcnt(4)
    v_mfma_f32_16x16x32_bf16 v[48:51], v[80:83], v[112:115], 0
    v_mfma_f32_16x16x32_bf16 v[52:55], v[80:83], v[116:119], 0
    ds_read_b128 v[80:83], v3 offset:7168
    s_waitcnt lgkmcnt(4)
    v_mfma_f32_16x16x32_bf16 v[56:59], v[84:87], v[112:115], 0
    v_mfma_f32_16x16x32_bf16 v[60:63], v[84:87], v[116:119], 0
    ds_read_b128 v[84:87], v3 offset:8192
    s_waitcnt lgkmcnt(4)
    v_mfma_f32_16x16x32_bf16 v[64:67], v[88:91], v[112:115], 0
    v_mfma_f32_16x16x32_bf16 v[68:71], v[88:91], v[116:119], 0
    ds_read_b128 v[88:91], v3 offset:9216
    s_waitcnt vmcnt(10)
    s_waitcnt lgkmcnt(4)
    v_mfma_f32_16x16x32_bf16 v[32:35], v[72:75], v[120:123], v[32:35]
    v_mfma_f32_16x16x32_bf16 v[36:39], v[72:75], v[124:127], v[36:39]
    ds_read_b128 v[72:75], v3 offset:10240
    s_add_u32 s14, s42, 4096
    buffer_load_dwordx4 v[160:163], v2, s[88:91], s14 offen offset:2048 sc1
    s_add_u32 s14, s42, 24576
    buffer_load_dwordx4 v[164:167], v2, s[88:91], s14 offen offset:2048 sc1
    s_waitcnt lgkmcnt(4)
    v_mfma_f32_16x16x32_bf16 v[40:43], v[76:79], v[120:123], v[40:43]
    v_mfma_f32_16x16x32_bf16 v[44:47], v[76:79], v[124:127], v[44:47]
    ds_read_b128 v[76:79], v3 offset:11264
    s_waitcnt lgkmcnt(4)
    v_mfma_f32_16x16x32_bf16 v[48:51], v[80:83], v[120:123], v[48:51]
    v_mfma_f32_16x16x32_bf16 v[52:55], v[80:83], v[124:127], v[52:55]
    ds_read_b128 v[80:83], v3 offset:12288
    s_waitcnt lgkmcnt(4)
    v_mfma_f32_16x16x32_bf16 v[56:59], v[84:87], v[120:123], v[56:59]
    v_mfma_f32_16x16x32_bf16 v[60:63], v[84:87], v[124:127], v[60:63]
    ds_read_b128 v[84:87], v3 offset:13312
    s_waitcnt lgkmcnt(4)
    v_mfma_f32_16x16x32_bf16 v[64:67], v[88:91], v[120:123], v[64:67]
    v_mfma_f32_16x16x32_bf16 v[68:71], v[88:91], v[124:127], v[68:71]
    ds_read_b128 v[88:91], v3 offset:14336
    s_waitcnt vmcnt(10)
    s_waitcnt lgkmcnt(4)
    v_mfma_f32_16x16x32_bf16 v[32:35], v[72:75], v[128:131], v[32:35]
    v_mfma_f32_16x16x32_bf16 v[36:39], v[72:75], v[132:135], v[36:39]
    ds_read_b128 v[72:75], v3 offset:15360
    s_add_u32 s14, s42, 4096
    buffer_load_dwordx4 v[168:171], v2, s[88:91], s14 offen offset:3072 sc1
    s_add_u32 s14, s42, 24576
    buffer_load_dwordx4 v[172:175], v2, s[88:91], s14 offen offset:3072 sc1
    s_waitcnt lgkmcnt(4)
    v_mfma_f32_16x16x32_bf16 v[40:43], v[76:79], v[128:131], v[40:43]
    v_mfma_f32_16x16x32_bf16 v[44:47], v[76:79], v[132:135], v[44:47]
    ds_read_b128 v[76:79], v3 offset:16384
    s_waitcnt lgkmcnt(4)
    v_mfma_f32_16x16x32_bf16 v[48:51], v[80:83], v[128:131], v[48:51]
    v_mfma_f32_16x16x32_bf16 v[52:55], v[80:83], v[132:135], v[52:55]
    ds_read_b128 v[80:83], v3 offset:17408
    s_waitcnt lgkmcnt(4)
    v_mfma_f32_16x16x32_bf16 v[56:59], v[84:87], v[128:131], v[56:59]
    v_mfma_f32_16x16x32_bf16 v[60:63], v[84:87], v[132:135], v[60:63]
    ds_read_b128 v[84:87], v3 offset:18432
    s_waitcnt lgkmcnt(4)
    v_mfma_f32_16x16x32_bf16 v[64:67], v[88:91], v[128:131], v[64:67]
    v_mfma_f32_16x16x32_bf16 v[68:71], v[88:91], v[132:135], v[68:71]
    ds_read_b128 v[88:91], v3 offset:19456
    s_waitcnt vmcnt(10)
    s_waitcnt lgkmcnt(4)
    v_mfma_f32_16x16x32_bf16 v[32:35], v[72:75], v[136:139], v[32:35]
    v_mfma_f32_16x16x32_bf16 v[36:39], v[72:75], v[140:143], v[36:39]
    ds_read_b128 v[72:75], v3 offset:20480
    s_add_u32 s14, s42, 8192
    buffer_load_dwordx4 v[176:179], v2, s[88:91], s14 offen offset:0 sc1
    s_add_u32 s14, s42, 28672
    buffer_load_dwordx4 v[180:183], v2, s[88:91], s14 offen offset:0 sc1
    s_waitcnt lgkmcnt(4)
    v_mfma_f32_16x16x32_bf16 v[40:43], v[76:79], v[136:139], v[40:43]
    v_mfma_f32_16x16x32_bf16 v[44:47], v[76:79], v[140:143], v[44:47]
    ds_read_b128 v[76:79], v3 offset:21504
    s_waitcnt lgkmcnt(4)
    v_mfma_f32_16x16x32_bf16 v[48:51], v[80:83], v[136:139], v[48:51]
    v_mfma_f32_16x16x32_bf16 v[52:55], v[80:83], v[140:143], v[52:55]
    ds_read_b128 v[80:83], v3 offset:22528
    s_waitcnt lgkmcnt(4)
    v_mfma_f32_16x16x32_bf16 v[56:59], v[84:87], v[136:139], v[56:59]
    v_mfma_f32_16x16x32_bf16 v[60:63], v[84:87], v[140:143], v[60:63]
    ds_read_b128 v[84:87], v3 offset:23552
    s_waitcnt lgkmcnt(4)
    v_mfma_f32_16x16x32_bf16 v[64:67], v[88:91], v[136:139], v[64:67]
    v_mfma_f32_16x16x32_bf16 v[68:71], v[88:91], v[140:143], v[68:71]
    ds_read_b128 v[88:91], v3 offset:24576
    s_waitcnt vmcnt(8)
    s_waitcnt lgkmcnt(4)
    v_mfma_f32_16x16x32_bf16 v[32:35], v[72:75], v[144:147], v[32:35]
    v_mfma_f32_16x16x32_bf16 v[36:39], v[72:75], v[148:151], v[36:39]
    ds_read_b128 v[72:75], v3 offset:25600
    s_add_u32 s14, s42, 8192
    buffer_load_dwordx2 v[184:185], v4, s[88:91], s14 offen offset:1024 sc1
    buffer_load_dwordx2 v[186:187], v4, s[88:91], s14 offen offset:1536 sc1
    s_add_u32 s14, s42, 28672
    buffer_load_dwordx2 v[188:189], v4, s[88:91], s14 offen offset:1024 sc1
    buffer_load_dwordx2 v[190:191], v4, s[88:91], s14 offen offset:1536 sc1
    s_waitcnt lgkmcnt(4)
    v_mfma_f32_16x16x32_bf16 v[40:43], v[76:79], v[144:147], v[40:43]
    v_mfma_f32_16x16x32_bf16 v[44:47], v[76:79], v[148:151], v[44:47]
    ds_read_b128 v[76:79], v3 offset:26624
    s_waitcnt lgkmcnt(4)
    v_mfma_f32_16x16x32_bf16 v[48:51], v[80:83], v[144:147], v[48:51]
    v_mfma_f32_16x16x32_bf16 v[52:55], v[80:83], v[148:151], v[52:55]
    ds_read_b128 v[80:83], v3 offset:27648
    s_waitcnt lgkmcnt(4)
    v_mfma_f32_16x16x32_bf16 v[56:59], v[84:87], v[144:147], v[56:59]
    v_mfma_f32_16x16x32_bf16 v[60:63], v[84:87], v[148:151], v[60:63]
    ds_read_b128 v[84:87], v3 offset:28672
    s_waitcnt lgkmcnt(4)
    v_mfma_f32_16x16x32_bf16 v[64:67], v[88:91], v[144:147], v[64:67]
    v_mfma_f32_16x16x32_bf16 v[68:71], v[88:91], v[148:151], v[68:71]
    ds_read_b128 v[88:91], v3 offset:29696
    s_waitcnt vmcnt(10)
    s_waitcnt lgkmcnt(4)
    v_mfma_f32_16x16x32_bf16 v[32:35], v[72:75], v[152:155], v[32:35]
    v_mfma_f32_16x16x32_bf16 v[36:39], v[72:75], v[156:159], v[36:39]
    ds_read_b128 v[72:75], v3 offset:30720
    s_waitcnt lgkmcnt(4)
    v_mfma_f32_16x16x32_bf16 v[40:43], v[76:79], v[152:155], v[40:43]
    v_mfma_f32_16x16x32_bf16 v[44:47], v[76:79], v[156:159], v[44:47]
    ds_read_b128 v[76:79], v3 offset:31744
    s_waitcnt lgkmcnt(4)
    v_mfma_f32_16x16x32_bf16 v[48:51], v[80:83], v[152:155], v[48:51]
    v_mfma_f32_16x16x32_bf16 v[52:55], v[80:83], v[156:159], v[52:55]
    ds_read_b128 v[80:83], v3 offset:32768
    s_waitcnt lgkmcnt(4)
    v_mfma_f32_16x16x32_bf16 v[56:59], v[84:87], v[152:155], v[56:59]
    v_mfma_f32_16x16x32_bf16 v[60:63], v[84:87], v[156:159], v[60:63]
    ds_read_b128 v[84:87], v3 offset:33792
    s_waitcnt lgkmcnt(4)
    v_mfma_f32_16x16x32_bf16 v[64:67], v[88:91], v[152:155], v[64:67]
    v_mfma_f32_16x16x32_bf16 v[68:71], v[88:91], v[156:159], v[68:71]
    ds_read_b128 v[88:91], v3 offset:34816
    s_waitcnt vmcnt(8)
    s_waitcnt lgkmcnt(4)
    v_mfma_f32_16x16x32_bf16 v[32:35], v[72:75], v[160:163], v[32:35]
    v_mfma_f32_16x16x32_bf16 v[36:39], v[72:75], v[164:167], v[36:39]
    ds_read_b128 v[72:75], v3 offset:35840
    s_waitcnt lgkmcnt(4)
    v_mfma_f32_16x16x32_bf16 v[40:43], v[76:79], v[160:163], v[40:43]
    v_mfma_f32_16x16x32_bf16 v[44:47], v[76:79], v[164:167], v[44:47]
    ds_read_b128 v[76:79], v3 offset:36864
    s_waitcnt lgkmcnt(4)
    v_mfma_f32_16x16x32_bf16 v[48:51], v[80:83], v[160:163], v[48:51]
    v_mfma_f32_16x16x32_bf16 v[52:55], v[80:83], v[164:167], v[52:55]
    ds_read_b128 v[80:83], v3 offset:37888
    s_waitcnt lgkmcnt(4)
    v_mfma_f32_16x16x32_bf16 v[56:59], v[84:87], v[160:163], v[56:59]
    v_mfma_f32_16x16x32_bf16 v[60:63], v[84:87], v[164:167], v[60:63]
    ds_read_b128 v[84:87], v3 offset:38912
    s_waitcnt lgkmcnt(4)
    v_mfma_f32_16x16x32_bf16 v[64:67], v[88:91], v[160:163], v[64:67]
    v_mfma_f32_16x16x32_bf16 v[68:71], v[88:91], v[164:167], v[68:71]
    ds_read_b128 v[88:91], v3 offset:39936
    s_waitcnt vmcnt(6)
    s_waitcnt lgkmcnt(4)
    v_mfma_f32_16x16x32_bf16 v[32:35], v[72:75], v[168:171], v[32:35]
    v_mfma_f32_16x16x32_bf16 v[36:39], v[72:75], v[172:175], v[36:39]
    ds_read_b128 v[72:75], v3 offset:40960
    s_waitcnt lgkmcnt(4)
    v_mfma_f32_16x16x32_bf16 v[40:43], v[76:79], v[168:171], v[40:43]
    v_mfma_f32_16x16x32_bf16 v[44:47], v[76:79], v[172:175], v[44:47]
    ds_read_b128 v[76:79], v3 offset:41984
    s_waitcnt lgkmcnt(4)
    v_mfma_f32_16x16x32_bf16 v[48:51], v[80:83], v[168:171], v[48:51]
    v_mfma_f32_16x16x32_bf16 v[52:55], v[80:83], v[172:175], v[52:55]
    ds_read_b128 v[80:83], v3 offset:43008
    s_waitcnt lgkmcnt(4)
    v_mfma_f32_16x16x32_bf16 v[56:59], v[84:87], v[168:171], v[56:59]
    v_mfma_f32_16x16x32_bf16 v[60:63], v[84:87], v[172:175], v[60:63]
    ds_read_b128 v[84:87], v3 offset:44032
    s_waitcnt lgkmcnt(4)
    v_mfma_f32_16x16x32_bf16 v[64:67], v[88:91], v[168:171], v[64:67]
    v_mfma_f32_16x16x32_bf16 v[68:71], v[88:91], v[172:175], v[68:71]
    ds_read_b128 v[88:91], v3 offset:45056
    s_waitcnt vmcnt(4)
    s_waitcnt lgkmcnt(4)
    v_mfma_f32_16x16x32_bf16 v[32:35], v[72:75], v[176:179], v[32:35]
    v_mfma_f32_16x16x32_bf16 v[36:39], v[72:75], v[180:183], v[36:39]
    ds_read_b128 v[72:75], v3 offset:46080
    s_waitcnt lgkmcnt(4)
    v_mfma_f32_16x16x32_bf16 v[40:43], v[76:79], v[176:179], v[40:43]
    v_mfma_f32_16x16x32_bf16 v[44:47], v[76:79], v[180:183], v[44:47]
    ds_read_b128 v[76:79], v3 offset:47104
    s_waitcnt lgkmcnt(4)
    v_mfma_f32_16x16x32_bf16 v[48:51], v[80:83], v[176:179], v[48:51]
    v_mfma_f32_16x16x32_bf16 v[52:55], v[80:83], v[180:183], v[52:55]
    ds_read_b128 v[80:83], v3 offset:48128
    s_waitcnt lgkmcnt(4)
    v_mfma_f32_16x16x32_bf16 v[56:59], v[84:87], v[176:179], v[56:59]
    v_mfma_f32_16x16x32_bf16 v[60:63], v[84:87], v[180:183], v[60:63]
    ds_read_b128 v[84:87], v3 offset:49152
    s_waitcnt lgkmcnt(4)
    v_mfma_f32_16x16x32_bf16 v[64:67], v[88:91], v[176:179], v[64:67]
    v_mfma_f32_16x16x32_bf16 v[68:71], v[88:91], v[180:183], v[68:71]
    ds_read_b128 v[88:91], v3 offset:50176
    s_waitcnt vmcnt(0)
    s_waitcnt lgkmcnt(4)
    v_mfma_f32_16x16x32_bf16 v[32:35], v[72:75], v[184:187], v[32:35]
    v_mfma_f32_16x16x32_bf16 v[36:39], v[72:75], v[188:191], v[36:39]
    s_waitcnt lgkmcnt(3)
    v_mfma_f32_16x16x32_bf16 v[40:43], v[76:79], v[184:187], v[40:43]
    v_mfma_f32_16x16x32_bf16 v[44:47], v[76:79], v[188:191], v[44:47]
    s_waitcnt lgkmcnt(2)
    v_mfma_f32_16x16x32_bf16 v[48:51], v[80:83], v[184:187], v[48:51]
    v_mfma_f32_16x16x32_bf16 v[52:55], v[80:83], v[188:191], v[52:55]
    s_waitcnt lgkmcnt(1)
    v_mfma_f32_16x16x32_bf16 v[56:59], v[84:87], v[184:187], v[56:59]
    v_mfma_f32_16x16x32_bf16 v[60:63], v[84:87], v[188:191], v[60:63]
    s_waitcnt lgkmcnt(0)
    v_mfma_f32_16x16x32_bf16 v[64:67], v[88:91], v[184:187], v[64:67]
    v_mfma_f32_16x16x32_bf16 v[68:71], v[88:91], v[188:191], v[68:71]
    v_and_b32 v12, 15, v0
    s_lshl_b32 s14, s40, 5
    v_add_u32 v12, s14, v12
    v_mul_u32_u24 v12, 336, v12
    v_lshrrev_b32 v13, 4, v0
    v_lshl_add_u32 v12, v13, 4, v12
    s_mul_i32 s14, s41, 21504
    s_add_u32 s14, s14, 102400
    v_add_u32 v12, s14, v12
    s_nop 1
    ds_write_b128 v12, v[32:35] offset:0
    ds_write_b128 v12, v[36:39] offset:5376
    ds_write_b128 v12, v[40:43] offset:64
    ds_write_b128 v12, v[44:47] offset:5440
    ds_write_b128 v12, v[48:51] offset:128
    ds_write_b128 v12, v[52:55] offset:5504
    ds_write_b128 v12, v[56:59] offset:192
    ds_write_b128 v12, v[60:63] offset:5568
    ds_write_b128 v12, v[64:67] offset:256
    ds_write_b128 v12, v[68:71] offset:5632
    s_waitcnt lgkmcnt(0)
L_p3_epi:
    s_barrier
L_p3_epi2:
    ds_read_b128 v[32:35], v5 offset:0
    ds_read_b128 v[36:39], v5 offset:16
    ds_read_b128 v[40:43], v5 offset:21504
    ds_read_b128 v[44:47], v5 offset:21520
    ds_read_b128 v[48:51], v5 offset:256
    ds_read_b128 v[52:55], v5 offset:272
    ds_read_b128 v[56:59], v5 offset:21760
    ds_read_b128 v[60:63], v5 offset:21776
    s_mov_b32 s46, 0xffff0000
    s_lshl_b32 s14, s16, 1
    s_lshr_b32 s15, s19, 2
    s_add_u32 s14, s14, s15
    s_mul_i32 s42, s14, 40960
    s_mul_i32 s15, s17, 5120
    s_add_u32 s42, s42, s15
    s_and_b32 s15, s19, 3
    s_lshl_b32 s18, s15, 7
    s_add_u32 s42, s42, s18
    s_add_u32 s42, s42, 11534336
    s_add_u32 s43, s42, 4096
    s_lshl_b32 s14, s14, 3
    s_add_u32 s14, s14, s17
    s_lshl_b32 s44, s14, 9
    s_lshl_b32 s15, s15, 7
    s_add_u32 s44, s44, s15
    s_add_u32 s44, s44, 14680064
    s_lshl_b32 s45, s16, 3
    s_add_u32 s45, s45, s17
    s_lshl_b32 s45, s45, 3
    s_add_u32 s45, s45, 34615296
    v_mov_b32 v18, 0
    v_mov_b32 v19, 0
    s_waitcnt lgkmcnt(4)
    v_pk_add_f32 v[32:33], v[32:33], v[40:41]
    v_lshlrev_b32 v20, 16, v24
    v_and_b32 v21, s46, v24
    v_pk_add_f32 v[32:33], v[32:33], v[20:21]
    v_cvt_pk_bf16_f32 v64, v32, v33
    v_pk_add_f32 v[34:35], v[34:35], v[42:43]
    v_lshlrev_b32 v20, 16, v25
    v_and_b32 v21, s46, v25
    v_pk_add_f32 v[34:35], v[34:35], v[20:21]
    v_cvt_pk_bf16_f32 v65, v34, v35
    v_pk_add_f32 v[36:37], v[36:37], v[44:45]
    v_lshlrev_b32 v20, 16, v26
    v_and_b32 v21, s46, v26
    v_pk_add_f32 v[36:37], v[36:37], v[20:21]
    v_cvt_pk_bf16_f32 v66, v36, v37
    v_pk_add_f32 v[38:39], v[38:39], v[46:47]
    v_lshlrev_b32 v20, 16, v27
    v_and_b32 v21, s46, v27
    v_pk_add_f32 v[38:39], v[38:39], v[20:21]
    v_cvt_pk_bf16_f32 v67, v38, v39
    buffer_store_dwordx4 v[64:67], v9, s[88:91], s42 offen sc1
    v_lshlrev_b32 v72, 16, v64
    v_and_b32 v73, s46, v64
    v_add_f32 v18, v18, v72
    v_add_f32 v18, v18, v73
    v_lshlrev_b32 v74, 16, v65
    v_and_b32 v75, s46, v65
    v_add_f32 v18, v18, v74
    v_add_f32 v18, v18, v75
    v_lshlrev_b32 v76, 16, v66
    v_and_b32 v77, s46, v66
    v_add_f32 v18, v18, v76
    v_add_f32 v18, v18, v77
    v_lshlrev_b32 v78, 16, v67
    v_and_b32 v79, s46, v67
    v_add_f32 v18, v18, v78
    v_add_f32 v18, v18, v79
    s_waitcnt lgkmcnt(0)
    s_mov_b32 exec_lo, 0xffff
    s_mov_b32 exec_hi, 0
    v_pk_add_f32 v[48:49], v[48:49], v[56:57]
    v_lshlrev_b32 v20, 16, v28
    v_and_b32 v21, s46, v28
    v_pk_add_f32 v[48:49], v[48:49], v[20:21]
    v_cvt_pk_bf16_f32 v68, v48, v49
    v_pk_add_f32 v[50:51], v[50:51], v[58:59]
    v_lshlrev_b32 v20, 16, v29
    v_and_b32 v21, s46, v29
    v_pk_add_f32 v[50:51], v[50:51], v[20:21]
    v_cvt_pk_bf16_f32 v69, v50, v51
    v_pk_add_f32 v[52:53], v[52:53], v[60:61]
    v_lshlrev_b32 v20, 16, v30
    v_and_b32 v21, s46, v30
    v_pk_add_f32 v[52:53], v[52:53], v[20:21]
    v_cvt_pk_bf16_f32 v70, v52, v53
    v_pk_add_f32 v[54:55], v[54:55], v[62:63]
    v_lshlrev_b32 v20, 16, v31
    v_and_b32 v21, s46, v31
    v_pk_add_f32 v[54:55], v[54:55], v[20:21]
    v_cvt_pk_bf16_f32 v71, v54, v55
    buffer_store_dwordx4 v[68:71], v9, s[88:91], s43 offen sc1
    v_lshlrev_b32 v80, 16, v68
    v_and_b32 v81, s46, v68
    v_add_f32 v18, v18, v80
    v_add_f32 v18, v18, v81
    v_lshlrev_b32 v82, 16, v69
    v_and_b32 v83, s46, v69
    v_add_f32 v18, v18, v82
    v_add_f32 v18, v18, v83
    v_lshlrev_b32 v84, 16, v70
    v_and_b32 v85, s46, v70
    v_add_f32 v18, v18, v84
    v_add_f32 v18, v18, v85
    v_lshlrev_b32 v86, 16, v71
    v_and_b32 v87, s46, v71
    v_add_f32 v18, v18, v86
    v_add_f32 v18, v18, v87
    s_mov_b64 exec, -1
    s_nop 1
    v_add_f32_dpp v18, v18, v18 row_ror:8 row_mask:0xf bank_mask:0xf
    v_mov_b32 v20, v18
    s_nop 1
    v_permlane32_swap_b32 v18, v20
    s_nop 1
    v_add_f32 v18, v18, v20
    v_mov_b32 v20, v18
    s_nop 1
    v_permlane16_swap_b32 v18, v20
    s_nop 1
    v_add_f32 v18, v18, v20
    v_mul_f32 v21, 0xbc4ccccd, v18
    v_add_f32 v72, v72, v21
    v_fmac_f32 v19, v72, v72
    v_add_f32 v73, v73, v21
    v_fmac_f32 v19, v73, v73
    v_add_f32 v74, v74, v21
    v_fmac_f32 v19, v74, v74
    v_add_f32 v75, v75, v21
    v_fmac_f32 v19, v75, v75
    v_add_f32 v76, v76, v21
    v_fmac_f32 v19, v76, v76
    v_add_f32 v77, v77, v21
    v_fmac_f32 v19, v77, v77
    v_add_f32 v78, v78, v21
    v_fmac_f32 v19, v78, v78
    v_add_f32 v79, v79, v21
    v_fmac_f32 v19, v79, v79
    s_mov_b32 exec_lo, 0xffff
    s_mov_b32 exec_hi, 0
    v_add_f32 v80, v80, v21
    v_fmac_f32 v19, v80, v80
    v_add_f32 v81, v81, v21
    v_fmac_f32 v19, v81, v81
    v_add_f32 v82, v82, v21
    v_fmac_f32 v19, v82, v82
    v_add_f32 v83, v83, v21
    v_fmac_f32 v19, v83, v83
    v_add_f32 v84, v84, v21
    v_fmac_f32 v19, v84, v84
    v_add_f32 v85, v85, v21
    v_fmac_f32 v19, v85, v85
    v_add_f32 v86, v86, v21
    v_fmac_f32 v19, v86, v86
    v_add_f32 v87, v87, v21
    v_fmac_f32 v19, v87, v87
    s_mov_b64 exec, -1
    s_nop 1
    v_add_f32_dpp v19, v19, v19 row_ror:8 row_mask:0xf bank_mask:0xf
    v_mov_b32 v20, v19
    s_nop 1
    v_permlane32_swap_b32 v19, v20
    s_nop 1
    v_add_f32 v19, v19, v20
    v_mov_b32 v20, v19
    s_nop 1
    v_permlane16_swap_b32 v19, v20
    s_nop 1
    v_add_f32 v19, v19, v20
    s_mov_b32 exec_lo, 0xffff
    s_mov_b32 exec_hi, 0
    buffer_store_dwordx2 v[18:19], v10, s[88:91], s44 offen sc1
    s_mov_b64 exec, -1
    s_waitcnt vmcnt(0)
    s_barrier
    s_cmp_lg_u32 s19, 0
    s_cbranch_scc1 L_p3_end
    v_mov_b32 v2, s92
    v_mov_b32 v3, s93
    v_mbcnt_lo_u32_b32 v4, -1, 0
    v_mul_u32_u24 v4, 69888, v4
    s_mov_b64 exec, 255
    buffer_store_dwordx2 v[2:3], v4, s[88:91], s45 offen sc1
    s_mov_b64 exec, -1
L_p3_end:
    s_and_b32 s14, s2, 7
    s_lshr_b32 s15, s2, 3
    s_lshr_b32 s16, s14, 2
    s_lshl_b32 s16, s16, 3
    s_lshr_b32 s17, s15, 2
    s_add_u32 s16, s16, s17
    s_and_b32 s17, s14, 3
    s_lshl_b32 s17, s17, 2
    s_and_b32 s18, s15, 3
    s_add_u32 s17, s17, s18
    s_mov_b32 s19, s94
    s_lshl_b32 s46, s16, 4
    s_add_u32 s46, s46, s17
    s_lshl_b32 s46, s46, 3
    v_lshlrev_b32 v2, 4, v0
    s_cmp_lt_u32 s19, 4
    s_cbranch_scc1 L_p4_C
    s_cmp_eq_u32 s19, 6
    s_cbranch_scc1 L_p4_L6
    s_cmp_eq_u32 s83, 1
    s_cbranch_scc1 L_p4_fp2ok
    v_lshlrev_b32 v6, 3, v0
    s_mov_b32 s14, 34627584
    s_mov_b32 s15, 16384
L_poll9:
    buffer_load_dwordx2 v[8:9], v6, s[96:99], s14 offen offset:0 sc1
    buffer_load_dwordx2 v[10:11], v6, s[96:99], s14 offen offset:512 sc1
    buffer_load_dwordx2 v[12:13], v6, s[96:99], s14 offen offset:1024 sc1
    buffer_load_dwordx2 v[14:15], v6, s[96:99], s14 offen offset:1536 sc1
    s_waitcnt vmcnt(0)
    v_xor_b32 v10, s92, v10
    v_xor_b32 v11, s93, v11
    v_or_b32 v10, v10, v11
    v_cmp_ne_u32 vcc, 0, v10
    s_nop 1
    v_cndmask_b32 v8, v8, 0, vcc
    v_xor_b32 v12, s92, v12
    v_xor_b32 v13, s93, v13
    v_or_b32 v12, v12, v13
    v_cmp_ne_u32 vcc, 0, v12
    s_nop 1
    v_cndmask_b32 v8, v8, 0, vcc
    v_xor_b32 v14, s92, v14
    v_xor_b32 v15, s93, v15
    v_or_b32 v14, v14, v15
    v_cmp_ne_u32 vcc, 0, v14
    s_nop 1
    v_cndmask_b32 v8, v8, 0, vcc
    v_cmp_ne_u64 vcc, s[92:93], v[8:9]
    s_sub_u32 s15, s15, 1
    s_cbranch_scc1 L_poll9_ok
    s_cmp_eq_u64 vcc, 0
    s_cbranch_scc1 L_poll9_ok
    s_sleep 1
    s_branch L_poll9
L_poll9_ok:
L_p4_fp2ok:
    s_cmp_eq_u32 s19, 7
    s_cbranch_scc1 L_p4_L7
L_p4w_2:
    s_add_u32 m0, s52, 0
    s_add_u32 s54, s54, 1
    buffer_load_dwordx4 v2, s[88:91], s48 offen sc1 lds
    s_add_u32 m0, s52, 2048
    s_add_u32 s48, s48, s53
    buffer_load_dwordx4 v2, s[88:91], s48 offen sc1 lds
    s_add_u32 m0, s52, 4096
    s_add_u32 s48, s48, s53
    buffer_load_dwordx4 v2, s[88:91], s48 offen sc1 lds
    s_add_u32 m0, s52, 6144
    s_add_u32 s48, s48, s53
    buffer_load_dwordx4 v2, s[88:91], s48 offen sc1 lds
    s_add_u32 s48, s48, s53
    s_add_u32 s52, s52, 8192
    s_and_b32 s52, s52, 131071
    s_cmp_eq_u32 s54, 10
    s_cselect_b32 s48, s49, s48
    s_cmp_eq_u32 s54, 20
    s_cselect_b32 s48, s50, s48
    s_cmp_eq_u32 s54, 30
    s_cselect_b32 s48, s51, s48
    s_cselect_b32 s53, 2048, s53
    s_cmp_lt_u32 s54, 12
    s_cbranch_scc1 L_p4w_2
    s_waitcnt vmcnt(32)
    s_barrier
L_p4w_3:
    s_add_u32 m0, s52, 0
    s_add_u32 s54, s54, 1
    buffer_load_dwordx4 v2, s[88:91], s48 offen sc1 lds
    s_add_u32 m0, s52, 2048
    s_add_u32 s48, s48, s53
    buffer_load_dwordx4 v2, s[88:91], s48 offen sc1 lds
    s_add_u32 m0, s52, 4096
    s_add_u32 s48, s48, s53
    buffer_load_dwordx4 v2, s[88:91], s48 offen sc1 lds
    s_add_u32 m0, s52, 6144
    s_add_u32 s48, s48, s53
    buffer_load_dwordx4 v2, s[88:91], s48 offen sc1 lds
    s_add_u32 s48, s48, s53
    s_add_u32 s52, s52, 8192
    s_and_b32 s52, s52, 131071
    s_cmp_eq_u32 s54, 10
    s_cselect_b32 s48, s49, s48
    s_cmp_eq_u32 s54, 20
    s_cselect_b32 s48, s50, s48
    s_cmp_eq_u32 s54, 30
    s_cselect_b32 s48, s51, s48
    s_cselect_b32 s53, 2048, s53
    s_cmp_lt_u32 s54, 16
    s_cbranch_scc1 L_p4w_3
    s_waitcnt vmcnt(32)
    s_barrier
    s_waitcnt vmcnt(16)
    s_barrier
    s_mov_b32 s33, 20
L_p4w_loop:
L_p4w_4:
    s_add_u32 m0, s52, 0
    s_add_u32 s54, s54, 1
    buffer_load_dwordx4 v2, s[88:91], s48 offen sc1 lds
    s_add_u32 m0, s52, 2048
    s_add_u32 s48, s48, s53
    buffer_load_dwordx4 v2, s[88:91], s48 offen sc1 lds
    s_add_u32 m0, s52, 4096
    s_add_u32 s48, s48, s53
    buffer_load_dwordx4 v2, s[88:91], s48 offen sc1 lds
    s_add_u32 m0, s52, 6144
    s_add_u32 s48, s48, s53
    buffer_load_dwordx4 v2, s[88:91], s48 offen sc1 lds
    s_add_u32 s48, s48, s53
    s_add_u32 s52, s52, 8192
    s_and_b32 s52, s52, 131071
    s_cmp_eq_u32 s54, 10
    s_cselect_b32 s48, s49, s48
    s_cmp_eq_u32 s54, 20
    s_cselect_b32 s48, s50, s48
    s_cmp_eq_u32 s54, 30
    s_cselect_b32 s48, s51, s48
    s_cselect_b32 s53, 2048, s53
    s_cmp_lt_u32 s54, s33
    s_cbranch_scc1 L_p4w_4
    s_add_u32 s33, s33, 4
    s_cmp_lt_u32 s33, 28
    s_waitcnt vmcnt(16)
    s_barrier
    s_cbranch_scc1 L_p4w_loop
    v_lshlrev_b32 v6, 3, v0
    s_mov_b32 s14, 34631680
    buffer_load_dwordx2 v[8:9], v6, s[96:99], s14 offen offset:0 sc1
    buffer_load_dwordx2 v[10:11], v6, s[96:99], s14 offen offset:512 sc1
    buffer_load_dwordx2 v[12:13], v6, s[96:99], s14 offen offset:1024 sc1
    buffer_load_dwordx2 v[14:15], v6, s[96:99], s14 offen offset:1536 sc1
L_p4w_5:
    s_add_u32 m0, s52, 0
    s_add_u32 s54, s54, 1
    buffer_load_dwordx4 v2, s[88:91], s48 offen sc1 lds
    s_add_u32 m0, s52, 2048
    s_add_u32 s48, s48, s53
    buffer_load_dwordx4 v2, s[88:91], s48 offen sc1 lds
    s_add_u32 m0, s52, 4096
    s_add_u32 s48, s48, s53
    buffer_load_dwordx4 v2, s[88:91], s48 offen sc1 lds
    s_add_u32 m0, s52, 6144
    s_add_u32 s48, s48, s53
    buffer_load_dwordx4 v2, s[88:91], s48 offen sc1 lds
    s_add_u32 s48, s48, s53
    s_add_u32 s52, s52, 8192
    s_and_b32 s52, s52, 131071
    s_cmp_eq_u32 s54, 10
    s_cselect_b32 s48, s49, s48
    s_cmp_eq_u32 s54, 20
    s_cselect_b32 s48, s50, s48
    s_cmp_eq_u32 s54, 30
    s_cselect_b32 s48, s51, s48
    s_cselect_b32 s53, 2048, s53
    s_cmp_lt_u32 s54, 28
    s_cbranch_scc1 L_p4w_5
    s_and_b32 s14, s2, 1
    s_lshl_b32 s14, s14, 2
    s_bfe_u32 s15, s2, 0x20003
    s_add_u32 s14, s14, s15
    s_and_b32 s15, s94, 1
    s_mul_i32 s61, s15, 5120
    s_add_u32 s61, s61, 131072
    s_mul_i32 s56, s14, 276480
    s_lshl_b32 s15, s15, 10
    s_add_u32 s56, s56, s15
    s_add_u32 s56, s56, 30408704
    s_mov_b32 s63, 0
    s_add_u32 s57, s56, 55296
    s_add_u32 s58, s56, 110592
    s_add_u32 s59, s56, 165888
    s_add_u32 s60, s56, 221184
    s_waitcnt vmcnt(16)
    s_barrier
L_p4w_6:
    s_add_u32 m0, s52, 0
    s_add_u32 s54, s54, 1
    buffer_load_dwordx4 v2, s[88:91], s48 offen sc1 lds
    s_add_u32 m0, s52, 2048
    s_add_u32 s48, s48, s53
    buffer_load_dwordx4 v2, s[88:91], s48 offen sc1 lds
    s_add_u32 m0, s52, 4096
    s_add_u32 s48, s48, s53
    buffer_load_dwordx4 v2, s[88:91], s48 offen sc1 lds
    s_add_u32 m0, s52, 6144
    s_add_u32 s48, s48, s53
    buffer_load_dwordx4 v2, s[88:91], s48 offen sc1 lds
    s_add_u32 s48, s48, s53
    s_add_u32 s52, s52, 8192
    s_and_b32 s52, s52, 131071
    s_cmp_eq_u32 s54, 10
    s_cselect_b32 s48, s49, s48
    s_cmp_eq_u32 s54, 20
    s_cselect_b32 s48, s50, s48
    s_cmp_eq_u32 s54, 30
    s_cselect_b32 s48, s51, s48
    s_cselect_b32 s53, 2048, s53
    s_cmp_lt_u32 s54, 32
    s_cbranch_scc1 L_p4w_6
    v_cmp_ne_u64 s[20:21], s[92:93], v[8:9]
    v_cmp_ne_u64 s[22:23], s[92:93], v[10:11]
    v_cmp_ne_u64 s[24:25], s[92:93], v[12:13]
    v_cmp_ne_u64 s[26:27], s[92:93], v[14:15]
    s_nop 1
    s_or_b64 s[20:21], s[20:21], s[22:23]
    s_or_b64 s[24:25], s[24:25], s[26:27]
    s_or_b64 s[20:21], s[20:21], s[24:25]
    s_cmp_eq_u64 s[20:21], 0
    s_cbranch_scc1 L_p4_fp3ok
    s_mov_b32 s14, 34631680
    s_mov_b32 s15, 16384
L_poll10:
    buffer_load_dwordx2 v[8:9], v6, s[96:99], s14 offen offset:0 sc1
    buffer_load_dwordx2 v[10:11], v6, s[96:99], s14 offen offset:512 sc1
    buffer_load_dwordx2 v[12:13], v6, s[96:99], s14 offen offset:1024 sc1
    buffer_load_dwordx2 v[14:15], v6, s[96:99], s14 offen offset:1536 sc1
    s_waitcnt vmcnt(0)
    v_xor_b32 v10, s92, v10
    v_xor_b32 v11, s93, v11
    v_or_b32 v10, v10, v11
    v_cmp_ne_u32 vcc, 0, v10
    s_nop 1
    v_cndmask_b32 v8, v8, 0, vcc
    v_xor_b32 v12, s92, v12
    v_xor_b32 v13, s93, v13
    v_or_b32 v12, v12, v13
    v_cmp_ne_u32 vcc, 0, v12
    s_nop 1
    v_cndmask_b32 v8, v8, 0, vcc
    v_xor_b32 v14, s92, v14
    v_xor_b32 v15, s93, v15
    v_or_b32 v14, v14, v15
    v_cmp_ne_u32 vcc, 0, v14
    s_nop 1
    v_cndmask_b32 v8, v8, 0, vcc
    v_cmp_ne_u64 vcc, s[92:93], v[8:9]
    s_sub_u32 s15, s15, 1
    s_cbranch_scc1 L_poll10_ok
    s_cmp_eq_u64 vcc, 0
    s_cbranch_scc1 L_poll10_ok
    s_sleep 1
    s_branch L_poll10
L_poll10_ok:
L_p4_fp3ok:
    s_add_u32 m0, s61, 0
    s_add_u32 s63, s63, 1
    buffer_load_dwordx4 v2, s[88:91], s56 offen sc1 lds
    s_cmp_eq_u32 s63, 27
    s_cselect_b32 s55, 1073741824, 2048
    s_add_u32 m0, s61, 1024
    s_add_u32 s56, s56, s55
    buffer_load_dwordx4 v2, s[88:91], s57 offen sc1 lds
    s_add_u32 m0, s61, 2048
    s_add_u32 s57, s57, s55
    buffer_load_dwordx4 v2, s[88:91], s58 offen sc1 lds
    s_add_u32 m0, s61, 3072
    s_add_u32 s58, s58, s55
    buffer_load_dwordx4 v2, s[88:91], s59 offen sc1 lds
    s_add_u32 m0, s61, 4096
    s_add_u32 s59, s59, s55
    buffer_load_dwordx4 v2, s[88:91], s60 offen sc1 lds
    s_add_u32 s60, s60, s55
    s_add_u32 s61, s61, 10240
    s_sub_u32 s55, s61, 161792
    s_cmp_lt_u32 s55, 5121
    s_cselect_b32 s55, 4294838272, 0
    s_add_u32 s61, s61, s55
    s_sub_u32 s55, s61, 83968
    s_cmp_lt_u32 s55, 5121
    s_cselect_b32 s55, 47104, 0
    s_add_u32 s61, s61, s55
    s_add_u32 m0, s61, 0
    s_add_u32 s63, s63, 1
    buffer_load_dwordx4 v2, s[88:91], s56 offen sc1 lds
    s_cmp_eq_u32 s63, 27
    s_cselect_b32 s55, 1073741824, 2048
    s_add_u32 m0, s61, 1024
    s_add_u32 s56, s56, s55
    buffer_load_dwordx4 v2, s[88:91], s57 offen sc1 lds
    s_add_u32 m0, s61, 2048
    s_add_u32 s57, s57, s55
    buffer_load_dwordx4 v2, s[88:91], s58 offen sc1 lds
    s_add_u32 m0, s61, 3072
    s_add_u32 s58, s58, s55
    buffer_load_dwordx4 v2, s[88:91], s59 offen sc1 lds
    s_add_u32 m0, s61, 4096
    s_add_u32 s59, s59, s55
    buffer_load_dwordx4 v2, s[88:91], s60 offen sc1 lds
    s_add_u32 s60, s60, s55
    s_add_u32 s61, s61, 10240
    s_sub_u32 s55, s61, 161792
    s_cmp_lt_u32 s55, 5121
    s_cselect_b32 s55, 4294838272, 0
    s_add_u32 s61, s61, s55
    s_sub_u32 s55, s61, 83968
    s_cmp_lt_u32 s55, 5121
    s_cselect_b32 s55, 47104, 0
    s_add_u32 s61, s61, s55
    s_waitcnt vmcnt(26)
    s_barrier
L_p4w_7:
    s_add_u32 m0, s52, 0
    s_add_u32 s54, s54, 1
    buffer_load_dwordx4 v2, s[88:91], s48 offen sc1 lds
    s_add_u32 m0, s52, 2048
    s_add_u32 s48, s48, s53
    buffer_load_dwordx4 v2, s[88:91], s48 offen sc1 lds
    s_add_u32 m0, s52, 4096
    s_add_u32 s48, s48, s53
    buffer_load_dwordx4 v2, s[88:91], s48 offen sc1 lds
    s_add_u32 m0, s52, 6144
    s_add_u32 s48, s48, s53
    buffer_load_dwordx4 v2, s[88:91], s48 offen sc1 lds
    s_add_u32 s48, s48, s53
    s_add_u32 s52, s52, 8192
    s_and_b32 s52, s52, 131071
    s_cmp_eq_u32 s54, 10
    s_cselect_b32 s48, s49, s48
    s_cmp_eq_u32 s54, 20
    s_cselect_b32 s48, s50, s48
    s_cmp_eq_u32 s54, 30
    s_cselect_b32 s48, s51, s48
    s_cselect_b32 s53, 2048, s53
    s_cmp_lt_u32 s54, 35
    s_cbranch_scc1 L_p4w_7
    s_add_u32 m0, s61, 0
    s_add_u32 s63, s63, 1
    buffer_load_dwordx4 v2, s[88:91], s56 offen sc1 lds
    s_cmp_eq_u32 s63, 27
    s_cselect_b32 s55, 1073741824, 2048
    s_add_u32 m0, s61, 1024
    s_add_u32 s56, s56, s55
    buffer_load_dwordx4 v2, s[88:91], s57 offen sc1 lds
    s_add_u32 m0, s61, 2048
    s_add_u32 s57, s57, s55
    buffer_load_dwordx4 v2, s[88:91], s58 offen sc1 lds
    s_add_u32 m0, s61, 3072
    s_add_u32 s58, s58, s55
    buffer_load_dwordx4 v2, s[88:91], s59 offen sc1 lds
    s_add_u32 m0, s61, 4096
    s_add_u32 s59, s59, s55
    buffer_load_dwordx4 v2, s[88:91], s60 offen sc1 lds
    s_add_u32 s60, s60, s55
    s_add_u32 s61, s61, 10240
    s_sub_u32 s55, s61, 161792
    s_cmp_lt_u32 s55, 5121
    s_cselect_b32 s55, 4294838272, 0
    s_add_u32 s61, s61, s55
    s_sub_u32 s55, s61, 83968
    s_cmp_lt_u32 s55, 5121
    s_cselect_b32 s55, 47104, 0
    s_add_u32 s61, s61, s55
    s_waitcnt vmcnt(27)
    s_barrier
    s_add_u32 m0, s61, 0
    s_add_u32 s63, s63, 1
    buffer_load_dwordx4 v2, s[88:91], s56 offen sc1 lds
    s_cmp_eq_u32 s63, 27
    s_cselect_b32 s55, 1073741824, 2048
    s_add_u32 m0, s61, 1024
    s_add_u32 s56, s56, s55
    buffer_load_dwordx4 v2, s[88:91], s57 offen sc1 lds
    s_add_u32 m0, s61, 2048
    s_add_u32 s57, s57, s55
    buffer_load_dwordx4 v2, s[88:91], s58 offen sc1 lds
    s_add_u32 m0, s61, 3072
    s_add_u32 s58, s58, s55
    buffer_load_dwordx4 v2, s[88:91], s59 offen sc1 lds
    s_add_u32 m0, s61, 4096
    s_add_u32 s59, s59, s55
    buffer_load_dwordx4 v2, s[88:91], s60 offen sc1 lds
    s_add_u32 s60, s60, s55
    s_add_u32 s61, s61, 10240
    s_sub_u32 s55, s61, 161792
    s_cmp_lt_u32 s55, 5121
    s_cselect_b32 s55, 4294838272, 0
    s_add_u32 s61, s61, s55
    s_sub_u32 s55, s61, 83968
    s_cmp_lt_u32 s55, 5121
    s_cselect_b32 s55, 47104, 0
    s_add_u32 s61, s61, s55
    s_add_u32 m0, s61, 0
    s_add_u32 s63, s63, 1
    buffer_load_dwordx4 v2, s[88:91], s56 offen sc1 lds
    s_cmp_eq_u32 s63, 27
    s_cselect_b32 s55, 1073741824, 2048
    s_add_u32 m0, s61, 1024
    s_add_u32 s56, s56, s55
    buffer_load_dwordx4 v2, s[88:91], s57 offen sc1 lds
    s_add_u32 m0, s61, 2048
    s_add_u32 s57, s57, s55
    buffer_load_dwordx4 v2, s[88:91], s58 offen sc1 lds
    s_add_u32 m0, s61, 3072
    s_add_u32 s58, s58, s55
    buffer_load_dwordx4 v2, s[88:91], s59 offen sc1 lds
    s_add_u32 m0, s61, 4096
    s_add_u32 s59, s59, s55
    buffer_load_dwordx4 v2, s[88:91], s60 offen sc1 lds
    s_add_u32 s60, s60, s55
    s_add_u32 s61, s61, 10240
    s_sub_u32 s55, s61, 161792
    s_cmp_lt_u32 s55, 5121
    s_cselect_b32 s55, 4294838272, 0
    s_add_u32 s61, s61, s55
    s_sub_u32 s55, s61, 83968
    s_cmp_lt_u32 s55, 5121
    s_cselect_b32 s55, 47104, 0
    s_add_u32 s61, s61, s55
    s_add_u32 m0, s61, 0
    s_add_u32 s63, s63, 1
    buffer_load_dwordx4 v2, s[88:91], s56 offen sc1 lds
    s_cmp_eq_u32 s63, 27
    s_cselect_b32 s55, 1073741824, 2048
    s_add_u32 m0, s61, 1024
    s_add_u32 s56, s56, s55
    buffer_load_dwordx4 v2, s[88:91], s57 offen sc1 lds
    s_add_u32 m0, s61, 2048
    s_add_u32 s57, s57, s55
    buffer_load_dwordx4 v2, s[88:91], s58 offen sc1 lds
    s_add_u32 m0, s61, 3072
    s_add_u32 s58, s58, s55
    buffer_load_dwordx4 v2, s[88:91], s59 offen sc1 lds
    s_add_u32 m0, s61, 4096
    s_add_u32 s59, s59, s55
    buffer_load_dwordx4 v2, s[88:91], s60 offen sc1 lds
    s_add_u32 s60, s60, s55
    s_add_u32 s61, s61, 10240
    s_sub_u32 s55, s61, 161792
    s_cmp_lt_u32 s55, 5121
    s_cselect_b32 s55, 4294838272, 0
    s_add_u32 s61, s61, s55
    s_sub_u32 s55, s61, 83968
    s_cmp_lt_u32 s55, 5121
    s_cselect_b32 s55, 47104, 0
    s_add_u32 s61, s61, s55
    s_waitcnt vmcnt(20)
    s_barrier
    s_add_u32 m0, s61, 0
    s_add_u32 s63, s63, 1
    buffer_load_dwordx4 v2, s[88:91], s56 offen sc1 lds
    s_cmp_eq_u32 s63, 27
    s_cselect_b32 s55, 1073741824, 2048
    s_add_u32 m0, s61, 1024
    s_add_u32 s56, s56, s55
    buffer_load_dwordx4 v2, s[88:91], s57 offen sc1 lds
    s_add_u32 m0, s61, 2048
    s_add_u32 s57, s57, s55
    buffer_load_dwordx4 v2, s[88:91], s58 offen sc1 lds
    s_add_u32 m0, s61, 3072
    s_add_u32 s58, s58, s55
    buffer_load_dwordx4 v2, s[88:91], s59 offen sc1 lds
    s_add_u32 m0, s61, 4096
    s_add_u32 s59, s59, s55
    buffer_load_dwordx4 v2, s[88:91], s60 offen sc1 lds
    s_add_u32 s60, s60, s55
    s_add_u32 s61, s61, 10240
    s_sub_u32 s55, s61, 161792
    s_cmp_lt_u32 s55, 5121
    s_cselect_b32 s55, 4294838272, 0
    s_add_u32 s61, s61, s55
    s_sub_u32 s55, s61, 83968
    s_cmp_lt_u32 s55, 5121
    s_cselect_b32 s55, 47104, 0
    s_add_u32 s61, s61, s55
    s_barrier
    s_branch L_p4_end
L_p4_L7:
    s_mul_i32 s14, s2, 5120
    s_add_u32 s14, s14, 35651584
    s_lshl_b32 s20, s2, 8
    s_add_u32 s20, s20, 14942208
    s_lshl_b32 s21, s2, 3
    s_add_u32 s21, s21, 34623488
    s_cmp_lt_u32 s2, 108
    s_cselect_b32 s14, s14, 1073741824
    s_cselect_b32 s20, s20, 1073741824
    s_cselect_b32 s21, s21, 1073741824
    s_add_u32 s15, s14, 4096
    v_lshlrev_b32 v6, 2, v0
    buffer_load_dword v112, v6, s[88:91], s14 offen offset:0 sc1
    buffer_load_dword v113, v6, s[88:91], s14 offen offset:256 sc1
    buffer_load_dword v114, v6, s[88:91], s14 offen offset:512 sc1
    buffer_load_dword v115, v6, s[88:91], s14 offen offset:768 sc1
    buffer_load_dword v116, v6, s[88:91], s14 offen offset:1024 sc1
    buffer_load_dword v117, v6, s[88:91], s14 offen offset:1280 sc1
    buffer_load_dword v118, v6, s[88:91], s14 offen offset:1536 sc1
    buffer_load_dword v119, v6, s[88:91], s14 offen offset:1792 sc1
    buffer_load_dword v120, v6, s[88:91], s14 offen offset:2048 sc1
    buffer_load_dword v121, v6, s[88:91], s14 offen offset:2304 sc1
    buffer_load_dword v122, v6, s[88:91], s14 offen offset:2560 sc1
    buffer_load_dword v123, v6, s[88:91], s14 offen offset:2816 sc1
    buffer_load_dword v124, v6, s[88:91], s14 offen offset:3072 sc1
    buffer_load_dword v125, v6, s[88:91], s14 offen offset:3328 sc1
    buffer_load_dword v126, v6, s[88:91], s14 offen offset:3584 sc1
    buffer_load_dword v127, v6, s[88:91], s14 offen offset:3840 sc1
    buffer_load_dword v128, v6, s[88:91], s15 offen offset:0 sc1
    buffer_load_dword v129, v6, s[88:91], s15 offen offset:256 sc1
    buffer_load_dword v130, v6, s[88:91], s15 offen offset:512 sc1
    buffer_load_dword v131, v6, s[88:91], s15 offen offset:768 sc1
    s_waitcnt vmcnt(0)
    v_add_f32 v112, v112, v113
    v_add_f32 v112, v112, v114
    v_add_f32 v112, v112, v115
    v_add_f32 v112, v112, v116
    v_add_f32 v112, v112, v117
    v_add_f32 v112, v112, v118
    v_add_f32 v112, v112, v119
    v_add_f32 v112, v112, v120
    v_add_f32 v112, v112, v121
    v_add_f32 v112, v112, v122
    v_add_f32 v112, v112, v123
    v_add_f32 v112, v112, v124
    v_add_f32 v112, v112, v125
    v_add_f32 v112, v112, v126
    v_add_f32 v112, v112, v127
    v_add_f32 v112, v112, v128
    v_add_f32 v112, v112, v129
    v_add_f32 v112, v112, v130
    v_add_f32 v112, v112, v131
    v_mov_b32 v113, v112
    s_nop 1
    v_permlane32_swap_b32 v112, v113
    s_nop 1
    v_add_f32 v112, v112, v113
    v_cvt_pk_bf16_f32 v113, v112, v112
    v_lshlrev_b32 v113, 16, v113
    v_sub_f32 v114, v112, v113
    v_cvt_pk_bf16_f32 v115, v114, v114
    v_lshlrev_b32 v115, 16, v115
    v_sub_f32 v116, v114, v115
    v_cvt_pk_bf16_f32 v118, v112, v114
    v_cvt_pk_bf16_f32 v119, v116, 0
    v_lshlrev_b32 v6, 3, v0
    s_mov_b32 exec_hi, 0
    buffer_store_dwordx2 v[118:119], v6, s[88:91], s20 offen sc1
    s_mov_b32 exec_hi, -1
    s_barrier
    s_waitcnt vmcnt(0)
    v_mov_b32 v112, s92
    v_mov_b32 v113, s93
    v_mbcnt_lo_u32_b32 v114, -1, 0
    v_mul_u32_u24 v114, 69888, v114
    s_mov_b64 exec, 255
    buffer_store_dwordx2 v[112:113], v114, s[88:91], s21 offen sc1
    s_mov_b64 exec, -1
    s_lshl_b32 s39, s79, 1
    s_lshl_b32 s38, 512, s39
    s_lshr_b32 s39, 2048, s39
    v_lshrrev_b32 v35, 5, v0
    v_mul_u32_u24 v32, s39, v35
    v_bfe_u32 v36, v0, 4, 1
    v_mul_u32_u24 v36, s38, v36
    v_add3_u32 v32, v32, v36, s80
    v_bfe_u32 v36, v0, 2, 2
    v_lshl_add_u32 v32, v36, 7, v32
    v_and_b32 v36, 3, v0
    v_lshl_add_u32 v32, v36, 3, v32
    v_lshlrev_b32 v33, 4, v0
    ds_read_b64_tr_b16 v[80:81], v32 offset:0
    ds_read_b64_tr_b16 v[82:83], v32 offset:1024
    ds_read_b64_tr_b16 v[84:85], v32 offset:32
    ds_read_b64_tr_b16 v[86:87], v32 offset:1056
    ds_read_b64_tr_b16 v[88:89], v32 offset:64
    ds_read_b64_tr_b16 v[90:91], v32 offset:1088
    ds_read_b64_tr_b16 v[92:93], v32 offset:96
    ds_read_b64_tr_b16 v[94:95], v32 offset:1120
    s_sub_u32 s38, s77, 25165824
    s_lshr_b32 s38, s38, 3
    s_add_u32 s38, s38, 35651584
    s_cmp_eq_u32 s79, 1
    s_cselect_b32 s38, s38, 1073741824
    s_mov_b32 s39, 0xffff0000
    v_lshlrev_b32 v34, 2, v0
    s_waitcnt lgkmcnt(6)
    buffer_store_dwordx4 v[80:83], v33, s[88:91], s77 offen sc1
    s_add_u32 s77, s77, s78
    s_waitcnt lgkmcnt(4)
    buffer_store_dwordx4 v[84:87], v33, s[88:91], s77 offen sc1
    s_add_u32 s77, s77, s78
    s_waitcnt lgkmcnt(2)
    buffer_store_dwordx4 v[88:91], v33, s[88:91], s77 offen sc1
    s_add_u32 s77, s77, s78
    s_waitcnt lgkmcnt(0)
    buffer_store_dwordx4 v[92:95], v33, s[88:91], s77 offen sc1
    s_add_u32 s77, s77, s78
    v_lshlrev_b32 v42, 16, v80
    v_and_b32 v43, s39, v80
    v_lshlrev_b32 v35, 16, v81
    v_and_b32 v36, s39, v81
    v_add_f32 v42, v42, v35
    v_add_f32 v43, v43, v36
    v_lshlrev_b32 v35, 16, v82
    v_and_b32 v36, s39, v82
    v_add_f32 v42, v42, v35
    v_add_f32 v43, v43, v36
    v_lshlrev_b32 v35, 16, v83
    v_and_b32 v36, s39, v83
    v_add_f32 v42, v42, v35
    v_add_f32 v43, v43, v36
    v_add_f32 v42, v42, v43
    v_mov_b32 v43, v42
    s_nop 1
    v_permlane32_swap_b32 v42, v43
    s_nop 1
    v_add_f32 v42, v42, v43
    s_mov_b32 exec_hi, 0
    buffer_store_dword v42, v34, s[88:91], s38 offen sc1
    s_mov_b32 exec_hi, -1
    s_add_u32 s38, s38, 5120
    v_lshlrev_b32 v44, 16, v84
    v_and_b32 v45, s39, v84
    v_lshlrev_b32 v35, 16, v85
    v_and_b32 v36, s39, v85
    v_add_f32 v44, v44, v35
    v_add_f32 v45, v45, v36
    v_lshlrev_b32 v35, 16, v86
    v_and_b32 v36, s39, v86
    v_add_f32 v44, v44, v35
    v_add_f32 v45, v45, v36
    v_lshlrev_b32 v35, 16, v87
    v_and_b32 v36, s39, v87
    v_add_f32 v44, v44, v35
    v_add_f32 v45, v45, v36
    v_add_f32 v44, v44, v45
    v_mov_b32 v45, v44
    s_nop 1
    v_permlane32_swap_b32 v44, v45
    s_nop 1
    v_add_f32 v44, v44, v45
    s_mov_b32 exec_hi, 0
    buffer_store_dword v44, v34, s[88:91], s38 offen sc1
    s_mov_b32 exec_hi, -1
    s_add_u32 s38, s38, 5120
    v_lshlrev_b32 v42, 16, v88
    v_and_b32 v43, s39, v88
    v_lshlrev_b32 v35, 16, v89
    v_and_b32 v36, s39, v89
    v_add_f32 v42, v42, v35
    v_add_f32 v43, v43, v36
    v_lshlrev_b32 v35, 16, v90
    v_and_b32 v36, s39, v90
    v_add_f32 v42, v42, v35
    v_add_f32 v43, v43, v36
    v_lshlrev_b32 v35, 16, v91
    v_and_b32 v36, s39, v91
    v_add_f32 v42, v42, v35
    v_add_f32 v43, v43, v36
    v_add_f32 v42, v42, v43
    v_mov_b32 v43, v42
    s_nop 1
    v_permlane32_swap_b32 v42, v43
    s_nop 1
    v_add_f32 v42, v42, v43
    s_mov_b32 exec_hi, 0
    buffer_store_dword v42, v34, s[88:91], s38 offen sc1
    s_mov_b32 exec_hi, -1
    s_add_u32 s38, s38, 5120
    v_lshlrev_b32 v44, 16, v92
    v_and_b32 v45, s39, v92
    v_lshlrev_b32 v35, 16, v93
    v_and_b32 v36, s39, v93
    v_add_f32 v44, v44, v35
    v_add_f32 v45, v45, v36
    v_lshlrev_b32 v35, 16, v94
    v_and_b32 v36, s39, v94
    v_add_f32 v44, v44, v35
    v_add_f32 v45, v45, v36
    v_lshlrev_b32 v35, 16, v95
    v_and_b32 v36, s39, v95
    v_add_f32 v44, v44, v35
    v_add_f32 v45, v45, v36
    v_add_f32 v44, v44, v45
    v_mov_b32 v45, v44
    s_nop 1
    v_permlane32_swap_b32 v44, v45
    s_nop 1
    v_add_f32 v44, v44, v45
    s_mov_b32 exec_hi, 0
    buffer_store_dword v44, v34, s[88:91], s38 offen sc1
    s_mov_b32 exec_hi, -1
    s_add_u32 s38, s38, 5120
    s_barrier
    s_waitcnt vmcnt(0)
    s_barrier
    s_barrier
    s_barrier
    s_barrier
    s_lshr_b32 s20, s2, 3
    s_xor_b32 s21, s94, 7
    s_or_b32 s20, s20, s21
    s_cmp_lg_u32 s20, 0
    s_cbranch_scc1 L_cpe4
    s_getpc_b64 s[20:21]
    L_cp4:
    s_add_u32 s20, s20, L_p4_end-L_cp4
    s_addc_u32 s21, s21, 0
    v_lshlrev_b32 v40, 7, v0
    v_min_u32 v42, L_done-L_p4_end, v40
    global_load_dword v41, v42, s[20:21]
    v_add_u32 v40, 8192, v40
    v_min_u32 v42, L_done-L_p4_end, v40
    global_load_dword v41, v42, s[20:21]
    v_add_u32 v40, 8192, v40
L_cpe4:
    s_barrier
    s_barrier
    s_barrier
    s_branch L_p4_Lend
L_p4_L6:
    s_mul_i32 s14, s17, 7
    v_and_b32 v6, 7, v0
    v_min_u32 v6, 6, v6
    v_add_u32 v6, s14, v6
    v_min_u32 v6, 107, v6
    v_lshlrev_b32 v6, 3, v6
    s_lshl_b32 s14, s2, 3
    s_add_u32 s14, s14, 34631680
    s_barrier
    v_mov_b32 v12, 163776
    v_mov_b32 v13, 0
    ds_write_b32 v12, v13
    s_lshl_b32 s39, s79, 1
    s_lshl_b32 s38, 512, s39
    s_lshr_b32 s39, 2048, s39
    v_lshrrev_b32 v35, 5, v0
    v_mul_u32_u24 v32, s39, v35
    v_bfe_u32 v36, v0, 4, 1
    v_mul_u32_u24 v36, s38, v36
    v_add3_u32 v32, v32, v36, s80
    v_bfe_u32 v36, v0, 2, 2
    v_lshl_add_u32 v32, v36, 7, v32
    v_and_b32 v36, 3, v0
    v_lshl_add_u32 v32, v36, 3, v32
    v_lshlrev_b32 v33, 4, v0
    ds_read_b64_tr_b16 v[80:81], v32 offset:0
    ds_read_b64_tr_b16 v[82:83], v32 offset:1024
    ds_read_b64_tr_b16 v[84:85], v32 offset:32
    ds_read_b64_tr_b16 v[86:87], v32 offset:1056
    ds_read_b64_tr_b16 v[88:89], v32 offset:64
    ds_read_b64_tr_b16 v[90:91], v32 offset:1088
    ds_read_b64_tr_b16 v[92:93], v32 offset:96
    ds_read_b64_tr_b16 v[94:95], v32 offset:1120
    s_sub_u32 s38, s77, 25165824
    s_lshr_b32 s38, s38, 3
    s_add_u32 s38, s38, 35651584
    s_cmp_eq_u32 s79, 1
    s_cselect_b32 s38, s38, 1073741824
    s_mov_b32 s39, 0xffff0000
    v_lshlrev_b32 v34, 2, v0
    s_waitcnt lgkmcnt(6)
    buffer_store_dwordx4 v[80:83], v33, s[88:91], s77 offen sc1
    s_add_u32 s77, s77, s78
    s_waitcnt lgkmcnt(4)
    buffer_store_dwordx4 v[84:87], v33, s[88:91], s77 offen sc1
    s_add_u32 s77, s77, s78
    s_waitcnt lgkmcnt(2)
    buffer_store_dwordx4 v[88:91], v33, s[88:91], s77 offen sc1
    s_add_u32 s77, s77, s78
    s_waitcnt lgkmcnt(0)
    buffer_store_dwordx4 v[92:95], v33, s[88:91], s77 offen sc1
    s_add_u32 s77, s77, s78
    v_lshlrev_b32 v42, 16, v80
    v_and_b32 v43, s39, v80
    v_lshlrev_b32 v35, 16, v81
    v_and_b32 v36, s39, v81
    v_add_f32 v42, v42, v35
    v_add_f32 v43, v43, v36
    v_lshlrev_b32 v35, 16, v82
    v_and_b32 v36, s39, v82
    v_add_f32 v42, v42, v35
    v_add_f32 v43, v43, v36
    v_lshlrev_b32 v35, 16, v83
    v_and_b32 v36, s39, v83
    v_add_f32 v42, v42, v35
    v_add_f32 v43, v43, v36
    v_add_f32 v42, v42, v43
    v_mov_b32 v43, v42
    s_nop 1
    v_permlane32_swap_b32 v42, v43
    s_nop 1
    v_add_f32 v42, v42, v43
    s_mov_b32 exec_hi, 0
    buffer_store_dword v42, v34, s[88:91], s38 offen sc1
    s_mov_b32 exec_hi, -1
    s_add_u32 s38, s38, 5120
    v_lshlrev_b32 v44, 16, v84
    v_and_b32 v45, s39, v84
    v_lshlrev_b32 v35, 16, v85
    v_and_b32 v36, s39, v85
    v_add_f32 v44, v44, v35
    v_add_f32 v45, v45, v36
    v_lshlrev_b32 v35, 16, v86
    v_and_b32 v36, s39, v86
    v_add_f32 v44, v44, v35
    v_add_f32 v45, v45, v36
    v_lshlrev_b32 v35, 16, v87
    v_and_b32 v36, s39, v87
    v_add_f32 v44, v44, v35
    v_add_f32 v45, v45, v36
    v_add_f32 v44, v44, v45
    v_mov_b32 v45, v44
    s_nop 1
    v_permlane32_swap_b32 v44, v45
    s_nop 1
    v_add_f32 v44, v44, v45
    s_mov_b32 exec_hi, 0
    buffer_store_dword v44, v34, s[88:91], s38 offen sc1
    s_mov_b32 exec_hi, -1
    s_add_u32 s38, s38, 5120
    v_lshlrev_b32 v42, 16, v88
    v_and_b32 v43, s39, v88
    v_lshlrev_b32 v35, 16, v89
    v_and_b32 v36, s39, v89
    v_add_f32 v42, v42, v35
    v_add_f32 v43, v43, v36
    v_lshlrev_b32 v35, 16, v90
    v_and_b32 v36, s39, v90
    v_add_f32 v42, v42, v35
    v_add_f32 v43, v43, v36
    v_lshlrev_b32 v35, 16, v91
    v_and_b32 v36, s39, v91
    v_add_f32 v42, v42, v35
    v_add_f32 v43, v43, v36
    v_add_f32 v42, v42, v43
    v_mov_b32 v43, v42
    s_nop 1
    v_permlane32_swap_b32 v42, v43
    s_nop 1
    v_add_f32 v42, v42, v43
    s_mov_b32 exec_hi, 0
    buffer_store_dword v42, v34, s[88:91], s38 offen sc1
    s_mov_b32 exec_hi, -1
    s_add_u32 s38, s38, 5120
    v_lshlrev_b32 v44, 16, v92
    v_and_b32 v45, s39, v92
    v_lshlrev_b32 v35, 16, v93
    v_and_b32 v36, s39, v93
    v_add_f32 v44, v44, v35
    v_add_f32 v45, v45, v36
    v_lshlrev_b32 v35, 16, v94
    v_and_b32 v36, s39, v94
    v_add_f32 v44, v44, v35
    v_add_f32 v45, v45, v36
    v_lshlrev_b32 v35, 16, v95
    v_and_b32 v36, s39, v95
    v_add_f32 v44, v44, v35
    v_add_f32 v45, v45, v36
    v_add_f32 v44, v44, v45
    v_mov_b32 v45, v44
    s_nop 1
    v_permlane32_swap_b32 v44, v45
    s_nop 1
    v_add_f32 v44, v44, v45
    s_mov_b32 exec_hi, 0
    buffer_store_dword v44, v34, s[88:91], s38 offen sc1
    s_mov_b32 exec_hi, -1
    s_add_u32 s38, s38, 5120
    s_barrier
    s_mov_b32 s18, 34623488
    s_mov_b32 s15, 16384
L_poll11:
    buffer_load_dwordx2 v[8:9], v6, s[96:99], s18 offen offset:0 sc1
    s_waitcnt vmcnt(0)
    v_cmp_ne_u64 vcc, s[92:93], v[8:9]
    s_sub_u32 s15, s15, 1
    s_cbranch_scc1 L_poll11_ok
    s_cmp_eq_u64 vcc, 0
    s_cbranch_scc1 L_poll11_ok
    s_sleep 1
    s_branch L_poll11
L_poll11_ok:
    s_barrier
    v_mov_b32 v14, s92
    v_mov_b32 v15, s93
    v_mbcnt_lo_u32_b32 v16, -1, 0
    v_mul_u32_u24 v16, 69888, v16
    s_mov_b64 exec, 255
    buffer_store_dwordx2 v[14:15], v16, s[88:91], s14 offen sc1
    s_mov_b64 exec, -1
    s_barrier
    s_barrier
    s_barrier
    s_barrier
    s_barrier
    s_barrier
    s_add_u32 s14, s46, 34652160
    v_mov_b32 v8, s92
    v_mov_b32 v9, s93
    v_mbcnt_lo_u32_b32 v10, -1, 0
    v_mul_u32_u24 v10, 69888, v10
    s_mov_b64 exec, 255
    buffer_store_dwordx2 v[8:9], v10, s[88:91], s14 offen sc1
    s_mov_b64 exec, -1
L_p4_Lend:
    s_waitcnt vmcnt(0)
    s_barrier
    s_branch L_p4_end
L_p4_C:
    v_and_b32 v64, 31, v0
    v_lshrrev_b32 v65, 5, v0
    v_lshlrev_b32 v65, 11, v65
    v_lshl_add_u32 v65, v64, 3, v65
    v_lshrrev_b32 v64, 3, v64
    v_lshl_add_u32 v65, v64, 6, v65
    v_cmp_gt_u32 s[20:21], 32, v0
    s_lshl_b32 s14, s16, 2
    s_add_u32 s42, s14, s19
    s_lshl_b32 s43, s42, 12
    s_add_u32 s43, s43, 14680064
    s_mul_i32 s44, s17, 1792
    s_add_u32 s44, s44, 14942208
    s_mul_i32 s45, s42, 40960
    s_add_u32 s45, s45, 11534336
    v_add_u32 v3, 65536, v2
    s_mul_i32 s47, s42, 110592
    s_add_u32 s47, s47, 16777216
    s_lshl_b32 s14, s17, 11
    s_add_u32 s48, s47, s14
    s_add_u32 s49, s48, 1024
    s_add_u32 s50, s48, 32768
    s_add_u32 s51, s50, 1024
    s_add_u32 s52, s48, 63488
    s_add_u32 s53, s52, 1024
    s_lshl_b32 s14, s17, 10
    s_add_u32 s54, s47, s14
    s_add_u32 s54, s54, 94208
    s_cmp_eq_u32 s17, 15
    s_cselect_b32 s50, s54, s50
    s_cselect_b32 s51, 1073741824, s51
    s_cselect_b32 s52, 1073741824, s52
    s_cselect_b32 s53, 1073741824, s53
    s_cselect_b32 s54, 1073741824, s54
    s_cselect_b32 s55, 1073741824, s44
    s_add_u32 s46, s46, 34619392
    v_mov_b32 v10, 0
    v_mov_b32 v11, 0
    v_and_b32 v78, 7, v0
    s_lshr_b32 s14, s19, 1
    s_lshl_b32 s14, s14, 3
    v_add_u32 v78, s14, v78
    v_lshlrev_b32 v78, 3, v78
    s_lshl_b32 s14, s16, 7
    s_add_u32 s14, s14, 34615296
    s_mov_b32 s15, 16384
    buffer_load_dwordx2 v[80:81], v78, s[96:99], s14 offen sc1
    s_sleep 2
L_poll12:
    buffer_load_dwordx2 v[82:83], v78, s[96:99], s14 offen sc1
    s_waitcnt vmcnt(1)
    v_cmp_ne_u64 vcc, s[92:93], v[80:81]
    s_sub_u32 s15, s15, 1
    s_cbranch_scc1 L_poll12_ok
    s_cmp_eq_u64 vcc, 0
    s_cbranch_scc1 L_poll12_ok
    s_sleep 0
    buffer_load_dwordx2 v[80:81], v78, s[96:99], s14 offen sc1
    s_waitcnt vmcnt(1)
    v_cmp_ne_u64 vcc, s[92:93], v[82:83]
    s_sub_u32 s15, s15, 1
    s_cbranch_scc1 L_poll12_ok
    s_cmp_eq_u64 vcc, 0
    s_cbranch_scc1 L_poll12_ok
    s_sleep 0
    s_branch L_poll12
L_poll12_ok:
    buffer_load_dwordx4 v[96:99], v2, s[88:91], s45 offen offset:0 sc1
    buffer_load_dwordx4 v[100:103], v2, s[88:91], s45 offen offset:1024 sc1
    buffer_load_dwordx4 v[104:107], v2, s[88:91], s45 offen offset:2048 sc1
    buffer_load_dwordx4 v[108:111], v2, s[88:91], s45 offen offset:3072 sc1
    buffer_load_dwordx2 v[68:69], v65, s[88:91], s43 offen offset:0 sc1
    buffer_load_dwordx2 v[70:71], v65, s[88:91], s43 offen offset:512 sc1
    buffer_load_dwordx2 v[72:73], v65, s[88:91], s43 offen offset:1024 sc1
    buffer_load_dwordx2 v[74:75], v65, s[88:91], s43 offen offset:1536 sc1
    s_add_u32 s45, s45, 4096
    buffer_load_dwordx4 v[112:115], v2, s[88:91], s45 offen offset:0 sc1
    buffer_load_dwordx4 v[116:119], v2, s[88:91], s45 offen offset:1024 sc1
    buffer_load_dwordx4 v[120:123], v2, s[88:91], s45 offen offset:2048 sc1
    buffer_load_dwordx4 v[124:127], v2, s[88:91], s45 offen offset:3072 sc1
    s_add_u32 s45, s45, 4096
    buffer_load_dwordx4 v[128:131], v2, s[88:91], s45 offen offset:0 sc1
    buffer_load_dwordx4 v[132:135], v2, s[88:91], s45 offen offset:1024 sc1
    buffer_load_dwordx4 v[136:139], v2, s[88:91], s45 offen offset:2048 sc1
    buffer_load_dwordx4 v[140:143], v2, s[88:91], s45 offen offset:3072 sc1
    s_barrier
    ds_read_b128 v[16:19], v2 offset:0
    ds_read_b128 v[20:23], v2 offset:1024
    ds_read_b128 v[24:27], v2 offset:2048
    ds_read_b128 v[28:31], v2 offset:3072
    s_waitcnt vmcnt(15)
    s_waitcnt lgkmcnt(3)
    v_mfma_f32_32x32x16_bf16 v[32:47], v[16:19], v[96:99], 0
    ds_read_b128 v[16:19], v2 offset:4096
    s_add_u32 s45, s45, 4096
    buffer_load_dwordx4 v[144:147], v2, s[88:91], s45 offen offset:0 sc1
    s_waitcnt lgkmcnt(3)
    v_mfma_f32_32x32x16_bf16 v[48:63], v[20:23], v[96:99], 0
    ds_read_b128 v[20:23], v2 offset:5120
    s_waitcnt vmcnt(15)
    s_waitcnt lgkmcnt(3)
    v_mfma_f32_32x32x16_bf16 v[32:47], v[24:27], v[100:103], v[32:47]
    ds_read_b128 v[24:27], v2 offset:6144
    buffer_load_dwordx4 v[148:151], v2, s[88:91], s45 offen offset:1024 sc1
    s_waitcnt lgkmcnt(3)
    v_mfma_f32_32x32x16_bf16 v[48:63], v[28:31], v[100:103], v[48:63]
    ds_read_b128 v[28:31], v2 offset:7168
    s_waitcnt vmcnt(15)
    s_waitcnt lgkmcnt(3)
    v_mfma_f32_32x32x16_bf16 v[32:47], v[16:19], v[104:107], v[32:47]
    ds_read_b128 v[16:19], v2 offset:8192
    buffer_load_dwordx4 v[152:155], v2, s[88:91], s45 offen offset:2048 sc1
    s_waitcnt lgkmcnt(3)
    v_mfma_f32_32x32x16_bf16 v[48:63], v[20:23], v[104:107], v[48:63]
    ds_read_b128 v[20:23], v2 offset:9216
    s_waitcnt vmcnt(15)
    s_waitcnt lgkmcnt(3)
    v_mfma_f32_32x32x16_bf16 v[32:47], v[24:27], v[108:111], v[32:47]
    ds_read_b128 v[24:27], v2 offset:10240
    buffer_load_dwordx4 v[156:159], v2, s[88:91], s45 offen offset:3072 sc1
    s_waitcnt lgkmcnt(3)
    v_mfma_f32_32x32x16_bf16 v[48:63], v[28:31], v[108:111], v[48:63]
    ds_read_b128 v[28:31], v2 offset:11264
    s_waitcnt vmcnt(11)
    s_waitcnt lgkmcnt(3)
    v_mfma_f32_32x32x16_bf16 v[32:47], v[16:19], v[112:115], v[32:47]
    ds_read_b128 v[16:19], v2 offset:12288
    s_add_u32 s45, s45, 4096
    buffer_load_dwordx4 v[160:163], v2, s[88:91], s45 offen offset:0 sc1
    s_waitcnt lgkmcnt(3)
    v_mfma_f32_32x32x16_bf16 v[48:63], v[20:23], v[112:115], v[48:63]
    ds_read_b128 v[20:23], v2 offset:13312
    s_waitcnt vmcnt(11)
    s_waitcnt lgkmcnt(3)
    v_mfma_f32_32x32x16_bf16 v[32:47], v[24:27], v[116:119], v[32:47]
    ds_read_b128 v[24:27], v2 offset:14336
    buffer_load_dwordx4 v[164:167], v2, s[88:91], s45 offen offset:1024 sc1
    s_waitcnt lgkmcnt(3)
    v_mfma_f32_32x32x16_bf16 v[48:63], v[28:31], v[116:119], v[48:63]
    ds_read_b128 v[28:31], v2 offset:15360
    s_waitcnt vmcnt(11)
    s_waitcnt lgkmcnt(3)
    v_mfma_f32_32x32x16_bf16 v[32:47], v[16:19], v[120:123], v[32:47]
    ds_read_b128 v[16:19], v2 offset:16384
    buffer_load_dwordx4 v[168:171], v2, s[88:91], s45 offen offset:2048 sc1
    v_add_f32 v64, v68, v70
    v_add_f32 v65, v72, v74
    v_add_f32 v64, v64, v65
    s_waitcnt lgkmcnt(3)
    v_mfma_f32_32x32x16_bf16 v[48:63], v[20:23], v[120:123], v[48:63]
    ds_read_b128 v[20:23], v2 offset:17408
    v_mov_b32 v65, v64
    v_add_f32 v66, v69, v71
    v_add_f32 v67, v73, v75
    s_waitcnt vmcnt(11)
    s_waitcnt lgkmcnt(3)
    v_mfma_f32_32x32x16_bf16 v[32:47], v[24:27], v[124:127], v[32:47]
    ds_read_b128 v[24:27], v2 offset:18432
    buffer_load_dwordx4 v[172:175], v2, s[88:91], s45 offen offset:3072 sc1
    v_permlane32_swap_b32 v64, v65
    v_add_f32 v66, v66, v67
    s_nop 0
    s_waitcnt lgkmcnt(3)
    v_mfma_f32_32x32x16_bf16 v[48:63], v[28:31], v[124:127], v[48:63]
    ds_read_b128 v[28:31], v2 offset:19456
    v_add_f32 v64, v64, v65
    v_mul_f32 v64, 0x3acccccd, v64
    s_mov_b32 s14, 0x3c4ccccd
    s_waitcnt vmcnt(11)
    s_waitcnt lgkmcnt(3)
    v_mfma_f32_32x32x16_bf16 v[32:47], v[16:19], v[128:131], v[32:47]
    ds_read_b128 v[16:19], v2 offset:20480
    s_add_u32 s45, s45, 4096
    buffer_load_dwordx4 v[176:179], v2, s[88:91], s45 offen offset:0 sc1
    v_mov_b32 v67, 0
    v_fma_f32 v65, v68, s14, -v64
    v_fmac_f32 v67, v65, v65
    s_waitcnt lgkmcnt(3)
    v_mfma_f32_32x32x16_bf16 v[48:63], v[20:23], v[128:131], v[48:63]
    ds_read_b128 v[20:23], v2 offset:21504
    v_fma_f32 v65, v70, s14, -v64
    v_fmac_f32 v67, v65, v65
    v_fma_f32 v65, v72, s14, -v64
    s_waitcnt vmcnt(11)
    s_waitcnt lgkmcnt(3)
    v_mfma_f32_32x32x16_bf16 v[32:47], v[24:27], v[132:135], v[32:47]
    ds_read_b128 v[24:27], v2 offset:22528
    buffer_load_dwordx4 v[180:183], v2, s[88:91], s45 offen offset:1024 sc1
    v_fmac_f32 v67, v65, v65
    v_fma_f32 v65, v74, s14, -v64
    v_fmac_f32 v67, v65, v65
    s_waitcnt lgkmcnt(3)
    v_mfma_f32_32x32x16_bf16 v[48:63], v[28:31], v[132:135], v[48:63]
    ds_read_b128 v[28:31], v2 offset:23552
    v_mov_b32 v65, 0x42a00000
    v_fmac_f32 v66, v65, v67
    v_mov_b32 v65, v66
    s_waitcnt vmcnt(11)
    s_waitcnt lgkmcnt(3)
    v_mfma_f32_32x32x16_bf16 v[32:47], v[16:19], v[136:139], v[32:47]
    ds_read_b128 v[16:19], v2 offset:24576
    buffer_load_dwordx4 v[184:187], v2, s[88:91], s45 offen offset:2048 sc1
    s_nop 1
    v_permlane32_swap_b32 v66, v65
    s_nop 1
    s_waitcnt lgkmcnt(3)
    v_mfma_f32_32x32x16_bf16 v[48:63], v[20:23], v[136:139], v[48:63]
    ds_read_b128 v[20:23], v2 offset:25600
    v_add_f32 v66, v66, v65
    v_mul_f32 v66, 0x3acccccd, v66
    v_cvt_pk_bf16_f32 v64, v64, v64
    s_waitcnt vmcnt(11)
    s_waitcnt lgkmcnt(3)
    v_mfma_f32_32x32x16_bf16 v[32:47], v[24:27], v[140:143], v[32:47]
    ds_read_b128 v[24:27], v2 offset:26624
    buffer_load_dwordx4 v[188:191], v2, s[88:91], s45 offen offset:3072 sc1
    v_lshlrev_b32 v64, 16, v64
    v_cvt_pk_bf16_f32 v66, v66, v66
    v_lshlrev_b32 v66, 16, v66
    s_waitcnt lgkmcnt(3)
    v_mfma_f32_32x32x16_bf16 v[48:63], v[28:31], v[140:143], v[48:63]
    ds_read_b128 v[28:31], v2 offset:27648
    v_sub_f32 v64, 0, v64
    v_add_f32 v66, 0x3727c5ac, v66
    v_cvt_pk_bf16_f32 v66, v66, v66
    s_waitcnt vmcnt(11)
    s_waitcnt lgkmcnt(3)
    v_mfma_f32_32x32x16_bf16 v[32:47], v[16:19], v[144:147], v[32:47]
    ds_read_b128 v[16:19], v2 offset:28672
    s_add_u32 s45, s45, 4096
    buffer_load_dwordx4 v[192:195], v2, s[88:91], s45 offen offset:0 sc1
    v_lshlrev_b32 v66, 16, v66
    v_sqrt_f32 v66, v66
    s_waitcnt lgkmcnt(3)
    v_mfma_f32_32x32x16_bf16 v[48:63], v[20:23], v[144:147], v[48:63]
    ds_read_b128 v[20:23], v2 offset:29696
    s_nop 0
    v_cvt_pk_bf16_f32 v66, v66, v66
    v_lshlrev_b32 v66, 16, v66
    s_waitcnt vmcnt(11)
    s_waitcnt lgkmcnt(3)
    v_mfma_f32_32x32x16_bf16 v[32:47], v[24:27], v[148:151], v[32:47]
    ds_read_b128 v[24:27], v2 offset:30720
    buffer_load_dwordx4 v[196:199], v2, s[88:91], s45 offen offset:1024 sc1
    v_rcp_f32 v67, v66
    v_mul_f32 v14, v66, v66
    s_waitcnt lgkmcnt(3)
    v_mfma_f32_32x32x16_bf16 v[48:63], v[28:31], v[148:151], v[48:63]
    ds_read_b128 v[28:31], v2 offset:31744
    v_cvt_pk_bf16_f32 v8, v64, v64
    v_mul_f32 v12, 0xc0135761, v67
    v_mul_f32 v65, v67, v67
    s_barrier
    s_waitcnt vmcnt(11)
    s_waitcnt lgkmcnt(3)
    v_mfma_f32_32x32x16_bf16 v[32:47], v[16:19], v[152:155], v[32:47]
    ds_read_b128 v[16:19], v2 offset:32768
    buffer_load_dwordx4 v[200:203], v2, s[88:91], s45 offen offset:2048 sc1
    v_mul_f32 v65, 0x3d372713, v65
    v_mul_f32 v13, v12, v65
    v_cvt_pk_bf16_f32 v9, v64, 0
    s_waitcnt lgkmcnt(3)
    v_mfma_f32_32x32x16_bf16 v[48:63], v[20:23], v[152:155], v[48:63]
    ds_read_b128 v[20:23], v2 offset:33792
    v_cndmask_b32 v8, 0, v8, s[20:21]
    v_cndmask_b32 v9, 0, v9, s[20:21]
    v_lshrrev_b32 v15, 1, v2
    s_waitcnt vmcnt(11)
    s_waitcnt lgkmcnt(3)
    v_mfma_f32_32x32x16_bf16 v[32:47], v[24:27], v[156:159], v[32:47]
    ds_read_b128 v[24:27], v2 offset:34816
    buffer_load_dwordx4 v[204:207], v2, s[88:91], s45 offen offset:3072 sc1
    v_and_b32 v15, 0xf8, v15
    s_waitcnt lgkmcnt(3)
    v_mfma_f32_32x32x16_bf16 v[48:63], v[28:31], v[156:159], v[48:63]
    ds_read_b128 v[28:31], v2 offset:35840
    s_waitcnt vmcnt(11)
    s_waitcnt lgkmcnt(3)
    v_mfma_f32_32x32x16_bf16 v[32:47], v[16:19], v[160:163], v[32:47]
    ds_read_b128 v[16:19], v2 offset:36864
    s_add_u32 s45, s45, 4096
    buffer_load_dwordx4 v[208:211], v2, s[88:91], s45 offen offset:0 sc1
    s_waitcnt lgkmcnt(3)
    v_mfma_f32_32x32x16_bf16 v[48:63], v[20:23], v[160:163], v[48:63]
    ds_read_b128 v[20:23], v2 offset:37888
    s_waitcnt vmcnt(11)
    s_waitcnt lgkmcnt(3)
    v_mfma_f32_32x32x16_bf16 v[32:47], v[24:27], v[164:167], v[32:47]
    ds_read_b128 v[24:27], v2 offset:38912
    buffer_load_dwordx4 v[212:215], v2, s[88:91], s45 offen offset:1024 sc1
    s_waitcnt lgkmcnt(3)
    v_mfma_f32_32x32x16_bf16 v[48:63], v[28:31], v[164:167], v[48:63]
    ds_read_b128 v[28:31], v2 offset:39936
    s_waitcnt vmcnt(11)
    s_waitcnt lgkmcnt(3)
    v_mfma_f32_32x32x16_bf16 v[32:47], v[16:19], v[168:171], v[32:47]
    ds_read_b128 v[16:19], v2 offset:40960
    buffer_load_dwordx4 v[216:219], v2, s[88:91], s45 offen offset:2048 sc1
    s_waitcnt lgkmcnt(3)
    v_mfma_f32_32x32x16_bf16 v[48:63], v[20:23], v[168:171], v[48:63]
    ds_read_b128 v[20:23], v2 offset:41984
    s_waitcnt vmcnt(11)
    s_waitcnt lgkmcnt(3)
    v_mfma_f32_32x32x16_bf16 v[32:47], v[24:27], v[172:175], v[32:47]
    ds_read_b128 v[24:27], v2 offset:43008
    buffer_load_dwordx4 v[220:223], v2, s[88:91], s45 offen offset:3072 sc1
    s_waitcnt lgkmcnt(3)
    v_mfma_f32_32x32x16_bf16 v[48:63], v[28:31], v[172:175], v[48:63]
    ds_read_b128 v[28:31], v2 offset:44032
    s_waitcnt vmcnt(11)
    s_waitcnt lgkmcnt(3)
    v_mfma_f32_32x32x16_bf16 v[32:47], v[16:19], v[176:179], v[32:47]
    ds_read_b128 v[16:19], v2 offset:45056
    s_add_u32 s45, s45, 4096
    buffer_load_dwordx4 v[224:227], v2, s[88:91], s45 offen offset:0 sc1
    s_waitcnt lgkmcnt(3)
    v_mfma_f32_32x32x16_bf16 v[48:63], v[20:23], v[176:179], v[48:63]
    ds_read_b128 v[20:23], v2 offset:46080
    s_waitcnt vmcnt(11)
    s_waitcnt lgkmcnt(3)
    v_mfma_f32_32x32x16_bf16 v[32:47], v[24:27], v[180:183], v[32:47]
    ds_read_b128 v[24:27], v2 offset:47104
    buffer_load_dwordx4 v[228:231], v2, s[88:91], s45 offen offset:1024 sc1
    s_waitcnt lgkmcnt(3)
    v_mfma_f32_32x32x16_bf16 v[48:63], v[28:31], v[180:183], v[48:63]
    ds_read_b128 v[28:31], v2 offset:48128
    s_waitcnt vmcnt(11)
    s_waitcnt lgkmcnt(3)
    v_mfma_f32_32x32x16_bf16 v[32:47], v[16:19], v[184:187], v[32:47]
    ds_read_b128 v[16:19], v2 offset:49152
    buffer_load_dwordx4 v[232:235], v2, s[88:91], s45 offen offset:2048 sc1
    s_waitcnt lgkmcnt(3)
    v_mfma_f32_32x32x16_bf16 v[48:63], v[20:23], v[184:187], v[48:63]
    ds_read_b128 v[20:23], v2 offset:50176
    s_waitcnt vmcnt(11)
    s_waitcnt lgkmcnt(3)
    v_mfma_f32_32x32x16_bf16 v[32:47], v[24:27], v[188:191], v[32:47]
    ds_read_b128 v[24:27], v2 offset:51200
    buffer_load_dwordx4 v[236:239], v2, s[88:91], s45 offen offset:3072 sc1
    s_waitcnt lgkmcnt(3)
    v_mfma_f32_32x32x16_bf16 v[48:63], v[28:31], v[188:191], v[48:63]
    ds_read_b128 v[28:31], v2 offset:52224
    s_waitcnt vmcnt(11)
    s_waitcnt lgkmcnt(3)
    v_mfma_f32_32x32x16_bf16 v[32:47], v[16:19], v[192:195], v[32:47]
    ds_read_b128 v[16:19], v2 offset:53248
    s_add_u32 s45, s45, 4096
    buffer_load_dwordx4 v[240:243], v2, s[88:91], s45 offen offset:0 sc1
    s_waitcnt lgkmcnt(3)
    v_mfma_f32_32x32x16_bf16 v[48:63], v[20:23], v[192:195], v[48:63]
    ds_read_b128 v[20:23], v2 offset:54272
    s_waitcnt vmcnt(11)
    s_waitcnt lgkmcnt(3)
    v_mfma_f32_32x32x16_bf16 v[32:47], v[24:27], v[196:199], v[32:47]
    ds_read_b128 v[24:27], v2 offset:55296
    buffer_load_dwordx4 v[244:247], v2, s[88:91], s45 offen offset:1024 sc1
    s_waitcnt lgkmcnt(3)
    v_mfma_f32_32x32x16_bf16 v[48:63], v[28:31], v[196:199], v[48:63]
    ds_read_b128 v[28:31], v2 offset:56320
    s_waitcnt vmcnt(11)
    s_waitcnt lgkmcnt(3)
    v_mfma_f32_32x32x16_bf16 v[32:47], v[16:19], v[200:203], v[32:47]
    ds_read_b128 v[16:19], v2 offset:57344
    buffer_load_dwordx4 v[248:251], v2, s[88:91], s45 offen offset:2048 sc1
    s_waitcnt lgkmcnt(3)
    v_mfma_f32_32x32x16_bf16 v[48:63], v[20:23], v[200:203], v[48:63]
    ds_read_b128 v[20:23], v2 offset:58368
    s_waitcnt vmcnt(11)
    s_waitcnt lgkmcnt(3)
    v_mfma_f32_32x32x16_bf16 v[32:47], v[24:27], v[204:207], v[32:47]
    ds_read_b128 v[24:27], v2 offset:59392
    buffer_load_dwordx4 v[252:255], v2, s[88:91], s45 offen offset:3072 sc1
    s_waitcnt lgkmcnt(3)
    v_mfma_f32_32x32x16_bf16 v[48:63], v[28:31], v[204:207], v[48:63]
    ds_read_b128 v[28:31], v2 offset:60416
    s_waitcnt vmcnt(11)
    s_waitcnt lgkmcnt(3)
    v_mfma_f32_32x32x16_bf16 v[32:47], v[16:19], v[208:211], v[32:47]
    ds_read_b128 v[16:19], v2 offset:61440
    s_waitcnt lgkmcnt(3)
    v_mfma_f32_32x32x16_bf16 v[48:63], v[20:23], v[208:211], v[48:63]
    ds_read_b128 v[20:23], v2 offset:62464
    s_waitcnt vmcnt(10)
    s_waitcnt lgkmcnt(3)
    v_mfma_f32_32x32x16_bf16 v[32:47], v[24:27], v[212:215], v[32:47]
    ds_read_b128 v[24:27], v2 offset:63488
    s_waitcnt lgkmcnt(3)
    v_mfma_f32_32x32x16_bf16 v[48:63], v[28:31], v[212:215], v[48:63]
    ds_read_b128 v[28:31], v2 offset:64512
    s_barrier
    s_waitcnt vmcnt(9)
    s_waitcnt lgkmcnt(3)
    v_mfma_f32_32x32x16_bf16 v[32:47], v[16:19], v[216:219], v[32:47]
    ds_read_b128 v[16:19], v3 offset:0
    v_lshrrev_b32 v4, 1, v2
    v_and_b32 v4, 0xf8, v4
    buffer_load_dwordx2 v[6:7], v4, s[88:91], s44 offen offset:256 sc1
    s_waitcnt lgkmcnt(3)
    v_mfma_f32_32x32x16_bf16 v[48:63], v[20:23], v[216:219], v[48:63]
    ds_read_b128 v[20:23], v3 offset:1024
    buffer_load_dwordx2 v[4:5], v4, s[88:91], s44 offen offset:0 sc1
    s_waitcnt vmcnt(10)
    s_waitcnt lgkmcnt(3)
    v_mfma_f32_32x32x16_bf16 v[32:47], v[24:27], v[220:223], v[32:47]
    ds_read_b128 v[24:27], v3 offset:2048
    s_waitcnt lgkmcnt(3)
    v_mfma_f32_32x32x16_bf16 v[48:63], v[28:31], v[220:223], v[48:63]
    ds_read_b128 v[28:31], v3 offset:3072
    s_waitcnt vmcnt(9)
    s_waitcnt lgkmcnt(3)
    v_mfma_f32_32x32x16_bf16 v[32:47], v[16:19], v[224:227], v[32:47]
    ds_read_b128 v[16:19], v3 offset:4096
    s_waitcnt lgkmcnt(3)
    v_mfma_f32_32x32x16_bf16 v[48:63], v[20:23], v[224:227], v[48:63]
    ds_read_b128 v[20:23], v3 offset:5120
    s_waitcnt vmcnt(8)
    s_waitcnt lgkmcnt(3)
    v_mfma_f32_32x32x16_bf16 v[32:47], v[24:27], v[228:231], v[32:47]
    ds_read_b128 v[24:27], v3 offset:6144
    s_waitcnt lgkmcnt(3)
    v_mfma_f32_32x32x16_bf16 v[48:63], v[28:31], v[228:231], v[48:63]
    ds_read_b128 v[28:31], v3 offset:7168
    s_waitcnt vmcnt(7)
    s_waitcnt lgkmcnt(3)
    v_mfma_f32_32x32x16_bf16 v[32:47], v[16:19], v[232:235], v[32:47]
    ds_read_b128 v[16:19], v3 offset:8192
    s_waitcnt lgkmcnt(3)
    v_mfma_f32_32x32x16_bf16 v[48:63], v[20:23], v[232:235], v[48:63]
    ds_read_b128 v[20:23], v3 offset:9216
    s_waitcnt vmcnt(6)
    s_waitcnt lgkmcnt(3)
    v_mfma_f32_32x32x16_bf16 v[32:47], v[24:27], v[236:239], v[32:47]
    ds_read_b128 v[24:27], v3 offset:10240
    s_waitcnt lgkmcnt(3)
    v_mfma_f32_32x32x16_bf16 v[48:63], v[28:31], v[236:239], v[48:63]
    ds_read_b128 v[28:31], v3 offset:11264
    s_waitcnt vmcnt(5)
    s_waitcnt lgkmcnt(3)
    v_mfma_f32_32x32x16_bf16 v[32:47], v[16:19], v[240:243], v[32:47]
    ds_read_b128 v[16:19], v3 offset:12288
    s_waitcnt lgkmcnt(3)
    v_mfma_f32_32x32x16_bf16 v[48:63], v[20:23], v[240:243], v[48:63]
    ds_read_b128 v[20:23], v3 offset:13312
    s_waitcnt vmcnt(4)
    s_waitcnt lgkmcnt(3)
    v_mfma_f32_32x32x16_bf16 v[32:47], v[24:27], v[244:247], v[32:47]
    ds_read_b128 v[24:27], v3 offset:14336
    s_waitcnt lgkmcnt(3)
    v_mfma_f32_32x32x16_bf16 v[48:63], v[28:31], v[244:247], v[48:63]
    ds_read_b128 v[28:31], v3 offset:15360
    s_waitcnt vmcnt(3)
    s_waitcnt lgkmcnt(3)
    v_mfma_f32_32x32x16_bf16 v[32:47], v[16:19], v[248:251], v[32:47]
    ds_read_b128 v[16:19], v3 offset:16384
    s_waitcnt lgkmcnt(3)
    v_mfma_f32_32x32x16_bf16 v[48:63], v[20:23], v[248:251], v[48:63]
    ds_read_b128 v[20:23], v3 offset:17408
    s_waitcnt vmcnt(2)
    s_waitcnt lgkmcnt(3)
    v_mfma_f32_32x32x16_bf16 v[32:47], v[24:27], v[252:255], v[32:47]
    ds_read_b128 v[24:27], v3 offset:18432
    s_waitcnt lgkmcnt(3)
    v_mfma_f32_32x32x16_bf16 v[48:63], v[28:31], v[252:255], v[48:63]
    ds_read_b128 v[28:31], v3 offset:19456
    s_waitcnt vmcnt(0)
    v_mfma_f32_32x32x16_bf16 v[32:47], v[4:7], v[8:11], v[32:47]
    v_mfma_f32_32x32x16_bf16 v[48:63], v[6:9], v[8:11], v[48:63]
    s_waitcnt lgkmcnt(3)
    v_mfma_f32_32x32x16_bf16 v[64:79], v[16:19], v[96:99], 0
    ds_read_b128 v[16:19], v3 offset:20480
    s_waitcnt lgkmcnt(3)
    v_mfma_f32_32x32x16_bf16 v[80:95], v[20:23], v[96:99], 0
    ds_read_b128 v[20:23], v3 offset:21504
    s_waitcnt lgkmcnt(3)
    v_mfma_f32_32x32x16_bf16 v[64:79], v[24:27], v[100:103], v[64:79]
    ds_read_b128 v[24:27], v3 offset:22528
    s_waitcnt lgkmcnt(3)
    v_mfma_f32_32x32x16_bf16 v[80:95], v[28:31], v[100:103], v[80:95]
    ds_read_b128 v[28:31], v3 offset:23552
    s_waitcnt lgkmcnt(3)
    v_mfma_f32_32x32x16_bf16 v[64:79], v[16:19], v[104:107], v[64:79]
    ds_read_b128 v[16:19], v3 offset:24576
    s_waitcnt lgkmcnt(3)
    v_mfma_f32_32x32x16_bf16 v[80:95], v[20:23], v[104:107], v[80:95]
    ds_read_b128 v[20:23], v3 offset:25600
    s_waitcnt lgkmcnt(3)
    v_mfma_f32_32x32x16_bf16 v[64:79], v[24:27], v[108:111], v[64:79]
    ds_read_b128 v[24:27], v3 offset:26624
    v_lshrrev_b32 v4, 1, v2
    v_and_b32 v4, 0xf8, v4
    buffer_load_dwordx2 v[6:7], v4, s[88:91], s55 offen offset:768 sc1
    s_waitcnt lgkmcnt(3)
    v_mfma_f32_32x32x16_bf16 v[80:95], v[28:31], v[108:111], v[80:95]
    ds_read_b128 v[28:31], v3 offset:27648
    buffer_load_dwordx2 v[4:5], v4, s[88:91], s44 offen offset:512 sc1
    v_mul_f32 v0, v32, v32
    v_mul_f32 v40, v40, v32
    s_waitcnt lgkmcnt(3)
    v_mfma_f32_32x32x16_bf16 v[64:79], v[16:19], v[112:115], v[64:79]
    ds_read_b128 v[16:19], v3 offset:28672
    v_fma_f32 v0, v0, v13, v12
    v_mul_f32 v32, v0, v32
    v_mul_f32 v15, v33, v33
    s_waitcnt lgkmcnt(3)
    v_mfma_f32_32x32x16_bf16 v[80:95], v[20:23], v[112:115], v[80:95]
    ds_read_b128 v[20:23], v3 offset:29696
    v_mul_f32 v41, v41, v33
    v_fma_f32 v15, v15, v13, v12
    v_mul_f32 v33, v15, v33
    s_waitcnt lgkmcnt(3)
    v_mfma_f32_32x32x16_bf16 v[64:79], v[24:27], v[116:119], v[64:79]
    ds_read_b128 v[24:27], v3 offset:30720
    v_mul_f32 v0, v34, v34
    v_mul_f32 v42, v42, v34
    v_fma_f32 v0, v0, v13, v12
    s_waitcnt lgkmcnt(3)
    v_mfma_f32_32x32x16_bf16 v[80:95], v[28:31], v[116:119], v[80:95]
    ds_read_b128 v[28:31], v3 offset:31744
    v_mul_f32 v34, v0, v34
    v_mul_f32 v15, v35, v35
    v_mul_f32 v43, v43, v35
    s_barrier
    s_waitcnt lgkmcnt(3)
    v_mfma_f32_32x32x16_bf16 v[64:79], v[16:19], v[120:123], v[64:79]
    ds_read_b128 v[16:19], v3 offset:32768
    v_fma_f32 v15, v15, v13, v12
    v_mul_f32 v35, v15, v35
    v_mul_f32 v0, v36, v36
    s_waitcnt lgkmcnt(3)
    v_mfma_f32_32x32x16_bf16 v[80:95], v[20:23], v[120:123], v[80:95]
    ds_read_b128 v[20:23], v3 offset:33792
    v_mul_f32 v44, v44, v36
    v_fma_f32 v0, v0, v13, v12
    v_mul_f32 v36, v0, v36
    s_waitcnt lgkmcnt(3)
    v_mfma_f32_32x32x16_bf16 v[64:79], v[24:27], v[124:127], v[64:79]
    ds_read_b128 v[24:27], v3 offset:34816
    v_mul_f32 v15, v37, v37
    v_mul_f32 v45, v45, v37
    v_fma_f32 v15, v15, v13, v12
    s_waitcnt lgkmcnt(3)
    v_mfma_f32_32x32x16_bf16 v[80:95], v[28:31], v[124:127], v[80:95]
    ds_read_b128 v[28:31], v3 offset:35840
    v_mul_f32 v37, v15, v37
    v_mul_f32 v0, v38, v38
    v_mul_f32 v46, v46, v38
    s_waitcnt lgkmcnt(3)
    v_mfma_f32_32x32x16_bf16 v[64:79], v[16:19], v[128:131], v[64:79]
    ds_read_b128 v[16:19], v3 offset:36864
    v_fma_f32 v0, v0, v13, v12
    v_mul_f32 v38, v0, v38
    v_mul_f32 v15, v39, v39
    s_waitcnt lgkmcnt(3)
    v_mfma_f32_32x32x16_bf16 v[80:95], v[20:23], v[128:131], v[80:95]
    ds_read_b128 v[20:23], v3 offset:37888
    v_mul_f32 v47, v47, v39
    v_fma_f32 v15, v15, v13, v12
    v_mul_f32 v39, v15, v39
    s_waitcnt lgkmcnt(3)
    v_mfma_f32_32x32x16_bf16 v[64:79], v[24:27], v[132:135], v[64:79]
    ds_read_b128 v[24:27], v3 offset:38912
    v_exp_f32 v32, v32
    v_exp_f32 v33, v33
    s_waitcnt lgkmcnt(3)
    v_mfma_f32_32x32x16_bf16 v[80:95], v[28:31], v[132:135], v[80:95]
    ds_read_b128 v[28:31], v3 offset:39936
    v_exp_f32 v34, v34
    v_exp_f32 v35, v35
    s_waitcnt lgkmcnt(3)
    v_mfma_f32_32x32x16_bf16 v[64:79], v[16:19], v[136:139], v[64:79]
    ds_read_b128 v[16:19], v3 offset:40960
    v_exp_f32 v36, v36
    v_exp_f32 v37, v37
    s_waitcnt lgkmcnt(3)
    v_mfma_f32_32x32x16_bf16 v[80:95], v[20:23], v[136:139], v[80:95]
    ds_read_b128 v[20:23], v3 offset:41984
    v_exp_f32 v38, v38
    v_exp_f32 v39, v39
    s_waitcnt lgkmcnt(3)
    v_mfma_f32_32x32x16_bf16 v[64:79], v[24:27], v[140:143], v[64:79]
    ds_read_b128 v[24:27], v3 offset:43008
    v_fma_f32 v32, v32, v14, v14
    v_fma_f32 v33, v33, v14, v14
    v_fma_f32 v34, v34, v14, v14
    s_waitcnt lgkmcnt(3)
    v_mfma_f32_32x32x16_bf16 v[80:95], v[28:31], v[140:143], v[80:95]
    ds_read_b128 v[28:31], v3 offset:44032
    v_fma_f32 v35, v35, v14, v14
    v_fma_f32 v36, v36, v14, v14
    v_fma_f32 v37, v37, v14, v14
    s_waitcnt lgkmcnt(3)
    v_mfma_f32_32x32x16_bf16 v[64:79], v[16:19], v[144:147], v[64:79]
    ds_read_b128 v[16:19], v3 offset:45056
    v_fma_f32 v38, v38, v14, v14
    v_fma_f32 v39, v39, v14, v14
    v_rcp_f32 v32, v32
    s_waitcnt lgkmcnt(3)
    v_mfma_f32_32x32x16_bf16 v[80:95], v[20:23], v[144:147], v[80:95]
    ds_read_b128 v[20:23], v3 offset:46080
    v_rcp_f32 v33, v33
    v_rcp_f32 v34, v34
    s_waitcnt lgkmcnt(3)
    v_mfma_f32_32x32x16_bf16 v[64:79], v[24:27], v[148:151], v[64:79]
    ds_read_b128 v[24:27], v3 offset:47104
    v_rcp_f32 v35, v35
    v_rcp_f32 v36, v36
    s_waitcnt lgkmcnt(3)
    v_mfma_f32_32x32x16_bf16 v[80:95], v[28:31], v[148:151], v[80:95]
    ds_read_b128 v[28:31], v3 offset:48128
    v_rcp_f32 v37, v37
    v_rcp_f32 v38, v38
    s_waitcnt lgkmcnt(3)
    v_mfma_f32_32x32x16_bf16 v[64:79], v[16:19], v[152:155], v[64:79]
    ds_read_b128 v[16:19], v3 offset:49152
    v_rcp_f32 v39, v39
    v_mul_f32 v40, v40, v32
    s_waitcnt lgkmcnt(3)
    v_mfma_f32_32x32x16_bf16 v[80:95], v[20:23], v[152:155], v[80:95]
    ds_read_b128 v[20:23], v3 offset:50176
    v_mul_f32 v41, v41, v33
    v_mul_f32 v42, v42, v34
    v_mul_f32 v43, v43, v35
    s_waitcnt lgkmcnt(3)
    v_mfma_f32_32x32x16_bf16 v[64:79], v[24:27], v[156:159], v[64:79]
    ds_read_b128 v[24:27], v3 offset:51200
    v_mul_f32 v44, v44, v36
    v_mul_f32 v45, v45, v37
    v_mul_f32 v46, v46, v38
    s_waitcnt lgkmcnt(3)
    v_mfma_f32_32x32x16_bf16 v[80:95], v[28:31], v[156:159], v[80:95]
    ds_read_b128 v[28:31], v3 offset:52224
    v_mul_f32 v47, v47, v39
    v_cvt_pk_bf16_f32 v32, v40, v41
    v_cvt_pk_bf16_f32 v33, v42, v43
    s_waitcnt lgkmcnt(3)
    v_mfma_f32_32x32x16_bf16 v[64:79], v[16:19], v[160:163], v[64:79]
    ds_read_b128 v[16:19], v3 offset:53248
    v_cvt_pk_bf16_f32 v34, v44, v45
    v_cvt_pk_bf16_f32 v35, v46, v47
    buffer_store_dwordx4 v[32:35], v2, s[88:91], s48 offen sc1
    s_waitcnt lgkmcnt(3)
    v_mfma_f32_32x32x16_bf16 v[80:95], v[20:23], v[160:163], v[80:95]
    ds_read_b128 v[20:23], v3 offset:54272
    v_mul_f32 v0, v48, v48
    v_mul_f32 v56, v56, v48
    v_fma_f32 v0, v0, v13, v12
    s_waitcnt lgkmcnt(3)
    v_mfma_f32_32x32x16_bf16 v[64:79], v[24:27], v[164:167], v[64:79]
    ds_read_b128 v[24:27], v3 offset:55296
    v_mul_f32 v48, v0, v48
    v_mul_f32 v15, v49, v49
    v_mul_f32 v57, v57, v49
    s_waitcnt lgkmcnt(3)
    v_mfma_f32_32x32x16_bf16 v[80:95], v[28:31], v[164:167], v[80:95]
    ds_read_b128 v[28:31], v3 offset:56320
    v_fma_f32 v15, v15, v13, v12
    v_mul_f32 v49, v15, v49
    v_mul_f32 v0, v50, v50
    s_waitcnt lgkmcnt(3)
    v_mfma_f32_32x32x16_bf16 v[64:79], v[16:19], v[168:171], v[64:79]
    ds_read_b128 v[16:19], v3 offset:57344
    v_mul_f32 v58, v58, v50
    v_fma_f32 v0, v0, v13, v12
    v_mul_f32 v50, v0, v50
    s_waitcnt lgkmcnt(3)
    v_mfma_f32_32x32x16_bf16 v[80:95], v[20:23], v[168:171], v[80:95]
    ds_read_b128 v[20:23], v3 offset:58368
    v_mul_f32 v15, v51, v51
    v_mul_f32 v59, v59, v51
    v_fma_f32 v15, v15, v13, v12
    s_waitcnt lgkmcnt(3)
    v_mfma_f32_32x32x16_bf16 v[64:79], v[24:27], v[172:175], v[64:79]
    ds_read_b128 v[24:27], v3 offset:59392
    v_mul_f32 v51, v15, v51
    v_mul_f32 v0, v52, v52
    v_mul_f32 v60, v60, v52
    s_waitcnt lgkmcnt(3)
    v_mfma_f32_32x32x16_bf16 v[80:95], v[28:31], v[172:175], v[80:95]
    ds_read_b128 v[28:31], v3 offset:60416
    v_fma_f32 v0, v0, v13, v12
    v_mul_f32 v52, v0, v52
    v_mul_f32 v15, v53, v53
    s_waitcnt lgkmcnt(3)
    v_mfma_f32_32x32x16_bf16 v[64:79], v[16:19], v[176:179], v[64:79]
    ds_read_b128 v[16:19], v3 offset:61440
    v_mul_f32 v61, v61, v53
    v_fma_f32 v15, v15, v13, v12
    v_mul_f32 v53, v15, v53
    s_waitcnt lgkmcnt(3)
    v_mfma_f32_32x32x16_bf16 v[80:95], v[20:23], v[176:179], v[80:95]
    ds_read_b128 v[20:23], v3 offset:62464
    v_mul_f32 v0, v54, v54
    v_mul_f32 v62, v62, v54
    v_fma_f32 v0, v0, v13, v12
    s_waitcnt lgkmcnt(3)
    v_mfma_f32_32x32x16_bf16 v[64:79], v[24:27], v[180:183], v[64:79]
    ds_read_b128 v[24:27], v3 offset:63488
    v_mul_f32 v54, v0, v54
    v_mul_f32 v15, v55, v55
    v_mul_f32 v63, v63, v55
    s_waitcnt lgkmcnt(3)
    v_mfma_f32_32x32x16_bf16 v[80:95], v[28:31], v[180:183], v[80:95]
    ds_read_b128 v[28:31], v3 offset:64512
    v_fma_f32 v15, v15, v13, v12
    v_mul_f32 v55, v15, v55
    v_exp_f32 v48, v48
    s_barrier
    s_waitcnt lgkmcnt(3)
    v_mfma_f32_32x32x16_bf16 v[64:79], v[16:19], v[184:187], v[64:79]
    ds_read_b128 v[16:19], v2 offset:0
    v_exp_f32 v49, v49
    v_exp_f32 v50, v50
    s_waitcnt lgkmcnt(3)
    v_mfma_f32_32x32x16_bf16 v[80:95], v[20:23], v[184:187], v[80:95]
    ds_read_b128 v[20:23], v2 offset:1024
    v_exp_f32 v51, v51
    v_exp_f32 v52, v52
    s_waitcnt lgkmcnt(3)
    v_mfma_f32_32x32x16_bf16 v[64:79], v[24:27], v[188:191], v[64:79]
    ds_read_b128 v[24:27], v2 offset:2048
    v_exp_f32 v53, v53
    v_exp_f32 v54, v54
    s_waitcnt lgkmcnt(3)
    v_mfma_f32_32x32x16_bf16 v[80:95], v[28:31], v[188:191], v[80:95]
    ds_read_b128 v[28:31], v2 offset:3072
    v_exp_f32 v55, v55
    v_fma_f32 v48, v48, v14, v14
    s_waitcnt lgkmcnt(3)
    v_mfma_f32_32x32x16_bf16 v[64:79], v[16:19], v[192:195], v[64:79]
    ds_read_b128 v[16:19], v2 offset:4096
    v_fma_f32 v49, v49, v14, v14
    v_fma_f32 v50, v50, v14, v14
    v_fma_f32 v51, v51, v14, v14
    s_waitcnt lgkmcnt(3)
    v_mfma_f32_32x32x16_bf16 v[80:95], v[20:23], v[192:195], v[80:95]
    ds_read_b128 v[20:23], v2 offset:5120
    v_fma_f32 v52, v52, v14, v14
    v_fma_f32 v53, v53, v14, v14
    v_fma_f32 v54, v54, v14, v14
    s_waitcnt lgkmcnt(3)
    v_mfma_f32_32x32x16_bf16 v[64:79], v[24:27], v[196:199], v[64:79]
    ds_read_b128 v[24:27], v2 offset:6144
    v_fma_f32 v55, v55, v14, v14
    v_rcp_f32 v48, v48
    s_waitcnt lgkmcnt(3)
    v_mfma_f32_32x32x16_bf16 v[80:95], v[28:31], v[196:199], v[80:95]
    ds_read_b128 v[28:31], v2 offset:7168
    v_rcp_f32 v49, v49
    v_rcp_f32 v50, v50
    s_waitcnt lgkmcnt(3)
    v_mfma_f32_32x32x16_bf16 v[64:79], v[16:19], v[200:203], v[64:79]
    ds_read_b128 v[16:19], v2 offset:8192
    v_rcp_f32 v51, v51
    v_rcp_f32 v52, v52
    s_waitcnt lgkmcnt(3)
    v_mfma_f32_32x32x16_bf16 v[80:95], v[20:23], v[200:203], v[80:95]
    ds_read_b128 v[20:23], v2 offset:9216
    v_rcp_f32 v53, v53
    v_rcp_f32 v54, v54
    s_waitcnt lgkmcnt(3)
    v_mfma_f32_32x32x16_bf16 v[64:79], v[24:27], v[204:207], v[64:79]
    ds_read_b128 v[24:27], v2 offset:10240
    v_rcp_f32 v55, v55
    v_mul_f32 v56, v56, v48
    s_waitcnt lgkmcnt(3)
    v_mfma_f32_32x32x16_bf16 v[80:95], v[28:31], v[204:207], v[80:95]
    ds_read_b128 v[28:31], v2 offset:11264
    v_mul_f32 v57, v57, v49
    v_mul_f32 v58, v58, v50
    v_mul_f32 v59, v59, v51
    s_waitcnt lgkmcnt(3)
    v_mfma_f32_32x32x16_bf16 v[64:79], v[16:19], v[208:211], v[64:79]
    ds_read_b128 v[16:19], v2 offset:12288
    v_mul_f32 v60, v60, v52
    v_mul_f32 v61, v61, v53
    v_mul_f32 v62, v62, v54
    s_waitcnt lgkmcnt(3)
    v_mfma_f32_32x32x16_bf16 v[80:95], v[20:23], v[208:211], v[80:95]
    ds_read_b128 v[20:23], v2 offset:13312
    v_mul_f32 v63, v63, v55
    v_cvt_pk_bf16_f32 v48, v56, v57
    v_cvt_pk_bf16_f32 v49, v58, v59
    s_waitcnt lgkmcnt(3)
    v_mfma_f32_32x32x16_bf16 v[64:79], v[24:27], v[212:215], v[64:79]
    ds_read_b128 v[24:27], v2 offset:14336
    v_cvt_pk_bf16_f32 v50, v60, v61
    v_cvt_pk_bf16_f32 v51, v62, v63
    buffer_store_dwordx4 v[48:51], v2, s[88:91], s49 offen sc1
    s_waitcnt lgkmcnt(3)
    v_mfma_f32_32x32x16_bf16 v[80:95], v[28:31], v[212:215], v[80:95]
    ds_read_b128 v[28:31], v2 offset:15360
    s_waitcnt lgkmcnt(3)
    v_mfma_f32_32x32x16_bf16 v[64:79], v[16:19], v[216:219], v[64:79]
    ds_read_b128 v[16:19], v2 offset:16384
    s_waitcnt lgkmcnt(3)
    v_mfma_f32_32x32x16_bf16 v[80:95], v[20:23], v[216:219], v[80:95]
    ds_read_b128 v[20:23], v2 offset:17408
    s_waitcnt lgkmcnt(3)
    v_mfma_f32_32x32x16_bf16 v[64:79], v[24:27], v[220:223], v[64:79]
    ds_read_b128 v[24:27], v2 offset:18432
    s_waitcnt lgkmcnt(3)
    v_mfma_f32_32x32x16_bf16 v[80:95], v[28:31], v[220:223], v[80:95]
    ds_read_b128 v[28:31], v2 offset:19456
    s_waitcnt lgkmcnt(3)
    v_mfma_f32_32x32x16_bf16 v[64:79], v[16:19], v[224:227], v[64:79]
    ds_read_b128 v[16:19], v2 offset:20480
    s_waitcnt lgkmcnt(3)
    v_mfma_f32_32x32x16_bf16 v[80:95], v[20:23], v[224:227], v[80:95]
    ds_read_b128 v[20:23], v2 offset:21504
    s_waitcnt lgkmcnt(3)
    v_mfma_f32_32x32x16_bf16 v[64:79], v[24:27], v[228:231], v[64:79]
    ds_read_b128 v[24:27], v2 offset:22528
    s_waitcnt lgkmcnt(3)
    v_mfma_f32_32x32x16_bf16 v[80:95], v[28:31], v[228:231], v[80:95]
    ds_read_b128 v[28:31], v2 offset:23552
    s_waitcnt lgkmcnt(3)
    v_mfma_f32_32x32x16_bf16 v[64:79], v[16:19], v[232:235], v[64:79]
    ds_read_b128 v[16:19], v2 offset:24576
    s_waitcnt lgkmcnt(3)
    v_mfma_f32_32x32x16_bf16 v[80:95], v[20:23], v[232:235], v[80:95]
    ds_read_b128 v[20:23], v2 offset:25600
    s_waitcnt lgkmcnt(3)
    v_mfma_f32_32x32x16_bf16 v[64:79], v[24:27], v[236:239], v[64:79]
    ds_read_b128 v[24:27], v2 offset:26624
    s_waitcnt lgkmcnt(3)
    v_mfma_f32_32x32x16_bf16 v[80:95], v[28:31], v[236:239], v[80:95]
    ds_read_b128 v[28:31], v2 offset:27648
    s_waitcnt lgkmcnt(3)
    v_mfma_f32_32x32x16_bf16 v[64:79], v[16:19], v[240:243], v[64:79]
    ds_read_b128 v[16:19], v2 offset:28672
    s_waitcnt lgkmcnt(3)
    v_mfma_f32_32x32x16_bf16 v[80:95], v[20:23], v[240:243], v[80:95]
    ds_read_b128 v[20:23], v2 offset:29696
    s_waitcnt lgkmcnt(3)
    v_mfma_f32_32x32x16_bf16 v[64:79], v[24:27], v[244:247], v[64:79]
    ds_read_b128 v[24:27], v2 offset:30720
    s_waitcnt lgkmcnt(3)
    v_mfma_f32_32x32x16_bf16 v[80:95], v[28:31], v[244:247], v[80:95]
    ds_read_b128 v[28:31], v2 offset:31744
    s_barrier
    s_waitcnt lgkmcnt(3)
    v_mfma_f32_32x32x16_bf16 v[64:79], v[16:19], v[248:251], v[64:79]
    ds_read_b128 v[16:19], v2 offset:32768
    s_waitcnt lgkmcnt(3)
    v_mfma_f32_32x32x16_bf16 v[80:95], v[20:23], v[248:251], v[80:95]
    ds_read_b128 v[20:23], v2 offset:33792
    s_waitcnt lgkmcnt(3)
    v_mfma_f32_32x32x16_bf16 v[64:79], v[24:27], v[252:255], v[64:79]
    ds_read_b128 v[24:27], v2 offset:34816
    s_waitcnt lgkmcnt(3)
    v_mfma_f32_32x32x16_bf16 v[80:95], v[28:31], v[252:255], v[80:95]
    ds_read_b128 v[28:31], v2 offset:35840
    s_waitcnt vmcnt(2)
    v_mfma_f32_32x32x16_bf16 v[64:79], v[4:7], v[8:11], v[64:79]
    v_mfma_f32_32x32x16_bf16 v[80:95], v[6:9], v[8:11], v[80:95]
    s_waitcnt lgkmcnt(3)
    v_mfma_f32_32x32x16_bf16 v[32:47], v[16:19], v[96:99], 0
    ds_read_b128 v[16:19], v2 offset:36864
    s_waitcnt lgkmcnt(3)
    v_mfma_f32_32x32x16_bf16 v[48:63], v[20:23], v[96:99], 0
    ds_read_b128 v[20:23], v2 offset:37888
    s_waitcnt lgkmcnt(3)
    v_mfma_f32_32x32x16_bf16 v[32:47], v[24:27], v[100:103], v[32:47]
    ds_read_b128 v[24:27], v2 offset:38912
    s_waitcnt lgkmcnt(3)
    v_mfma_f32_32x32x16_bf16 v[48:63], v[28:31], v[100:103], v[48:63]
    ds_read_b128 v[28:31], v2 offset:39936
    s_waitcnt lgkmcnt(3)
    v_mfma_f32_32x32x16_bf16 v[32:47], v[16:19], v[104:107], v[32:47]
    ds_read_b128 v[16:19], v2 offset:40960
    s_waitcnt lgkmcnt(3)
    v_mfma_f32_32x32x16_bf16 v[48:63], v[20:23], v[104:107], v[48:63]
    ds_read_b128 v[20:23], v2 offset:41984
    s_waitcnt lgkmcnt(3)
    v_mfma_f32_32x32x16_bf16 v[32:47], v[24:27], v[108:111], v[32:47]
    ds_read_b128 v[24:27], v2 offset:43008
    v_lshrrev_b32 v4, 1, v2
    v_and_b32 v4, 0xf8, v4
    buffer_load_dwordx2 v[6:7], v4, s[88:91], s55 offen offset:1280 sc1
    s_waitcnt lgkmcnt(3)
    v_mfma_f32_32x32x16_bf16 v[48:63], v[28:31], v[108:111], v[48:63]
    ds_read_b128 v[28:31], v2 offset:44032
    buffer_load_dwordx2 v[4:5], v4, s[88:91], s55 offen offset:1024 sc1
    v_mul_f32 v0, v64, v64
    v_mul_f32 v72, v72, v64
    s_waitcnt lgkmcnt(3)
    v_mfma_f32_32x32x16_bf16 v[32:47], v[16:19], v[112:115], v[32:47]
    ds_read_b128 v[16:19], v2 offset:45056
    v_fma_f32 v0, v0, v13, v12
    v_mul_f32 v64, v0, v64
    v_mul_f32 v15, v65, v65
    s_waitcnt lgkmcnt(3)
    v_mfma_f32_32x32x16_bf16 v[48:63], v[20:23], v[112:115], v[48:63]
    ds_read_b128 v[20:23], v2 offset:46080
    v_mul_f32 v73, v73, v65
    v_fma_f32 v15, v15, v13, v12
    v_mul_f32 v65, v15, v65
    s_waitcnt lgkmcnt(3)
    v_mfma_f32_32x32x16_bf16 v[32:47], v[24:27], v[116:119], v[32:47]
    ds_read_b128 v[24:27], v2 offset:47104
    v_mul_f32 v0, v66, v66
    v_mul_f32 v74, v74, v66
    v_fma_f32 v0, v0, v13, v12
    s_waitcnt lgkmcnt(3)
    v_mfma_f32_32x32x16_bf16 v[48:63], v[28:31], v[116:119], v[48:63]
    ds_read_b128 v[28:31], v2 offset:48128
    v_mul_f32 v66, v0, v66
    v_mul_f32 v15, v67, v67
    v_mul_f32 v75, v75, v67
    s_waitcnt lgkmcnt(3)
    v_mfma_f32_32x32x16_bf16 v[32:47], v[16:19], v[120:123], v[32:47]
    ds_read_b128 v[16:19], v2 offset:49152
    v_fma_f32 v15, v15, v13, v12
    v_mul_f32 v67, v15, v67
    v_mul_f32 v0, v68, v68
    s_waitcnt lgkmcnt(3)
    v_mfma_f32_32x32x16_bf16 v[48:63], v[20:23], v[120:123], v[48:63]
    ds_read_b128 v[20:23], v2 offset:50176
    v_mul_f32 v76, v76, v68
    v_fma_f32 v0, v0, v13, v12
    v_mul_f32 v68, v0, v68
    s_waitcnt lgkmcnt(3)
    v_mfma_f32_32x32x16_bf16 v[32:47], v[24:27], v[124:127], v[32:47]
    ds_read_b128 v[24:27], v2 offset:51200
    v_mul_f32 v15, v69, v69
    v_mul_f32 v77, v77, v69
    v_fma_f32 v15, v15, v13, v12
    s_waitcnt lgkmcnt(3)
    v_mfma_f32_32x32x16_bf16 v[48:63], v[28:31], v[124:127], v[48:63]
    ds_read_b128 v[28:31], v2 offset:52224
    v_mul_f32 v69, v15, v69
    v_mul_f32 v0, v70, v70
    v_mul_f32 v78, v78, v70
    s_waitcnt lgkmcnt(3)
    v_mfma_f32_32x32x16_bf16 v[32:47], v[16:19], v[128:131], v[32:47]
    ds_read_b128 v[16:19], v2 offset:53248
    v_fma_f32 v0, v0, v13, v12
    v_mul_f32 v70, v0, v70
    v_mul_f32 v15, v71, v71
    s_waitcnt lgkmcnt(3)
    v_mfma_f32_32x32x16_bf16 v[48:63], v[20:23], v[128:131], v[48:63]
    ds_read_b128 v[20:23], v2 offset:54272
    v_mul_f32 v79, v79, v71
    v_fma_f32 v15, v15, v13, v12
    v_mul_f32 v71, v15, v71
    s_waitcnt lgkmcnt(3)
    v_mfma_f32_32x32x16_bf16 v[32:47], v[24:27], v[132:135], v[32:47]
    ds_read_b128 v[24:27], v2 offset:55296
    v_exp_f32 v64, v64
    v_exp_f32 v65, v65
    s_waitcnt lgkmcnt(3)
    v_mfma_f32_32x32x16_bf16 v[48:63], v[28:31], v[132:135], v[48:63]
    ds_read_b128 v[28:31], v2 offset:56320
    v_exp_f32 v66, v66
    v_exp_f32 v67, v67
    s_waitcnt lgkmcnt(3)
    v_mfma_f32_32x32x16_bf16 v[32:47], v[16:19], v[136:139], v[32:47]
    ds_read_b128 v[16:19], v2 offset:57344
    v_exp_f32 v68, v68
    v_exp_f32 v69, v69
    s_waitcnt lgkmcnt(3)
    v_mfma_f32_32x32x16_bf16 v[48:63], v[20:23], v[136:139], v[48:63]
    ds_read_b128 v[20:23], v2 offset:58368
    v_exp_f32 v70, v70
    v_exp_f32 v71, v71
    s_waitcnt lgkmcnt(3)
    v_mfma_f32_32x32x16_bf16 v[32:47], v[24:27], v[140:143], v[32:47]
    ds_read_b128 v[24:27], v2 offset:59392
    v_fma_f32 v64, v64, v14, v14
    v_fma_f32 v65, v65, v14, v14
    v_fma_f32 v66, v66, v14, v14
    s_waitcnt lgkmcnt(3)
    v_mfma_f32_32x32x16_bf16 v[48:63], v[28:31], v[140:143], v[48:63]
    ds_read_b128 v[28:31], v2 offset:60416
    v_fma_f32 v67, v67, v14, v14
    v_fma_f32 v68, v68, v14, v14
    v_fma_f32 v69, v69, v14, v14
    s_waitcnt lgkmcnt(3)
    v_mfma_f32_32x32x16_bf16 v[32:47], v[16:19], v[144:147], v[32:47]
    ds_read_b128 v[16:19], v2 offset:61440
    v_fma_f32 v70, v70, v14, v14
    v_fma_f32 v71, v71, v14, v14
    v_rcp_f32 v64, v64
    s_waitcnt lgkmcnt(3)
    v_mfma_f32_32x32x16_bf16 v[48:63], v[20:23], v[144:147], v[48:63]
    ds_read_b128 v[20:23], v2 offset:62464
    v_rcp_f32 v65, v65
    v_rcp_f32 v66, v66
    s_waitcnt lgkmcnt(3)
    v_mfma_f32_32x32x16_bf16 v[32:47], v[24:27], v[148:151], v[32:47]
    ds_read_b128 v[24:27], v2 offset:63488
    v_rcp_f32 v67, v67
    v_rcp_f32 v68, v68
    s_waitcnt lgkmcnt(3)
    v_mfma_f32_32x32x16_bf16 v[48:63], v[28:31], v[148:151], v[48:63]
    ds_read_b128 v[28:31], v2 offset:64512
    v_rcp_f32 v69, v69
    v_rcp_f32 v70, v70
    s_barrier
    s_waitcnt lgkmcnt(3)
    v_mfma_f32_32x32x16_bf16 v[32:47], v[16:19], v[152:155], v[32:47]
    ds_read_b128 v[16:19], v3 offset:0
    v_rcp_f32 v71, v71
    v_mul_f32 v72, v72, v64
    s_waitcnt lgkmcnt(3)
    v_mfma_f32_32x32x16_bf16 v[48:63], v[20:23], v[152:155], v[48:63]
    ds_read_b128 v[20:23], v3 offset:1024
    v_mul_f32 v73, v73, v65
    v_mul_f32 v74, v74, v66
    v_mul_f32 v75, v75, v67
    s_waitcnt lgkmcnt(3)
    v_mfma_f32_32x32x16_bf16 v[32:47], v[24:27], v[156:159], v[32:47]
    ds_read_b128 v[24:27], v3 offset:2048
    v_mul_f32 v76, v76, v68
    v_mul_f32 v77, v77, v69
    v_mul_f32 v78, v78, v70
    s_waitcnt lgkmcnt(3)
    v_mfma_f32_32x32x16_bf16 v[48:63], v[28:31], v[156:159], v[48:63]
    ds_read_b128 v[28:31], v3 offset:3072
    v_mul_f32 v79, v79, v71
    v_cvt_pk_bf16_f32 v64, v72, v73
    v_cvt_pk_bf16_f32 v65, v74, v75
    s_waitcnt lgkmcnt(3)
    v_mfma_f32_32x32x16_bf16 v[32:47], v[16:19], v[160:163], v[32:47]
    ds_read_b128 v[16:19], v3 offset:4096
    v_cvt_pk_bf16_f32 v66, v76, v77
    v_cvt_pk_bf16_f32 v67, v78, v79
    buffer_store_dwordx4 v[64:67], v2, s[88:91], s50 offen sc1
    s_waitcnt lgkmcnt(3)
    v_mfma_f32_32x32x16_bf16 v[48:63], v[20:23], v[160:163], v[48:63]
    ds_read_b128 v[20:23], v3 offset:5120
    v_mul_f32 v0, v80, v80
    v_mul_f32 v88, v88, v80
    v_fma_f32 v0, v0, v13, v12
    s_waitcnt lgkmcnt(3)
    v_mfma_f32_32x32x16_bf16 v[32:47], v[24:27], v[164:167], v[32:47]
    ds_read_b128 v[24:27], v3 offset:6144
    v_mul_f32 v80, v0, v80
    v_mul_f32 v15, v81, v81
    v_mul_f32 v89, v89, v81
    s_waitcnt lgkmcnt(3)
    v_mfma_f32_32x32x16_bf16 v[48:63], v[28:31], v[164:167], v[48:63]
    ds_read_b128 v[28:31], v3 offset:7168
    v_fma_f32 v15, v15, v13, v12
    v_mul_f32 v81, v15, v81
    v_mul_f32 v0, v82, v82
    s_waitcnt lgkmcnt(3)
    v_mfma_f32_32x32x16_bf16 v[32:47], v[16:19], v[168:171], v[32:47]
    ds_read_b128 v[16:19], v3 offset:8192
    v_mul_f32 v90, v90, v82
    v_fma_f32 v0, v0, v13, v12
    v_mul_f32 v82, v0, v82
    s_waitcnt lgkmcnt(3)
    v_mfma_f32_32x32x16_bf16 v[48:63], v[20:23], v[168:171], v[48:63]
    ds_read_b128 v[20:23], v3 offset:9216
    v_mul_f32 v15, v83, v83
    v_mul_f32 v91, v91, v83
    v_fma_f32 v15, v15, v13, v12
    s_waitcnt lgkmcnt(3)
    v_mfma_f32_32x32x16_bf16 v[32:47], v[24:27], v[172:175], v[32:47]
    ds_read_b128 v[24:27], v3 offset:10240
    v_mul_f32 v83, v15, v83
    v_mul_f32 v0, v84, v84
    v_mul_f32 v92, v92, v84
    s_waitcnt lgkmcnt(3)
    v_mfma_f32_32x32x16_bf16 v[48:63], v[28:31], v[172:175], v[48:63]
    ds_read_b128 v[28:31], v3 offset:11264
    v_fma_f32 v0, v0, v13, v12
    v_mul_f32 v84, v0, v84
    v_mul_f32 v15, v85, v85
    s_waitcnt lgkmcnt(3)
    v_mfma_f32_32x32x16_bf16 v[32:47], v[16:19], v[176:179], v[32:47]
    ds_read_b128 v[16:19], v3 offset:12288
    v_mul_f32 v93, v93, v85
    v_fma_f32 v15, v15, v13, v12
    v_mul_f32 v85, v15, v85
    s_waitcnt lgkmcnt(3)
    v_mfma_f32_32x32x16_bf16 v[48:63], v[20:23], v[176:179], v[48:63]
    ds_read_b128 v[20:23], v3 offset:13312
    v_mul_f32 v0, v86, v86
    v_mul_f32 v94, v94, v86
    v_fma_f32 v0, v0, v13, v12
    s_waitcnt lgkmcnt(3)
    v_mfma_f32_32x32x16_bf16 v[32:47], v[24:27], v[180:183], v[32:47]
    ds_read_b128 v[24:27], v3 offset:14336
    v_mul_f32 v86, v0, v86
    v_mul_f32 v15, v87, v87
    v_mul_f32 v95, v95, v87
    s_waitcnt lgkmcnt(3)
    v_mfma_f32_32x32x16_bf16 v[48:63], v[28:31], v[180:183], v[48:63]
    ds_read_b128 v[28:31], v3 offset:15360
    v_fma_f32 v15, v15, v13, v12
    v_mul_f32 v87, v15, v87
    v_exp_f32 v80, v80
    s_waitcnt lgkmcnt(3)
    v_mfma_f32_32x32x16_bf16 v[32:47], v[16:19], v[184:187], v[32:47]
    ds_read_b128 v[16:19], v3 offset:16384
    v_exp_f32 v81, v81
    v_exp_f32 v82, v82
    s_waitcnt lgkmcnt(3)
    v_mfma_f32_32x32x16_bf16 v[48:63], v[20:23], v[184:187], v[48:63]
    ds_read_b128 v[20:23], v3 offset:17408
    v_exp_f32 v83, v83
    v_exp_f32 v84, v84
    s_waitcnt lgkmcnt(3)
    v_mfma_f32_32x32x16_bf16 v[32:47], v[24:27], v[188:191], v[32:47]
    ds_read_b128 v[24:27], v3 offset:18432
    v_exp_f32 v85, v85
    v_exp_f32 v86, v86
    s_waitcnt lgkmcnt(3)
    v_mfma_f32_32x32x16_bf16 v[48:63], v[28:31], v[188:191], v[48:63]
    ds_read_b128 v[28:31], v3 offset:19456
    v_exp_f32 v87, v87
    v_fma_f32 v80, v80, v14, v14
    s_waitcnt lgkmcnt(3)
    v_mfma_f32_32x32x16_bf16 v[32:47], v[16:19], v[192:195], v[32:47]
    ds_read_b128 v[16:19], v3 offset:20480
    v_fma_f32 v81, v81, v14, v14
    v_fma_f32 v82, v82, v14, v14
    v_fma_f32 v83, v83, v14, v14
    s_waitcnt lgkmcnt(3)
    v_mfma_f32_32x32x16_bf16 v[48:63], v[20:23], v[192:195], v[48:63]
    ds_read_b128 v[20:23], v3 offset:21504
    v_fma_f32 v84, v84, v14, v14
    v_fma_f32 v85, v85, v14, v14
    v_fma_f32 v86, v86, v14, v14
    s_waitcnt lgkmcnt(3)
    v_mfma_f32_32x32x16_bf16 v[32:47], v[24:27], v[196:199], v[32:47]
    ds_read_b128 v[24:27], v3 offset:22528
    v_fma_f32 v87, v87, v14, v14
    v_rcp_f32 v80, v80
    s_waitcnt lgkmcnt(3)
    v_mfma_f32_32x32x16_bf16 v[48:63], v[28:31], v[196:199], v[48:63]
    ds_read_b128 v[28:31], v3 offset:23552
    v_rcp_f32 v81, v81
    v_rcp_f32 v82, v82
    s_waitcnt lgkmcnt(3)
    v_mfma_f32_32x32x16_bf16 v[32:47], v[16:19], v[200:203], v[32:47]
    ds_read_b128 v[16:19], v3 offset:24576
    v_rcp_f32 v83, v83
    v_rcp_f32 v84, v84
    s_waitcnt lgkmcnt(3)
    v_mfma_f32_32x32x16_bf16 v[48:63], v[20:23], v[200:203], v[48:63]
    ds_read_b128 v[20:23], v3 offset:25600
    v_rcp_f32 v85, v85
    v_rcp_f32 v86, v86
    s_waitcnt lgkmcnt(3)
    v_mfma_f32_32x32x16_bf16 v[32:47], v[24:27], v[204:207], v[32:47]
    ds_read_b128 v[24:27], v3 offset:26624
    v_rcp_f32 v87, v87
    v_mul_f32 v88, v88, v80
    s_waitcnt lgkmcnt(3)
    v_mfma_f32_32x32x16_bf16 v[48:63], v[28:31], v[204:207], v[48:63]
    ds_read_b128 v[28:31], v3 offset:27648
    v_mul_f32 v89, v89, v81
    v_mul_f32 v90, v90, v82
    v_mul_f32 v91, v91, v83
    s_waitcnt lgkmcnt(3)
    v_mfma_f32_32x32x16_bf16 v[32:47], v[16:19], v[208:211], v[32:47]
    ds_read_b128 v[16:19], v3 offset:28672
    v_mul_f32 v92, v92, v84
    v_mul_f32 v93, v93, v85
    v_mul_f32 v94, v94, v86
    s_waitcnt lgkmcnt(3)
    v_mfma_f32_32x32x16_bf16 v[48:63], v[20:23], v[208:211], v[48:63]
    ds_read_b128 v[20:23], v3 offset:29696
    v_mul_f32 v95, v95, v87
    v_cvt_pk_bf16_f32 v80, v88, v89
    v_cvt_pk_bf16_f32 v81, v90, v91
    s_waitcnt lgkmcnt(3)
    v_mfma_f32_32x32x16_bf16 v[32:47], v[24:27], v[212:215], v[32:47]
    ds_read_b128 v[24:27], v3 offset:30720
    v_cvt_pk_bf16_f32 v82, v92, v93
    v_cvt_pk_bf16_f32 v83, v94, v95
    buffer_store_dwordx4 v[80:83], v2, s[88:91], s51 offen sc1
    s_waitcnt lgkmcnt(3)
    v_mfma_f32_32x32x16_bf16 v[48:63], v[28:31], v[212:215], v[48:63]
    ds_read_b128 v[28:31], v3 offset:31744
    s_barrier
    s_waitcnt lgkmcnt(3)
    v_mfma_f32_32x32x16_bf16 v[32:47], v[16:19], v[216:219], v[32:47]
    ds_read_b128 v[16:19], v3 offset:32768
    s_waitcnt lgkmcnt(3)
    v_mfma_f32_32x32x16_bf16 v[48:63], v[20:23], v[216:219], v[48:63]
    ds_read_b128 v[20:23], v3 offset:33792
    s_waitcnt lgkmcnt(3)
    v_mfma_f32_32x32x16_bf16 v[32:47], v[24:27], v[220:223], v[32:47]
    ds_read_b128 v[24:27], v3 offset:34816
    s_waitcnt lgkmcnt(3)
    v_mfma_f32_32x32x16_bf16 v[48:63], v[28:31], v[220:223], v[48:63]
    ds_read_b128 v[28:31], v3 offset:35840
    s_waitcnt lgkmcnt(3)
    v_mfma_f32_32x32x16_bf16 v[32:47], v[16:19], v[224:227], v[32:47]
    ds_read_b128 v[16:19], v3 offset:36864
    s_waitcnt lgkmcnt(3)
    v_mfma_f32_32x32x16_bf16 v[48:63], v[20:23], v[224:227], v[48:63]
    ds_read_b128 v[20:23], v3 offset:37888
    s_waitcnt lgkmcnt(3)
    v_mfma_f32_32x32x16_bf16 v[32:47], v[24:27], v[228:231], v[32:47]
    ds_read_b128 v[24:27], v3 offset:38912
    s_waitcnt lgkmcnt(3)
    v_mfma_f32_32x32x16_bf16 v[48:63], v[28:31], v[228:231], v[48:63]
    ds_read_b128 v[28:31], v3 offset:39936
    s_waitcnt lgkmcnt(3)
    v_mfma_f32_32x32x16_bf16 v[32:47], v[16:19], v[232:235], v[32:47]
    ds_read_b128 v[16:19], v3 offset:40960
    s_waitcnt lgkmcnt(3)
    v_mfma_f32_32x32x16_bf16 v[48:63], v[20:23], v[232:235], v[48:63]
    ds_read_b128 v[20:23], v3 offset:41984
    s_waitcnt lgkmcnt(3)
    v_mfma_f32_32x32x16_bf16 v[32:47], v[24:27], v[236:239], v[32:47]
    ds_read_b128 v[24:27], v3 offset:43008
    s_waitcnt lgkmcnt(3)
    v_mfma_f32_32x32x16_bf16 v[48:63], v[28:31], v[236:239], v[48:63]
    ds_read_b128 v[28:31], v3 offset:44032
    s_waitcnt lgkmcnt(3)
    v_mfma_f32_32x32x16_bf16 v[32:47], v[16:19], v[240:243], v[32:47]
    ds_read_b128 v[16:19], v3 offset:45056
    s_waitcnt lgkmcnt(3)
    v_mfma_f32_32x32x16_bf16 v[48:63], v[20:23], v[240:243], v[48:63]
    ds_read_b128 v[20:23], v3 offset:46080
    s_waitcnt lgkmcnt(3)
    v_mfma_f32_32x32x16_bf16 v[32:47], v[24:27], v[244:247], v[32:47]
    ds_read_b128 v[24:27], v3 offset:47104
    s_waitcnt lgkmcnt(3)
    v_mfma_f32_32x32x16_bf16 v[48:63], v[28:31], v[244:247], v[48:63]
    ds_read_b128 v[28:31], v3 offset:48128
    s_waitcnt lgkmcnt(3)
    v_mfma_f32_32x32x16_bf16 v[32:47], v[16:19], v[248:251], v[32:47]
    ds_read_b128 v[16:19], v3 offset:49152
    s_waitcnt lgkmcnt(3)
    v_mfma_f32_32x32x16_bf16 v[48:63], v[20:23], v[248:251], v[48:63]
    ds_read_b128 v[20:23], v3 offset:50176
    s_waitcnt lgkmcnt(3)
    v_mfma_f32_32x32x16_bf16 v[32:47], v[24:27], v[252:255], v[32:47]
    ds_read_b128 v[24:27], v3 offset:51200
    s_waitcnt lgkmcnt(3)
    v_mfma_f32_32x32x16_bf16 v[48:63], v[28:31], v[252:255], v[48:63]
    ds_read_b128 v[28:31], v3 offset:52224
    s_waitcnt vmcnt(2)
    v_mfma_f32_32x32x16_bf16 v[32:47], v[4:7], v[8:11], v[32:47]
    v_mfma_f32_32x32x16_bf16 v[48:63], v[6:9], v[8:11], v[48:63]
    s_waitcnt lgkmcnt(3)
    v_mfma_f32_32x32x16_bf16 v[64:79], v[16:19], v[96:99], 0
    ds_read_b128 v[16:19], v3 offset:53248
    s_waitcnt lgkmcnt(3)
    v_mfma_f32_32x32x16_bf16 v[64:79], v[20:23], v[100:103], v[64:79]
    ds_read_b128 v[20:23], v3 offset:54272
    s_waitcnt lgkmcnt(3)
    v_mfma_f32_32x32x16_bf16 v[64:79], v[24:27], v[104:107], v[64:79]
    ds_read_b128 v[24:27], v3 offset:55296
    s_waitcnt lgkmcnt(3)
    v_mfma_f32_32x32x16_bf16 v[64:79], v[28:31], v[108:111], v[64:79]
    ds_read_b128 v[28:31], v3 offset:56320
    s_waitcnt lgkmcnt(3)
    v_mfma_f32_32x32x16_bf16 v[64:79], v[16:19], v[112:115], v[64:79]
    ds_read_b128 v[16:19], v3 offset:57344
    s_waitcnt lgkmcnt(3)
    v_mfma_f32_32x32x16_bf16 v[64:79], v[20:23], v[116:119], v[64:79]
    ds_read_b128 v[20:23], v3 offset:58368
    s_waitcnt lgkmcnt(3)
    v_mfma_f32_32x32x16_bf16 v[64:79], v[24:27], v[120:123], v[64:79]
    ds_read_b128 v[24:27], v3 offset:59392
    v_lshrrev_b32 v4, 1, v2
    v_and_b32 v4, 0xf8, v4
    buffer_load_dwordx2 v[6:7], v4, s[88:91], s55 offen offset:1536 sc1
    buffer_load_dwordx2 v[4:5], v4, s[88:91], s55 offen offset:1536 sc1
    v_mul_f32 v0, v32, v32
    s_waitcnt lgkmcnt(3)
    v_mfma_f32_32x32x16_bf16 v[64:79], v[28:31], v[124:127], v[64:79]
    ds_read_b128 v[28:31], v3 offset:60416
    v_mul_f32 v40, v40, v32
    v_fma_f32 v0, v0, v13, v12
    v_mul_f32 v32, v0, v32
    v_mul_f32 v15, v33, v33
    v_mul_f32 v41, v41, v33
    s_waitcnt lgkmcnt(3)
    v_mfma_f32_32x32x16_bf16 v[64:79], v[16:19], v[128:131], v[64:79]
    ds_read_b128 v[16:19], v3 offset:61440
    v_fma_f32 v15, v15, v13, v12
    v_mul_f32 v33, v15, v33
    v_mul_f32 v0, v34, v34
    v_mul_f32 v42, v42, v34
    v_fma_f32 v0, v0, v13, v12
    s_waitcnt lgkmcnt(3)
    v_mfma_f32_32x32x16_bf16 v[64:79], v[20:23], v[132:135], v[64:79]
    ds_read_b128 v[20:23], v3 offset:62464
    v_mul_f32 v34, v0, v34
    v_mul_f32 v15, v35, v35
    v_mul_f32 v43, v43, v35
    v_fma_f32 v15, v15, v13, v12
    v_mul_f32 v35, v15, v35
    s_waitcnt lgkmcnt(3)
    v_mfma_f32_32x32x16_bf16 v[64:79], v[24:27], v[136:139], v[64:79]
    ds_read_b128 v[24:27], v3 offset:63488
    v_mul_f32 v0, v36, v36
    v_mul_f32 v44, v44, v36
    v_fma_f32 v0, v0, v13, v12
    v_mul_f32 v36, v0, v36
    v_mul_f32 v15, v37, v37
    s_waitcnt lgkmcnt(3)
    v_mfma_f32_32x32x16_bf16 v[64:79], v[28:31], v[140:143], v[64:79]
    ds_read_b128 v[28:31], v3 offset:64512
    v_mul_f32 v45, v45, v37
    v_fma_f32 v15, v15, v13, v12
    v_mul_f32 v37, v15, v37
    v_mul_f32 v0, v38, v38
    v_mul_f32 v46, v46, v38
    s_waitcnt vmcnt(2)
    s_barrier
    s_waitcnt lgkmcnt(3)
    v_mfma_f32_32x32x16_bf16 v[64:79], v[16:19], v[144:147], v[64:79]
    ds_read_b128 v[16:19], v2 offset:0
    v_fma_f32 v0, v0, v13, v12
    v_mul_f32 v38, v0, v38
    v_mul_f32 v15, v39, v39
    v_mul_f32 v47, v47, v39
    v_fma_f32 v15, v15, v13, v12
    s_waitcnt lgkmcnt(3)
    v_mfma_f32_32x32x16_bf16 v[64:79], v[20:23], v[148:151], v[64:79]
    ds_read_b128 v[20:23], v2 offset:1024
    v_mul_f32 v39, v15, v39
    v_exp_f32 v32, v32
    v_exp_f32 v33, v33
    s_waitcnt lgkmcnt(3)
    v_mfma_f32_32x32x16_bf16 v[64:79], v[24:27], v[152:155], v[64:79]
    ds_read_b128 v[24:27], v2 offset:2048
    v_exp_f32 v34, v34
    v_exp_f32 v35, v35
    v_exp_f32 v36, v36
    s_waitcnt lgkmcnt(3)
    v_mfma_f32_32x32x16_bf16 v[64:79], v[28:31], v[156:159], v[64:79]
    ds_read_b128 v[28:31], v2 offset:3072
    v_exp_f32 v37, v37
    v_exp_f32 v38, v38
    v_exp_f32 v39, v39
    s_waitcnt lgkmcnt(3)
    v_mfma_f32_32x32x16_bf16 v[64:79], v[16:19], v[160:163], v[64:79]
    ds_read_b128 v[16:19], v2 offset:4096
    v_fma_f32 v32, v32, v14, v14
    v_fma_f32 v33, v33, v14, v14
    v_fma_f32 v34, v34, v14, v14
    v_fma_f32 v35, v35, v14, v14
    v_fma_f32 v36, v36, v14, v14
    s_waitcnt lgkmcnt(3)
    v_mfma_f32_32x32x16_bf16 v[64:79], v[20:23], v[164:167], v[64:79]
    ds_read_b128 v[20:23], v2 offset:5120
    v_fma_f32 v37, v37, v14, v14
    v_fma_f32 v38, v38, v14, v14
    v_fma_f32 v39, v39, v14, v14
    v_rcp_f32 v32, v32
    s_waitcnt lgkmcnt(3)
    v_mfma_f32_32x32x16_bf16 v[64:79], v[24:27], v[168:171], v[64:79]
    ds_read_b128 v[24:27], v2 offset:6144
    v_rcp_f32 v33, v33
    v_rcp_f32 v34, v34
    v_rcp_f32 v35, v35
    s_waitcnt lgkmcnt(3)
    v_mfma_f32_32x32x16_bf16 v[64:79], v[28:31], v[172:175], v[64:79]
    ds_read_b128 v[28:31], v2 offset:7168
    v_rcp_f32 v36, v36
    v_rcp_f32 v37, v37
    v_rcp_f32 v38, v38
    s_waitcnt lgkmcnt(3)
    v_mfma_f32_32x32x16_bf16 v[64:79], v[16:19], v[176:179], v[64:79]
    ds_read_b128 v[16:19], v2 offset:8192
    v_rcp_f32 v39, v39
    v_mul_f32 v40, v40, v32
    v_mul_f32 v41, v41, v33
    v_mul_f32 v42, v42, v34
    s_waitcnt lgkmcnt(3)
    v_mfma_f32_32x32x16_bf16 v[64:79], v[20:23], v[180:183], v[64:79]
    ds_read_b128 v[20:23], v2 offset:9216
    v_mul_f32 v43, v43, v35
    v_mul_f32 v44, v44, v36
    v_mul_f32 v45, v45, v37
    v_mul_f32 v46, v46, v38
    v_mul_f32 v47, v47, v39
    s_waitcnt lgkmcnt(3)
    v_mfma_f32_32x32x16_bf16 v[64:79], v[24:27], v[184:187], v[64:79]
    ds_read_b128 v[24:27], v2 offset:10240
    v_cvt_pk_bf16_f32 v32, v40, v41
    v_cvt_pk_bf16_f32 v33, v42, v43
    v_cvt_pk_bf16_f32 v34, v44, v45
    v_cvt_pk_bf16_f32 v35, v46, v47
    buffer_store_dwordx4 v[32:35], v2, s[88:91], s52 offen sc1
    s_waitcnt lgkmcnt(3)
    v_mfma_f32_32x32x16_bf16 v[64:79], v[28:31], v[188:191], v[64:79]
    ds_read_b128 v[28:31], v2 offset:11264
    v_mul_f32 v0, v48, v48
    v_mul_f32 v56, v56, v48
    v_fma_f32 v0, v0, v13, v12
    v_mul_f32 v48, v0, v48
    v_mul_f32 v15, v49, v49
    s_waitcnt lgkmcnt(3)
    v_mfma_f32_32x32x16_bf16 v[64:79], v[16:19], v[192:195], v[64:79]
    ds_read_b128 v[16:19], v2 offset:12288
    v_mul_f32 v57, v57, v49
    v_fma_f32 v15, v15, v13, v12
    v_mul_f32 v49, v15, v49
    v_mul_f32 v0, v50, v50
    v_mul_f32 v58, v58, v50
    s_waitcnt lgkmcnt(3)
    v_mfma_f32_32x32x16_bf16 v[64:79], v[20:23], v[196:199], v[64:79]
    ds_read_b128 v[20:23], v2 offset:13312
    v_fma_f32 v0, v0, v13, v12
    v_mul_f32 v50, v0, v50
    v_mul_f32 v15, v51, v51
    v_mul_f32 v59, v59, v51
    v_fma_f32 v15, v15, v13, v12
    s_waitcnt lgkmcnt(3)
    v_mfma_f32_32x32x16_bf16 v[64:79], v[24:27], v[200:203], v[64:79]
    ds_read_b128 v[24:27], v2 offset:14336
    v_mul_f32 v51, v15, v51
    v_mul_f32 v0, v52, v52
    v_mul_f32 v60, v60, v52
    v_fma_f32 v0, v0, v13, v12
    v_mul_f32 v52, v0, v52
    s_waitcnt lgkmcnt(3)
    v_mfma_f32_32x32x16_bf16 v[64:79], v[28:31], v[204:207], v[64:79]
    ds_read_b128 v[28:31], v2 offset:15360
    v_mul_f32 v15, v53, v53
    v_mul_f32 v61, v61, v53
    v_fma_f32 v15, v15, v13, v12
    v_mul_f32 v53, v15, v53
    v_mul_f32 v0, v54, v54
    s_waitcnt lgkmcnt(3)
    v_mfma_f32_32x32x16_bf16 v[64:79], v[16:19], v[208:211], v[64:79]
    ds_read_b128 v[16:19], v2 offset:16384
    v_mul_f32 v62, v62, v54
    v_fma_f32 v0, v0, v13, v12
    v_mul_f32 v54, v0, v54
    v_mul_f32 v15, v55, v55
    v_mul_f32 v63, v63, v55
    s_waitcnt lgkmcnt(3)
    v_mfma_f32_32x32x16_bf16 v[64:79], v[20:23], v[212:215], v[64:79]
    ds_read_b128 v[20:23], v2 offset:17408
    v_fma_f32 v15, v15, v13, v12
    v_mul_f32 v55, v15, v55
    v_exp_f32 v48, v48
    v_exp_f32 v49, v49
    s_waitcnt lgkmcnt(3)
    v_mfma_f32_32x32x16_bf16 v[64:79], v[24:27], v[216:219], v[64:79]
    ds_read_b128 v[24:27], v2 offset:18432
    v_exp_f32 v50, v50
    v_exp_f32 v51, v51
    v_exp_f32 v52, v52
    s_waitcnt lgkmcnt(3)
    v_mfma_f32_32x32x16_bf16 v[64:79], v[28:31], v[220:223], v[64:79]
    ds_read_b128 v[28:31], v2 offset:19456
    v_exp_f32 v53, v53
    v_exp_f32 v54, v54
    v_exp_f32 v55, v55
    s_waitcnt lgkmcnt(3)
    v_mfma_f32_32x32x16_bf16 v[64:79], v[16:19], v[224:227], v[64:79]
    ds_read_b128 v[16:19], v2 offset:20480
    v_fma_f32 v48, v48, v14, v14
    v_fma_f32 v49, v49, v14, v14
    v_fma_f32 v50, v50, v14, v14
    v_fma_f32 v51, v51, v14, v14
    v_fma_f32 v52, v52, v14, v14
    s_waitcnt lgkmcnt(3)
    v_mfma_f32_32x32x16_bf16 v[64:79], v[20:23], v[228:231], v[64:79]
    ds_read_b128 v[20:23], v2 offset:21504
    v_fma_f32 v53, v53, v14, v14
    v_fma_f32 v54, v54, v14, v14
    v_fma_f32 v55, v55, v14, v14
    v_rcp_f32 v48, v48
    s_waitcnt lgkmcnt(3)
    v_mfma_f32_32x32x16_bf16 v[64:79], v[24:27], v[232:235], v[64:79]
    ds_read_b128 v[24:27], v2 offset:22528
    v_rcp_f32 v49, v49
    v_rcp_f32 v50, v50
    v_rcp_f32 v51, v51
    s_waitcnt lgkmcnt(3)
    v_mfma_f32_32x32x16_bf16 v[64:79], v[28:31], v[236:239], v[64:79]
    ds_read_b128 v[28:31], v2 offset:23552
    v_rcp_f32 v52, v52
    v_rcp_f32 v53, v53
    v_rcp_f32 v54, v54
    s_waitcnt lgkmcnt(3)
    v_mfma_f32_32x32x16_bf16 v[64:79], v[16:19], v[240:243], v[64:79]
    ds_read_b128 v[16:19], v2 offset:20480
    v_rcp_f32 v55, v55
    v_mul_f32 v56, v56, v48
    v_mul_f32 v57, v57, v49
    v_mul_f32 v58, v58, v50
    s_waitcnt lgkmcnt(3)
    v_mfma_f32_32x32x16_bf16 v[64:79], v[20:23], v[244:247], v[64:79]
    ds_read_b128 v[20:23], v2 offset:21504
    v_mul_f32 v59, v59, v51
    v_mul_f32 v60, v60, v52
    v_mul_f32 v61, v61, v53
    v_mul_f32 v62, v62, v54
    v_mul_f32 v63, v63, v55
    s_waitcnt lgkmcnt(3)
    v_mfma_f32_32x32x16_bf16 v[64:79], v[24:27], v[248:251], v[64:79]
    ds_read_b128 v[24:27], v2 offset:22528
    v_cvt_pk_bf16_f32 v48, v56, v57
    v_cvt_pk_bf16_f32 v49, v58, v59
    v_cvt_pk_bf16_f32 v50, v60, v61
    v_cvt_pk_bf16_f32 v51, v62, v63
    buffer_store_dwordx4 v[48:51], v2, s[88:91], s53 offen sc1
    s_waitcnt lgkmcnt(3)
    v_mfma_f32_32x32x16_bf16 v[64:79], v[28:31], v[252:255], v[64:79]
    ds_read_b128 v[28:31], v2 offset:23552
    s_waitcnt vmcnt(2)
    v_mfma_f32_32x32x16_bf16 v[64:79], v[4:7], v[8:11], v[64:79]
    s_waitcnt lgkmcnt(0)
    s_barrier
    s_nop 9
    v_mul_f32 v0, v64, v64
    v_mul_f32 v72, v72, v64
    v_fma_f32 v0, v0, v13, v12
    v_mul_f32 v64, v0, v64
    v_mul_f32 v15, v65, v65
    v_mul_f32 v73, v73, v65
    v_fma_f32 v15, v15, v13, v12
    v_mul_f32 v65, v15, v65
    v_mul_f32 v0, v66, v66
    v_mul_f32 v74, v74, v66
    v_fma_f32 v0, v0, v13, v12
    v_mul_f32 v66, v0, v66
    v_mul_f32 v15, v67, v67
    v_mul_f32 v75, v75, v67
    v_fma_f32 v15, v15, v13, v12
    v_mul_f32 v67, v15, v67
    v_mul_f32 v0, v68, v68
    v_mul_f32 v76, v76, v68
    v_fma_f32 v0, v0, v13, v12
    v_mul_f32 v68, v0, v68
    v_mul_f32 v15, v69, v69
    v_mul_f32 v77, v77, v69
    v_fma_f32 v15, v15, v13, v12
    v_mul_f32 v69, v15, v69
    v_mul_f32 v0, v70, v70
    v_mul_f32 v78, v78, v70
    v_fma_f32 v0, v0, v13, v12
    v_mul_f32 v70, v0, v70
    v_mul_f32 v15, v71, v71
    v_mul_f32 v79, v79, v71
    v_fma_f32 v15, v15, v13, v12
    v_mul_f32 v71, v15, v71
    v_exp_f32 v64, v64
    v_exp_f32 v65, v65
    v_exp_f32 v66, v66
    v_exp_f32 v67, v67
    v_exp_f32 v68, v68
    v_exp_f32 v69, v69
    v_exp_f32 v70, v70
    v_exp_f32 v71, v71
    v_fma_f32 v64, v64, v14, v14
    v_fma_f32 v65, v65, v14, v14
    v_fma_f32 v66, v66, v14, v14
    v_fma_f32 v67, v67, v14, v14
    v_fma_f32 v68, v68, v14, v14
    v_fma_f32 v69, v69, v14, v14
    v_fma_f32 v70, v70, v14, v14
    v_fma_f32 v71, v71, v14, v14
    v_rcp_f32 v64, v64
    v_rcp_f32 v65, v65
    v_rcp_f32 v66, v66
    v_rcp_f32 v67, v67
    v_rcp_f32 v68, v68
    v_rcp_f32 v69, v69
    v_rcp_f32 v70, v70
    v_rcp_f32 v71, v71
    v_mul_f32 v72, v72, v64
    v_mul_f32 v73, v73, v65
    v_mul_f32 v74, v74, v66
    v_mul_f32 v75, v75, v67
    v_mul_f32 v76, v76, v68
    v_mul_f32 v77, v77, v69
    v_mul_f32 v78, v78, v70
    v_mul_f32 v79, v79, v71
    v_cvt_pk_bf16_f32 v64, v72, v73
    v_cvt_pk_bf16_f32 v65, v74, v75
    v_cvt_pk_bf16_f32 v66, v76, v77
    v_cvt_pk_bf16_f32 v67, v78, v79
    buffer_store_dwordx4 v[64:67], v2, s[88:91], s54 offen sc1
    v_lshrrev_b32 v0, 4, v2
    v_mov_b32 v4, 163776
    v_mov_b32 v5, 1
    s_mov_b64 exec, 1
    s_waitcnt vmcnt(0)
    ds_add_rtn_u32 v6, v4, v5
    s_waitcnt lgkmcnt(0)
    s_mov_b64 exec, -1
    v_readfirstlane_b32 s14, v6
    s_cmp_lg_u32 s14, 3
    s_cbranch_scc1 L_p4_end
    v_mov_b32 v4, s92
    v_mov_b32 v5, s93
    v_mbcnt_lo_u32_b32 v6, -1, 0
    v_mul_u32_u24 v6, 69888, v6
    s_mov_b64 exec, 255
    buffer_store_dwordx2 v[4:5], v6, s[88:91], s46 offen sc1
    s_mov_b64 exec, -1
L_p4_end:
    s_load_dwordx2 s[4:5], s[0:1], 56
    s_and_b32 s14, s2, 7
    s_lshr_b32 s15, s2, 3
    s_lshr_b32 s16, s14, 1
    s_lshl_b32 s16, s16, 3
    s_lshr_b32 s17, s15, 2
    s_add_u32 s16, s16, s17
    s_and_b32 s17, s14, 1
    s_lshl_b32 s17, s17, 2
    s_and_b32 s18, s15, 3
    s_add_u32 s17, s17, s18
    s_mov_b32 s19, s94
    v_lshlrev_b32 v2, 4, v0
    s_cmp_lt_u32 s19, 4
    s_cbranch_scc1 L_p5_C
    s_and_b32 s40, s19, 1
    s_cmp_ge_u32 s19, 6
    s_cbranch_scc1 L_p5_LA
    s_waitcnt lgkmcnt(0)
    s_mov_b32 s28, s4
    s_mov_b32 s29, s5
    s_mov_b32 s30, 2621440
    s_mov_b32 s31, 0x00020000
    v_add_u32 v12, 0, v0
    v_mul_u32_u24 v13, 6554, v12
    v_lshrrev_b32 v13, 16, v13
    v_mul_u32_u24 v14, 10, v13
    v_sub_u32 v14, v12, v14
    s_lshl_b32 s14, s19, 3
    v_add_u32 v15, s14, v13
    v_mul_u32_u24 v5, 336, v15
    v_lshl_add_u32 v5, v14, 5, v5
    v_lshlrev_b32 v7, 9, v14
    v_lshl_add_u32 v7, v13, 4, v7
    v_mul_u32_u24 v9, 1280, v15
    v_lshl_add_u32 v9, v14, 4, v9
    v_add_u32 v12, 64, v0
    v_mul_u32_u24 v13, 6554, v12
    v_lshrrev_b32 v13, 16, v13
    v_mul_u32_u24 v14, 10, v13
    v_sub_u32 v14, v12, v14
    s_lshl_b32 s14, s19, 3
    v_add_u32 v15, s14, v13
    v_mul_u32_u24 v6, 336, v15
    v_lshl_add_u32 v6, v14, 5, v6
    v_lshlrev_b32 v8, 9, v14
    v_lshl_add_u32 v8, v13, 4, v8
    v_mul_u32_u24 v10, 1280, v15
    v_lshl_add_u32 v10, v14, 4, v10
    v_cmp_gt_u32 vcc, 16, v0
    v_mov_b32 v15, 1073741824
    s_lshl_b32 s14, s16, 1
    s_lshr_b32 s15, s19, 2
    v_cndmask_b32 v8, v15, v8, vcc
    v_cndmask_b32 v10, v15, v10, vcc
    s_add_u32 s14, s14, s15
    s_mul_i32 s14, s14, 40960
    s_mul_i32 s15, s17, 5120
    s_add_u32 s14, s14, s15
    s_and_b32 s15, s19, 3
    s_lshl_b32 s15, s15, 7
    s_add_u32 s14, s14, s15
    s_add_u32 s14, s14, 11534336
    buffer_load_dwordx4 v[24:27], v7, s[88:91], s14 offen sc1
    buffer_load_dwordx4 v[28:31], v8, s[88:91], s14 offen sc1
    s_waitcnt vmcnt(30)
    s_barrier
    s_waitcnt vmcnt(25)
    s_barrier
L_p5w_hl:
    s_add_u32 m0, s61, 0
    s_add_u32 s63, s63, 1
    buffer_load_dwordx4 v2, s[88:91], s56 offen sc1 lds
    s_cmp_eq_u32 s63, 27
    s_cselect_b32 s55, 1073741824, 2048
    s_add_u32 m0, s61, 1024
    s_add_u32 s56, s56, s55
    buffer_load_dwordx4 v2, s[88:91], s57 offen sc1 lds
    s_add_u32 m0, s61, 2048
    s_add_u32 s57, s57, s55
    buffer_load_dwordx4 v2, s[88:91], s58 offen sc1 lds
    s_add_u32 m0, s61, 3072
    s_add_u32 s58, s58, s55
    buffer_load_dwordx4 v2, s[88:91], s59 offen sc1 lds
    s_add_u32 m0, s61, 4096
    s_add_u32 s59, s59, s55
    buffer_load_dwordx4 v2, s[88:91], s60 offen sc1 lds
    s_add_u32 s60, s60, s55
    s_add_u32 s61, s61, 10240
    s_sub_u32 s55, s61, 161792
    s_cmp_lt_u32 s55, 5121
    s_cselect_b32 s55, 4294838272, 0
    s_add_u32 s61, s61, s55
    s_sub_u32 s55, s61, 83968
    s_cmp_lt_u32 s55, 5121
    s_cselect_b32 s55, 47104, 0
    s_add_u32 s61, s61, s55
    s_cmp_lt_u32 s63, 27
    s_waitcnt vmcnt(25)
    s_barrier
    s_cbranch_scc1 L_p5w_hl
    s_waitcnt vmcnt(20)
    s_barrier
    s_waitcnt vmcnt(15)
    s_barrier
    s_waitcnt vmcnt(10)
    s_barrier
    s_waitcnt vmcnt(5)
    s_barrier
    s_waitcnt vmcnt(0)
    s_barrier
    s_waitcnt vmcnt(0)
    s_barrier
    s_branch L_p5_Lend
L_p5_LA:
    s_waitcnt lgkmcnt(0)
    s_mov_b32 s28, s4
    s_mov_b32 s29, s5
    s_mov_b32 s30, 2621440
    s_mov_b32 s31, 0x00020000
    v_add_u32 v12, 0, v0
    v_mul_u32_u24 v13, 6554, v12
    v_lshrrev_b32 v13, 16, v13
    v_mul_u32_u24 v14, 10, v13
    v_sub_u32 v14, v12, v14
    s_lshl_b32 s14, s19, 3
    v_add_u32 v15, s14, v13
    v_mul_u32_u24 v5, 336, v15
    v_lshl_add_u32 v5, v14, 5, v5
    v_lshlrev_b32 v7, 9, v14
    v_lshl_add_u32 v7, v13, 4, v7
    v_mul_u32_u24 v9, 1280, v15
    v_lshl_add_u32 v9, v14, 4, v9
    v_add_u32 v12, 64, v0
    v_mul_u32_u24 v13, 6554, v12
    v_lshrrev_b32 v13, 16, v13
    v_mul_u32_u24 v14, 10, v13
    v_sub_u32 v14, v12, v14
    s_lshl_b32 s14, s19, 3
    v_add_u32 v15, s14, v13
    v_mul_u32_u24 v6, 336, v15
    v_lshl_add_u32 v6, v14, 5, v6
    v_lshlrev_b32 v8, 9, v14
    v_lshl_add_u32 v8, v13, 4, v8
    v_mul_u32_u24 v10, 1280, v15
    v_lshl_add_u32 v10, v14, 4, v10
    v_cmp_gt_u32 vcc, 16, v0
    v_mov_b32 v15, 1073741824
    s_lshl_b32 s14, s16, 1
    s_lshr_b32 s15, s19, 2
    v_cndmask_b32 v8, v15, v8, vcc
    v_cndmask_b32 v10, v15, v10, vcc
    s_add_u32 s14, s14, s15
    s_mul_i32 s14, s14, 40960
    s_mul_i32 s15, s17, 5120
    s_add_u32 s14, s14, s15
    s_and_b32 s15, s19, 3
    s_lshl_b32 s15, s15, 7
    s_add_u32 s14, s14, s15
    s_add_u32 s14, s14, 11534336
    buffer_load_dwordx4 v[24:27], v7, s[88:91], s14 offen sc1
    buffer_load_dwordx4 v[28:31], v8, s[88:91], s14 offen sc1
    s_lshl_b32 s34, s40, 12
    s_add_u32 s34, s34, 83968
    s_add_u32 s35, s34, 73728
    v_and_b32 v12, 15, v0
    v_lshrrev_b32 v13, 4, v0
    v_lshlrev_b32 v13, 9, v13
    v_lshl_add_u32 v3, v12, 4, v13
    s_mul_i32 s42, s16, 221184
    s_lshl_b32 s14, s40, 11
    s_add_u32 s42, s42, s14
    s_add_u32 s42, s42, 16777216
    v_lshlrev_b32 v12, 3, v12
    s_lshr_b32 s14, s16, 1
    s_lshl_b32 s14, s14, 7
    s_add_u32 s47, s14, 34619392
    s_add_u32 s14, s14, 34652160
    s_add_u32 s43, s42, 256
    s_add_u32 s44, s42, 110592
    s_add_u32 s45, s42, 110848
    s_mov_b32 s15, 16384
L_poll13:
    buffer_load_dwordx2 v[14:15], v12, s[96:99], s14 offen offset:0 sc1
    s_waitcnt vmcnt(0)
    v_cmp_ne_u64 vcc, s[92:93], v[14:15]
    s_sub_u32 s15, s15, 1
    s_cbranch_scc1 L_poll13_ok
    s_cmp_eq_u64 vcc, 0
    s_cbranch_scc1 L_poll13_ok
    s_sleep 1
    s_branch L_poll13
L_poll13_ok:
    s_mov_b32 s32, 0
L_p5a_pl:
    s_add_u32 m0, s34, 0
    s_add_u32 s32, s32, 1
    buffer_load_dwordx4 v3, s[88:91], s42 offen sc1 lds
    s_cmp_eq_u32 s32, 27
    s_cselect_b32 s33, 1073741824, 4096
    s_add_u32 m0, s34, 1024
    s_add_u32 s42, s42, s33
    buffer_load_dwordx4 v3, s[88:91], s43 offen sc1 lds
    s_add_u32 m0, s34, 2048
    s_add_u32 s43, s43, s33
    buffer_load_dwordx4 v3, s[88:91], s44 offen sc1 lds
    s_add_u32 m0, s34, 3072
    s_add_u32 s44, s44, s33
    buffer_load_dwordx4 v3, s[88:91], s45 offen sc1 lds
    s_add_u32 s45, s45, s33
    s_add_u32 s34, s34, 8192
    s_sub_u32 s33, s34, 124928
    s_cmp_lt_u32 s33, 4097
    s_cselect_b32 s33, 4294842368, 0
    s_add_u32 s34, s34, s33
    s_sub_u32 s33, s34, 32768
    s_cmp_lt_u32 s33, 4097
    s_cselect_b32 s33, 51200, 0
    s_add_u32 s34, s34, s33
    s_cmp_lt_u32 s32, 6
    s_cbranch_scc1 L_p5a_pl
    s_waitcnt vmcnt(20)
    s_barrier
    s_add_u32 m0, s34, 0
    s_add_u32 s32, s32, 1
    buffer_load_dwordx4 v3, s[88:91], s42 offen sc1 lds
    s_cmp_eq_u32 s32, 27
    s_cselect_b32 s33, 1073741824, 4096
    s_add_u32 m0, s34, 1024
    s_add_u32 s42, s42, s33
    buffer_load_dwordx4 v3, s[88:91], s43 offen sc1 lds
    s_add_u32 m0, s34, 2048
    s_add_u32 s43, s43, s33
    buffer_load_dwordx4 v3, s[88:91], s44 offen sc1 lds
    s_add_u32 m0, s34, 3072
    s_add_u32 s44, s44, s33
    buffer_load_dwordx4 v3, s[88:91], s45 offen sc1 lds
    s_add_u32 s45, s45, s33
    s_add_u32 s34, s34, 8192
    s_sub_u32 s33, s34, 124928
    s_cmp_lt_u32 s33, 4097
    s_cselect_b32 s33, 4294842368, 0
    s_add_u32 s34, s34, s33
    s_sub_u32 s33, s34, 32768
    s_cmp_lt_u32 s33, 4097
    s_cselect_b32 s33, 51200, 0
    s_add_u32 s34, s34, s33
    s_add_u32 m0, s34, 0
    s_add_u32 s32, s32, 1
    buffer_load_dwordx4 v3, s[88:91], s42 offen sc1 lds
    s_cmp_eq_u32 s32, 27
    s_cselect_b32 s33, 1073741824, 4096
    s_add_u32 m0, s34, 1024
    s_add_u32 s42, s42, s33
    buffer_load_dwordx4 v3, s[88:91], s43 offen sc1 lds
    s_add_u32 m0, s34, 2048
    s_add_u32 s43, s43, s33
    buffer_load_dwordx4 v3, s[88:91], s44 offen sc1 lds
    s_add_u32 m0, s34, 3072
    s_add_u32 s44, s44, s33
    buffer_load_dwordx4 v3, s[88:91], s45 offen sc1 lds
    s_add_u32 s45, s45, s33
    s_add_u32 s34, s34, 8192
    s_sub_u32 s33, s34, 124928
    s_cmp_lt_u32 s33, 4097
    s_cselect_b32 s33, 4294842368, 0
    s_add_u32 s34, s34, s33
    s_sub_u32 s33, s34, 32768
    s_cmp_lt_u32 s33, 4097
    s_cselect_b32 s33, 51200, 0
    s_add_u32 s34, s34, s33
    s_waitcnt vmcnt(24)
    s_barrier
L_p5a_hl:
    s_cmp_lg_u32 s32, 9
    s_cbranch_scc1 L_p5_h1
    buffer_load_dwordx2 v[14:15], v12, s[96:99], s47 offen sc1
    L_p5_h1:
    s_cmp_lg_u32 s32, 15
    s_cbranch_scc1 L_p5_h2
    s_waitcnt vmcnt(24)
    v_cmp_ne_u64 vcc, s[92:93], v[14:15]
    s_nop 1
    s_cmp_eq_u64 vcc, 0
    s_cbranch_scc1 L_p5_h2
    s_mov_b32 s15, 16384
L_poll14:
    buffer_load_dwordx2 v[14:15], v12, s[96:99], s47 offen offset:0 sc1
    s_waitcnt vmcnt(0)
    v_cmp_ne_u64 vcc, s[92:93], v[14:15]
    s_sub_u32 s15, s15, 1
    s_cbranch_scc1 L_poll14_ok
    s_cmp_eq_u64 vcc, 0
    s_cbranch_scc1 L_poll14_ok
    s_sleep 1
    s_branch L_poll14
L_poll14_ok:
L_p5_h2:
    s_add_u32 m0, s34, 0
    s_add_u32 s32, s32, 1
    buffer_load_dwordx4 v3, s[88:91], s42 offen sc1 lds
    s_cmp_eq_u32 s32, 27
    s_cselect_b32 s33, 1073741824, 4096
    s_add_u32 m0, s34, 1024
    s_add_u32 s42, s42, s33
    buffer_load_dwordx4 v3, s[88:91], s43 offen sc1 lds
    s_add_u32 m0, s34, 2048
    s_add_u32 s43, s43, s33
    buffer_load_dwordx4 v3, s[88:91], s44 offen sc1 lds
    s_add_u32 m0, s34, 3072
    s_add_u32 s44, s44, s33
    buffer_load_dwordx4 v3, s[88:91], s45 offen sc1 lds
    s_add_u32 s45, s45, s33
    s_add_u32 s34, s34, 8192
    s_sub_u32 s33, s34, 124928
    s_cmp_lt_u32 s33, 4097
    s_cselect_b32 s33, 4294842368, 0
    s_add_u32 s34, s34, s33
    s_sub_u32 s33, s34, 32768
    s_cmp_lt_u32 s33, 4097
    s_cselect_b32 s33, 51200, 0
    s_add_u32 s34, s34, s33
    s_cmp_lt_u32 s32, 27
    s_waitcnt vmcnt(24)
    s_barrier
    s_cbranch_scc1 L_p5a_hl
    s_waitcnt vmcnt(20)
    s_barrier
    s_waitcnt vmcnt(16)
    s_barrier
    s_waitcnt vmcnt(12)
    s_barrier
    s_waitcnt vmcnt(8)
    s_barrier
    s_waitcnt vmcnt(4)
    s_barrier
    s_waitcnt vmcnt(0)
    s_barrier
    s_waitcnt vmcnt(0)
    s_barrier
L_p5_Lend:
    s_waitcnt vmcnt(0)
    s_barrier
    s_branch L_p5_epi
L_p5_C:
    s_and_b32 s40, s19, 1
    s_lshr_b32 s41, s19, 1
    s_mul_i32 s14, s41, 5120
    v_add_u32 v108, s14, v2
    v_add_u32 v109, 0x10000, v108
    v_add_u32 v110, 0x20000, v108
    s_lshl_b32 s14, s41, 12
    s_lshl_b32 s15, s40, 11
    s_add_u32 s14, s14, s15
    v_add_u32 v111, s14, v2
    v_add_u32 v112, 0x10000, v111
    s_waitcnt lgkmcnt(0)
    s_mov_b32 s28, s4
    s_mov_b32 s29, s5
    s_mov_b32 s30, 2621440
    s_mov_b32 s31, 0x00020000
    v_add_u32 v12, 0, v0
    v_mul_u32_u24 v13, 6554, v12
    v_lshrrev_b32 v13, 16, v13
    v_mul_u32_u24 v14, 10, v13
    v_sub_u32 v14, v12, v14
    s_lshl_b32 s14, s19, 3
    v_add_u32 v15, s14, v13
    v_mul_u32_u24 v5, 336, v15
    v_lshl_add_u32 v5, v14, 5, v5
    v_lshlrev_b32 v7, 9, v14
    v_lshl_add_u32 v7, v13, 4, v7
    v_mul_u32_u24 v9, 1280, v15
    v_lshl_add_u32 v9, v14, 4, v9
    v_add_u32 v12, 64, v0
    v_mul_u32_u24 v13, 6554, v12
    v_lshrrev_b32 v13, 16, v13
    v_mul_u32_u24 v14, 10, v13
    v_sub_u32 v14, v12, v14
    s_lshl_b32 s14, s19, 3
    v_add_u32 v15, s14, v13
    v_mul_u32_u24 v6, 336, v15
    v_lshl_add_u32 v6, v14, 5, v6
    v_lshlrev_b32 v8, 9, v14
    v_lshl_add_u32 v8, v13, 4, v8
    v_mul_u32_u24 v10, 1280, v15
    v_lshl_add_u32 v10, v14, 4, v10
    v_cmp_gt_u32 vcc, 16, v0
    v_mov_b32 v15, 1073741824
    s_lshl_b32 s14, s16, 1
    s_lshr_b32 s15, s19, 2
    v_cndmask_b32 v8, v15, v8, vcc
    v_cndmask_b32 v10, v15, v10, vcc
    s_add_u32 s14, s14, s15
    s_mul_i32 s14, s14, 40960
    s_mul_i32 s15, s17, 5120
    s_add_u32 s14, s14, s15
    s_and_b32 s15, s19, 3
    s_lshl_b32 s15, s15, 7
    s_add_u32 s14, s14, s15
    s_add_u32 s14, s14, 11534336
    buffer_load_dwordx4 v[24:27], v7, s[88:91], s14 offen sc1
    buffer_load_dwordx4 v[28:31], v8, s[88:91], s14 offen sc1
    s_barrier
    ds_read_b128 v[92:95], v112 offset:18432
    ds_read_b128 v[96:99], v112 offset:19456
    ds_read_b128 v[72:75], v110 offset:0
    ds_read_b128 v[76:79], v110 offset:1024
    ds_read_b128 v[80:83], v110 offset:2048
    ds_read_b128 v[84:87], v110 offset:3072
    ds_read_b128 v[88:91], v110 offset:4096
    s_waitcnt lgkmcnt(4)
    v_mfma_f32_16x16x32_bf16 v[32:35], v[72:75], v[92:95], 0
    v_mfma_f32_16x16x32_bf16 v[36:39], v[72:75], v[96:99], 0
    s_barrier
    ds_read_b128 v[100:103], v112 offset:26624
    ds_read_b128 v[104:107], v112 offset:27648
    ds_read_b128 v[72:75], v110 offset:10240
    s_waitcnt lgkmcnt(6)
    v_mfma_f32_16x16x32_bf16 v[40:43], v[76:79], v[92:95], 0
    v_mfma_f32_16x16x32_bf16 v[44:47], v[76:79], v[96:99], 0
    ds_read_b128 v[76:79], v110 offset:11264
    s_waitcnt lgkmcnt(6)
    v_mfma_f32_16x16x32_bf16 v[48:51], v[80:83], v[92:95], 0
    v_mfma_f32_16x16x32_bf16 v[52:55], v[80:83], v[96:99], 0
    ds_read_b128 v[80:83], v110 offset:12288
    s_waitcnt lgkmcnt(6)
    v_mfma_f32_16x16x32_bf16 v[56:59], v[84:87], v[92:95], 0
    v_mfma_f32_16x16x32_bf16 v[60:63], v[84:87], v[96:99], 0
    ds_read_b128 v[84:87], v110 offset:13312
    s_waitcnt lgkmcnt(6)
    v_mfma_f32_16x16x32_bf16 v[64:67], v[88:91], v[92:95], 0
    v_mfma_f32_16x16x32_bf16 v[68:71], v[88:91], v[96:99], 0
    ds_read_b128 v[88:91], v110 offset:14336
    s_waitcnt lgkmcnt(4)
    v_mfma_f32_16x16x32_bf16 v[32:35], v[72:75], v[100:103], v[32:35]
    v_mfma_f32_16x16x32_bf16 v[36:39], v[72:75], v[104:107], v[36:39]
    s_barrier
    ds_read_b128 v[92:95], v112 offset:34816
    ds_read_b128 v[96:99], v112 offset:35840
    ds_read_b128 v[72:75], v110 offset:20480
    s_waitcnt lgkmcnt(6)
    v_mfma_f32_16x16x32_bf16 v[40:43], v[76:79], v[100:103], v[40:43]
    v_mfma_f32_16x16x32_bf16 v[44:47], v[76:79], v[104:107], v[44:47]
    ds_read_b128 v[76:79], v110 offset:21504
    s_waitcnt lgkmcnt(6)
    v_mfma_f32_16x16x32_bf16 v[48:51], v[80:83], v[100:103], v[48:51]
    v_mfma_f32_16x16x32_bf16 v[52:55], v[80:83], v[104:107], v[52:55]
    ds_read_b128 v[80:83], v110 offset:22528
    s_waitcnt lgkmcnt(6)
    v_mfma_f32_16x16x32_bf16 v[56:59], v[84:87], v[100:103], v[56:59]
    v_mfma_f32_16x16x32_bf16 v[60:63], v[84:87], v[104:107], v[60:63]
    ds_read_b128 v[84:87], v110 offset:23552
    s_waitcnt lgkmcnt(6)
    v_mfma_f32_16x16x32_bf16 v[64:67], v[88:91], v[100:103], v[64:67]
    v_mfma_f32_16x16x32_bf16 v[68:71], v[88:91], v[104:107], v[68:71]
    ds_read_b128 v[88:91], v110 offset:24576
    s_waitcnt lgkmcnt(4)
    v_mfma_f32_16x16x32_bf16 v[32:35], v[72:75], v[92:95], v[32:35]
    v_mfma_f32_16x16x32_bf16 v[36:39], v[72:75], v[96:99], v[36:39]
    s_barrier
    ds_read_b128 v[100:103], v112 offset:43008
    ds_read_b128 v[104:107], v112 offset:44032
    ds_read_b128 v[72:75], v108 offset:32768
    s_waitcnt lgkmcnt(6)
    v_mfma_f32_16x16x32_bf16 v[40:43], v[76:79], v[92:95], v[40:43]
    v_mfma_f32_16x16x32_bf16 v[44:47], v[76:79], v[96:99], v[44:47]
    ds_read_b128 v[76:79], v108 offset:33792
    s_waitcnt lgkmcnt(6)
    v_mfma_f32_16x16x32_bf16 v[48:51], v[80:83], v[92:95], v[48:51]
    v_mfma_f32_16x16x32_bf16 v[52:55], v[80:83], v[96:99], v[52:55]
    ds_read_b128 v[80:83], v108 offset:34816
    s_waitcnt lgkmcnt(6)
    v_mfma_f32_16x16x32_bf16 v[56:59], v[84:87], v[92:95], v[56:59]
    v_mfma_f32_16x16x32_bf16 v[60:63], v[84:87], v[96:99], v[60:63]
    ds_read_b128 v[84:87], v108 offset:35840
    s_waitcnt lgkmcnt(6)
    v_mfma_f32_16x16x32_bf16 v[64:67], v[88:91], v[92:95], v[64:67]
    v_mfma_f32_16x16x32_bf16 v[68:71], v[88:91], v[96:99], v[68:71]
    ds_read_b128 v[88:91], v108 offset:36864
    s_waitcnt lgkmcnt(4)
    v_mfma_f32_16x16x32_bf16 v[32:35], v[72:75], v[100:103], v[32:35]
    v_mfma_f32_16x16x32_bf16 v[36:39], v[72:75], v[104:107], v[36:39]
    s_barrier
    ds_read_b128 v[92:95], v112 offset:51200
    ds_read_b128 v[96:99], v112 offset:52224
    ds_read_b128 v[72:75], v108 offset:43008
    s_waitcnt lgkmcnt(6)
    v_mfma_f32_16x16x32_bf16 v[40:43], v[76:79], v[100:103], v[40:43]
    v_mfma_f32_16x16x32_bf16 v[44:47], v[76:79], v[104:107], v[44:47]
    ds_read_b128 v[76:79], v108 offset:44032
    s_waitcnt lgkmcnt(6)
    v_mfma_f32_16x16x32_bf16 v[48:51], v[80:83], v[100:103], v[48:51]
    v_mfma_f32_16x16x32_bf16 v[52:55], v[80:83], v[104:107], v[52:55]
    ds_read_b128 v[80:83], v108 offset:45056
    s_waitcnt lgkmcnt(6)
    v_mfma_f32_16x16x32_bf16 v[56:59], v[84:87], v[100:103], v[56:59]
    v_mfma_f32_16x16x32_bf16 v[60:63], v[84:87], v[104:107], v[60:63]
    ds_read_b128 v[84:87], v108 offset:46080
    s_waitcnt lgkmcnt(6)
    v_mfma_f32_16x16x32_bf16 v[64:67], v[88:91], v[100:103], v[64:67]
    v_mfma_f32_16x16x32_bf16 v[68:71], v[88:91], v[104:107], v[68:71]
    ds_read_b128 v[88:91], v108 offset:47104
    s_waitcnt lgkmcnt(4)
    v_mfma_f32_16x16x32_bf16 v[32:35], v[72:75], v[92:95], v[32:35]
    v_mfma_f32_16x16x32_bf16 v[36:39], v[72:75], v[96:99], v[36:39]
    s_barrier
    ds_read_b128 v[100:103], v111 offset:0
    ds_read_b128 v[104:107], v111 offset:1024
    ds_read_b128 v[72:75], v108 offset:53248
    s_waitcnt lgkmcnt(6)
    v_mfma_f32_16x16x32_bf16 v[40:43], v[76:79], v[92:95], v[40:43]
    v_mfma_f32_16x16x32_bf16 v[44:47], v[76:79], v[96:99], v[44:47]
    ds_read_b128 v[76:79], v108 offset:54272
    s_waitcnt lgkmcnt(6)
    v_mfma_f32_16x16x32_bf16 v[48:51], v[80:83], v[92:95], v[48:51]
    v_mfma_f32_16x16x32_bf16 v[52:55], v[80:83], v[96:99], v[52:55]
    ds_read_b128 v[80:83], v108 offset:55296
    s_waitcnt lgkmcnt(6)
    v_mfma_f32_16x16x32_bf16 v[56:59], v[84:87], v[92:95], v[56:59]
    v_mfma_f32_16x16x32_bf16 v[60:63], v[84:87], v[96:99], v[60:63]
    ds_read_b128 v[84:87], v108 offset:56320
    s_waitcnt lgkmcnt(6)
    v_mfma_f32_16x16x32_bf16 v[64:67], v[88:91], v[92:95], v[64:67]
    v_mfma_f32_16x16x32_bf16 v[68:71], v[88:91], v[96:99], v[68:71]
    ds_read_b128 v[88:91], v108 offset:57344
    s_waitcnt lgkmcnt(4)
    v_mfma_f32_16x16x32_bf16 v[32:35], v[72:75], v[100:103], v[32:35]
    v_mfma_f32_16x16x32_bf16 v[36:39], v[72:75], v[104:107], v[36:39]
    s_barrier
    ds_read_b128 v[92:95], v111 offset:8192
    ds_read_b128 v[96:99], v111 offset:9216
    ds_read_b128 v[72:75], v108 offset:63488
    s_waitcnt lgkmcnt(6)
    v_mfma_f32_16x16x32_bf16 v[40:43], v[76:79], v[100:103], v[40:43]
    v_mfma_f32_16x16x32_bf16 v[44:47], v[76:79], v[104:107], v[44:47]
    ds_read_b128 v[76:79], v108 offset:64512
    s_waitcnt lgkmcnt(6)
    v_mfma_f32_16x16x32_bf16 v[48:51], v[80:83], v[100:103], v[48:51]
    v_mfma_f32_16x16x32_bf16 v[52:55], v[80:83], v[104:107], v[52:55]
    ds_read_b128 v[80:83], v109 offset:0
    s_waitcnt lgkmcnt(6)
    v_mfma_f32_16x16x32_bf16 v[56:59], v[84:87], v[100:103], v[56:59]
    v_mfma_f32_16x16x32_bf16 v[60:63], v[84:87], v[104:107], v[60:63]
    ds_read_b128 v[84:87], v109 offset:1024
    s_waitcnt lgkmcnt(6)
    v_mfma_f32_16x16x32_bf16 v[64:67], v[88:91], v[100:103], v[64:67]
    v_mfma_f32_16x16x32_bf16 v[68:71], v[88:91], v[104:107], v[68:71]
    ds_read_b128 v[88:91], v109 offset:2048
    s_waitcnt lgkmcnt(4)
    v_mfma_f32_16x16x32_bf16 v[32:35], v[72:75], v[92:95], v[32:35]
    v_mfma_f32_16x16x32_bf16 v[36:39], v[72:75], v[96:99], v[36:39]
    s_barrier
    ds_read_b128 v[100:103], v111 offset:16384
    ds_read_b128 v[104:107], v111 offset:17408
    ds_read_b128 v[72:75], v109 offset:8192
    s_waitcnt lgkmcnt(6)
    v_mfma_f32_16x16x32_bf16 v[40:43], v[76:79], v[92:95], v[40:43]
    v_mfma_f32_16x16x32_bf16 v[44:47], v[76:79], v[96:99], v[44:47]
    ds_read_b128 v[76:79], v109 offset:9216
    s_waitcnt lgkmcnt(6)
    v_mfma_f32_16x16x32_bf16 v[48:51], v[80:83], v[92:95], v[48:51]
    v_mfma_f32_16x16x32_bf16 v[52:55], v[80:83], v[96:99], v[52:55]
    ds_read_b128 v[80:83], v109 offset:10240
    s_waitcnt lgkmcnt(6)
    v_mfma_f32_16x16x32_bf16 v[56:59], v[84:87], v[92:95], v[56:59]
    v_mfma_f32_16x16x32_bf16 v[60:63], v[84:87], v[96:99], v[60:63]
    ds_read_b128 v[84:87], v109 offset:11264
    s_waitcnt lgkmcnt(6)
    v_mfma_f32_16x16x32_bf16 v[64:67], v[88:91], v[92:95], v[64:67]
    v_mfma_f32_16x16x32_bf16 v[68:71], v[88:91], v[96:99], v[68:71]
    ds_read_b128 v[88:91], v109 offset:12288
    s_waitcnt lgkmcnt(4)
    v_mfma_f32_16x16x32_bf16 v[32:35], v[72:75], v[100:103], v[32:35]
    v_mfma_f32_16x16x32_bf16 v[36:39], v[72:75], v[104:107], v[36:39]
    s_barrier
    ds_read_b128 v[92:95], v111 offset:24576
    ds_read_b128 v[96:99], v111 offset:25600
    ds_read_b128 v[72:75], v110 offset:0
    s_waitcnt lgkmcnt(6)
    v_mfma_f32_16x16x32_bf16 v[40:43], v[76:79], v[100:103], v[40:43]
    v_mfma_f32_16x16x32_bf16 v[44:47], v[76:79], v[104:107], v[44:47]
    ds_read_b128 v[76:79], v110 offset:1024
    s_waitcnt lgkmcnt(6)
    v_mfma_f32_16x16x32_bf16 v[48:51], v[80:83], v[100:103], v[48:51]
    v_mfma_f32_16x16x32_bf16 v[52:55], v[80:83], v[104:107], v[52:55]
    ds_read_b128 v[80:83], v110 offset:2048
    s_waitcnt lgkmcnt(6)
    v_mfma_f32_16x16x32_bf16 v[56:59], v[84:87], v[100:103], v[56:59]
    v_mfma_f32_16x16x32_bf16 v[60:63], v[84:87], v[104:107], v[60:63]
    ds_read_b128 v[84:87], v110 offset:3072
    s_waitcnt lgkmcnt(6)
    v_mfma_f32_16x16x32_bf16 v[64:67], v[88:91], v[100:103], v[64:67]
    v_mfma_f32_16x16x32_bf16 v[68:71], v[88:91], v[104:107], v[68:71]
    ds_read_b128 v[88:91], v110 offset:4096
    s_waitcnt lgkmcnt(4)
    v_mfma_f32_16x16x32_bf16 v[32:35], v[72:75], v[92:95], v[32:35]
    v_mfma_f32_16x16x32_bf16 v[36:39], v[72:75], v[96:99], v[36:39]
    s_barrier
    ds_read_b128 v[100:103], v112 offset:18432
    ds_read_b128 v[104:107], v112 offset:19456
    ds_read_b128 v[72:75], v110 offset:10240
    s_waitcnt lgkmcnt(6)
    v_mfma_f32_16x16x32_bf16 v[40:43], v[76:79], v[92:95], v[40:43]
    v_mfma_f32_16x16x32_bf16 v[44:47], v[76:79], v[96:99], v[44:47]
    ds_read_b128 v[76:79], v110 offset:11264
    s_waitcnt lgkmcnt(6)
    v_mfma_f32_16x16x32_bf16 v[48:51], v[80:83], v[92:95], v[48:51]
    v_mfma_f32_16x16x32_bf16 v[52:55], v[80:83], v[96:99], v[52:55]
    ds_read_b128 v[80:83], v110 offset:12288
    s_waitcnt lgkmcnt(6)
    v_mfma_f32_16x16x32_bf16 v[56:59], v[84:87], v[92:95], v[56:59]
    v_mfma_f32_16x16x32_bf16 v[60:63], v[84:87], v[96:99], v[60:63]
    ds_read_b128 v[84:87], v110 offset:13312
    s_waitcnt lgkmcnt(6)
    v_mfma_f32_16x16x32_bf16 v[64:67], v[88:91], v[92:95], v[64:67]
    v_mfma_f32_16x16x32_bf16 v[68:71], v[88:91], v[96:99], v[68:71]
    ds_read_b128 v[88:91], v110 offset:14336
    s_waitcnt lgkmcnt(4)
    v_mfma_f32_16x16x32_bf16 v[32:35], v[72:75], v[100:103], v[32:35]
    v_mfma_f32_16x16x32_bf16 v[36:39], v[72:75], v[104:107], v[36:39]
    s_barrier
    ds_read_b128 v[92:95], v112 offset:26624
    ds_read_b128 v[96:99], v112 offset:27648
    ds_read_b128 v[72:75], v110 offset:20480
    s_waitcnt lgkmcnt(6)
    v_mfma_f32_16x16x32_bf16 v[40:43], v[76:79], v[100:103], v[40:43]
    v_mfma_f32_16x16x32_bf16 v[44:47], v[76:79], v[104:107], v[44:47]
    ds_read_b128 v[76:79], v110 offset:21504
    s_waitcnt lgkmcnt(6)
    v_mfma_f32_16x16x32_bf16 v[48:51], v[80:83], v[100:103], v[48:51]
    v_mfma_f32_16x16x32_bf16 v[52:55], v[80:83], v[104:107], v[52:55]
    ds_read_b128 v[80:83], v110 offset:22528
    s_waitcnt lgkmcnt(6)
    v_mfma_f32_16x16x32_bf16 v[56:59], v[84:87], v[100:103], v[56:59]
    v_mfma_f32_16x16x32_bf16 v[60:63], v[84:87], v[104:107], v[60:63]
    ds_read_b128 v[84:87], v110 offset:23552
    s_waitcnt lgkmcnt(6)
    v_mfma_f32_16x16x32_bf16 v[64:67], v[88:91], v[100:103], v[64:67]
    v_mfma_f32_16x16x32_bf16 v[68:71], v[88:91], v[104:107], v[68:71]
    ds_read_b128 v[88:91], v110 offset:24576
    s_waitcnt lgkmcnt(4)
    v_mfma_f32_16x16x32_bf16 v[32:35], v[72:75], v[92:95], v[32:35]
    v_mfma_f32_16x16x32_bf16 v[36:39], v[72:75], v[96:99], v[36:39]
    s_barrier
    ds_read_b128 v[100:103], v112 offset:34816
    ds_read_b128 v[104:107], v112 offset:35840
    ds_read_b128 v[72:75], v108 offset:32768
    s_waitcnt lgkmcnt(6)
    v_mfma_f32_16x16x32_bf16 v[40:43], v[76:79], v[92:95], v[40:43]
    v_mfma_f32_16x16x32_bf16 v[44:47], v[76:79], v[96:99], v[44:47]
    ds_read_b128 v[76:79], v108 offset:33792
    s_waitcnt lgkmcnt(6)
    v_mfma_f32_16x16x32_bf16 v[48:51], v[80:83], v[92:95], v[48:51]
    v_mfma_f32_16x16x32_bf16 v[52:55], v[80:83], v[96:99], v[52:55]
    ds_read_b128 v[80:83], v108 offset:34816
    s_waitcnt lgkmcnt(6)
    v_mfma_f32_16x16x32_bf16 v[56:59], v[84:87], v[92:95], v[56:59]
    v_mfma_f32_16x16x32_bf16 v[60:63], v[84:87], v[96:99], v[60:63]
    ds_read_b128 v[84:87], v108 offset:35840
    s_waitcnt lgkmcnt(6)
    v_mfma_f32_16x16x32_bf16 v[64:67], v[88:91], v[92:95], v[64:67]
    v_mfma_f32_16x16x32_bf16 v[68:71], v[88:91], v[96:99], v[68:71]
    ds_read_b128 v[88:91], v108 offset:36864
    s_waitcnt lgkmcnt(4)
    v_mfma_f32_16x16x32_bf16 v[32:35], v[72:75], v[100:103], v[32:35]
    v_mfma_f32_16x16x32_bf16 v[36:39], v[72:75], v[104:107], v[36:39]
    s_barrier
    ds_read_b128 v[92:95], v112 offset:43008
    ds_read_b128 v[96:99], v112 offset:44032
    ds_read_b128 v[72:75], v108 offset:43008
    s_waitcnt lgkmcnt(6)
    v_mfma_f32_16x16x32_bf16 v[40:43], v[76:79], v[100:103], v[40:43]
    v_mfma_f32_16x16x32_bf16 v[44:47], v[76:79], v[104:107], v[44:47]
    ds_read_b128 v[76:79], v108 offset:44032
    s_waitcnt lgkmcnt(6)
    v_mfma_f32_16x16x32_bf16 v[48:51], v[80:83], v[100:103], v[48:51]
    v_mfma_f32_16x16x32_bf16 v[52:55], v[80:83], v[104:107], v[52:55]
    ds_read_b128 v[80:83], v108 offset:45056
    s_waitcnt lgkmcnt(6)
    v_mfma_f32_16x16x32_bf16 v[56:59], v[84:87], v[100:103], v[56:59]
    v_mfma_f32_16x16x32_bf16 v[60:63], v[84:87], v[104:107], v[60:63]
    ds_read_b128 v[84:87], v108 offset:46080
    s_waitcnt lgkmcnt(6)
    v_mfma_f32_16x16x32_bf16 v[64:67], v[88:91], v[100:103], v[64:67]
    v_mfma_f32_16x16x32_bf16 v[68:71], v[88:91], v[104:107], v[68:71]
    ds_read_b128 v[88:91], v108 offset:47104
    s_waitcnt lgkmcnt(4)
    v_mfma_f32_16x16x32_bf16 v[32:35], v[72:75], v[92:95], v[32:35]
    v_mfma_f32_16x16x32_bf16 v[36:39], v[72:75], v[96:99], v[36:39]
    s_barrier
    ds_read_b128 v[100:103], v112 offset:51200
    ds_read_b128 v[104:107], v112 offset:52224
    ds_read_b128 v[72:75], v108 offset:53248
    s_waitcnt lgkmcnt(6)
    v_mfma_f32_16x16x32_bf16 v[40:43], v[76:79], v[92:95], v[40:43]
    v_mfma_f32_16x16x32_bf16 v[44:47], v[76:79], v[96:99], v[44:47]
    ds_read_b128 v[76:79], v108 offset:54272
    s_waitcnt lgkmcnt(6)
    v_mfma_f32_16x16x32_bf16 v[48:51], v[80:83], v[92:95], v[48:51]
    v_mfma_f32_16x16x32_bf16 v[52:55], v[80:83], v[96:99], v[52:55]
    ds_read_b128 v[80:83], v108 offset:55296
    s_waitcnt lgkmcnt(6)
    v_mfma_f32_16x16x32_bf16 v[56:59], v[84:87], v[92:95], v[56:59]
    v_mfma_f32_16x16x32_bf16 v[60:63], v[84:87], v[96:99], v[60:63]
    ds_read_b128 v[84:87], v108 offset:56320
    s_waitcnt lgkmcnt(6)
    v_mfma_f32_16x16x32_bf16 v[64:67], v[88:91], v[92:95], v[64:67]
    v_mfma_f32_16x16x32_bf16 v[68:71], v[88:91], v[96:99], v[68:71]
    ds_read_b128 v[88:91], v108 offset:57344
    s_waitcnt lgkmcnt(4)
    v_mfma_f32_16x16x32_bf16 v[32:35], v[72:75], v[100:103], v[32:35]
    v_mfma_f32_16x16x32_bf16 v[36:39], v[72:75], v[104:107], v[36:39]
    s_barrier
    ds_read_b128 v[92:95], v111 offset:0
    ds_read_b128 v[96:99], v111 offset:1024
    ds_read_b128 v[72:75], v108 offset:63488
    s_waitcnt lgkmcnt(6)
    v_mfma_f32_16x16x32_bf16 v[40:43], v[76:79], v[100:103], v[40:43]
    v_mfma_f32_16x16x32_bf16 v[44:47], v[76:79], v[104:107], v[44:47]
    ds_read_b128 v[76:79], v108 offset:64512
    s_waitcnt lgkmcnt(6)
    v_mfma_f32_16x16x32_bf16 v[48:51], v[80:83], v[100:103], v[48:51]
    v_mfma_f32_16x16x32_bf16 v[52:55], v[80:83], v[104:107], v[52:55]
    ds_read_b128 v[80:83], v109 offset:0
    s_waitcnt lgkmcnt(6)
    v_mfma_f32_16x16x32_bf16 v[56:59], v[84:87], v[100:103], v[56:59]
    v_mfma_f32_16x16x32_bf16 v[60:63], v[84:87], v[104:107], v[60:63]
    ds_read_b128 v[84:87], v109 offset:1024
    s_waitcnt lgkmcnt(6)
    v_mfma_f32_16x16x32_bf16 v[64:67], v[88:91], v[100:103], v[64:67]
    v_mfma_f32_16x16x32_bf16 v[68:71], v[88:91], v[104:107], v[68:71]
    ds_read_b128 v[88:91], v109 offset:2048
    s_waitcnt lgkmcnt(4)
    v_mfma_f32_16x16x32_bf16 v[32:35], v[72:75], v[92:95], v[32:35]
    v_mfma_f32_16x16x32_bf16 v[36:39], v[72:75], v[96:99], v[36:39]
    s_barrier
    ds_read_b128 v[100:103], v111 offset:8192
    ds_read_b128 v[104:107], v111 offset:9216
    ds_read_b128 v[72:75], v109 offset:8192
    s_waitcnt lgkmcnt(6)
    v_mfma_f32_16x16x32_bf16 v[40:43], v[76:79], v[92:95], v[40:43]
    v_mfma_f32_16x16x32_bf16 v[44:47], v[76:79], v[96:99], v[44:47]
    ds_read_b128 v[76:79], v109 offset:9216
    s_waitcnt lgkmcnt(6)
    v_mfma_f32_16x16x32_bf16 v[48:51], v[80:83], v[92:95], v[48:51]
    v_mfma_f32_16x16x32_bf16 v[52:55], v[80:83], v[96:99], v[52:55]
    ds_read_b128 v[80:83], v109 offset:10240
    s_waitcnt lgkmcnt(6)
    v_mfma_f32_16x16x32_bf16 v[56:59], v[84:87], v[92:95], v[56:59]
    v_mfma_f32_16x16x32_bf16 v[60:63], v[84:87], v[96:99], v[60:63]
    ds_read_b128 v[84:87], v109 offset:11264
    s_waitcnt lgkmcnt(6)
    v_mfma_f32_16x16x32_bf16 v[64:67], v[88:91], v[92:95], v[64:67]
    v_mfma_f32_16x16x32_bf16 v[68:71], v[88:91], v[96:99], v[68:71]
    ds_read_b128 v[88:91], v109 offset:12288
    s_waitcnt lgkmcnt(4)
    v_mfma_f32_16x16x32_bf16 v[32:35], v[72:75], v[100:103], v[32:35]
    v_mfma_f32_16x16x32_bf16 v[36:39], v[72:75], v[104:107], v[36:39]
    s_barrier
    ds_read_b128 v[92:95], v111 offset:16384
    ds_read_b128 v[96:99], v111 offset:17408
    ds_read_b128 v[72:75], v110 offset:0
    s_waitcnt lgkmcnt(6)
    v_mfma_f32_16x16x32_bf16 v[40:43], v[76:79], v[100:103], v[40:43]
    v_mfma_f32_16x16x32_bf16 v[44:47], v[76:79], v[104:107], v[44:47]
    ds_read_b128 v[76:79], v110 offset:1024
    s_waitcnt lgkmcnt(6)
    v_mfma_f32_16x16x32_bf16 v[48:51], v[80:83], v[100:103], v[48:51]
    v_mfma_f32_16x16x32_bf16 v[52:55], v[80:83], v[104:107], v[52:55]
    ds_read_b128 v[80:83], v110 offset:2048
    s_waitcnt lgkmcnt(6)
    v_mfma_f32_16x16x32_bf16 v[56:59], v[84:87], v[100:103], v[56:59]
    v_mfma_f32_16x16x32_bf16 v[60:63], v[84:87], v[104:107], v[60:63]
    ds_read_b128 v[84:87], v110 offset:3072
    s_waitcnt lgkmcnt(6)
    v_mfma_f32_16x16x32_bf16 v[64:67], v[88:91], v[100:103], v[64:67]
    v_mfma_f32_16x16x32_bf16 v[68:71], v[88:91], v[104:107], v[68:71]
    ds_read_b128 v[88:91], v110 offset:4096
    s_waitcnt lgkmcnt(4)
    v_mfma_f32_16x16x32_bf16 v[32:35], v[72:75], v[92:95], v[32:35]
    v_mfma_f32_16x16x32_bf16 v[36:39], v[72:75], v[96:99], v[36:39]
    s_barrier
    ds_read_b128 v[100:103], v111 offset:24576
    ds_read_b128 v[104:107], v111 offset:25600
    ds_read_b128 v[72:75], v110 offset:10240
    s_waitcnt lgkmcnt(6)
    v_mfma_f32_16x16x32_bf16 v[40:43], v[76:79], v[92:95], v[40:43]
    v_mfma_f32_16x16x32_bf16 v[44:47], v[76:79], v[96:99], v[44:47]
    ds_read_b128 v[76:79], v110 offset:11264
    s_waitcnt lgkmcnt(6)
    v_mfma_f32_16x16x32_bf16 v[48:51], v[80:83], v[92:95], v[48:51]
    v_mfma_f32_16x16x32_bf16 v[52:55], v[80:83], v[96:99], v[52:55]
    ds_read_b128 v[80:83], v110 offset:12288
    s_waitcnt lgkmcnt(6)
    v_mfma_f32_16x16x32_bf16 v[56:59], v[84:87], v[92:95], v[56:59]
    v_mfma_f32_16x16x32_bf16 v[60:63], v[84:87], v[96:99], v[60:63]
    ds_read_b128 v[84:87], v110 offset:13312
    s_waitcnt lgkmcnt(6)
    v_mfma_f32_16x16x32_bf16 v[64:67], v[88:91], v[92:95], v[64:67]
    v_mfma_f32_16x16x32_bf16 v[68:71], v[88:91], v[96:99], v[68:71]
    ds_read_b128 v[88:91], v110 offset:14336
    s_waitcnt lgkmcnt(4)
    v_mfma_f32_16x16x32_bf16 v[32:35], v[72:75], v[100:103], v[32:35]
    v_mfma_f32_16x16x32_bf16 v[36:39], v[72:75], v[104:107], v[36:39]
    s_barrier
    ds_read_b128 v[92:95], v112 offset:18432
    ds_read_b128 v[96:99], v112 offset:19456
    ds_read_b128 v[72:75], v110 offset:20480
    s_waitcnt lgkmcnt(6)
    v_mfma_f32_16x16x32_bf16 v[40:43], v[76:79], v[100:103], v[40:43]
    v_mfma_f32_16x16x32_bf16 v[44:47], v[76:79], v[104:107], v[44:47]
    ds_read_b128 v[76:79], v110 offset:21504
    s_waitcnt lgkmcnt(6)
    v_mfma_f32_16x16x32_bf16 v[48:51], v[80:83], v[100:103], v[48:51]
    v_mfma_f32_16x16x32_bf16 v[52:55], v[80:83], v[104:107], v[52:55]
    ds_read_b128 v[80:83], v110 offset:22528
    s_waitcnt lgkmcnt(6)
    v_mfma_f32_16x16x32_bf16 v[56:59], v[84:87], v[100:103], v[56:59]
    v_mfma_f32_16x16x32_bf16 v[60:63], v[84:87], v[104:107], v[60:63]
    ds_read_b128 v[84:87], v110 offset:23552
    s_waitcnt lgkmcnt(6)
    v_mfma_f32_16x16x32_bf16 v[64:67], v[88:91], v[100:103], v[64:67]
    v_mfma_f32_16x16x32_bf16 v[68:71], v[88:91], v[104:107], v[68:71]
    ds_read_b128 v[88:91], v110 offset:24576
    s_waitcnt lgkmcnt(4)
    v_mfma_f32_16x16x32_bf16 v[32:35], v[72:75], v[92:95], v[32:35]
    v_mfma_f32_16x16x32_bf16 v[36:39], v[72:75], v[96:99], v[36:39]
    s_barrier
    ds_read_b128 v[100:103], v112 offset:26624
    ds_read_b128 v[104:107], v112 offset:27648
    ds_read_b128 v[72:75], v108 offset:32768
    s_waitcnt lgkmcnt(6)
    v_mfma_f32_16x16x32_bf16 v[40:43], v[76:79], v[92:95], v[40:43]
    v_mfma_f32_16x16x32_bf16 v[44:47], v[76:79], v[96:99], v[44:47]
    ds_read_b128 v[76:79], v108 offset:33792
    s_waitcnt lgkmcnt(6)
    v_mfma_f32_16x16x32_bf16 v[48:51], v[80:83], v[92:95], v[48:51]
    v_mfma_f32_16x16x32_bf16 v[52:55], v[80:83], v[96:99], v[52:55]
    ds_read_b128 v[80:83], v108 offset:34816
    s_waitcnt lgkmcnt(6)
    v_mfma_f32_16x16x32_bf16 v[56:59], v[84:87], v[92:95], v[56:59]
    v_mfma_f32_16x16x32_bf16 v[60:63], v[84:87], v[96:99], v[60:63]
    ds_read_b128 v[84:87], v108 offset:35840
    s_waitcnt lgkmcnt(6)
    v_mfma_f32_16x16x32_bf16 v[64:67], v[88:91], v[92:95], v[64:67]
    v_mfma_f32_16x16x32_bf16 v[68:71], v[88:91], v[96:99], v[68:71]
    ds_read_b128 v[88:91], v108 offset:36864
    s_waitcnt lgkmcnt(4)
    v_mfma_f32_16x16x32_bf16 v[32:35], v[72:75], v[100:103], v[32:35]
    v_mfma_f32_16x16x32_bf16 v[36:39], v[72:75], v[104:107], v[36:39]
    s_barrier
    ds_read_b128 v[92:95], v112 offset:34816
    ds_read_b128 v[96:99], v112 offset:35840
    ds_read_b128 v[72:75], v108 offset:43008
    s_waitcnt lgkmcnt(6)
    v_mfma_f32_16x16x32_bf16 v[40:43], v[76:79], v[100:103], v[40:43]
    v_mfma_f32_16x16x32_bf16 v[44:47], v[76:79], v[104:107], v[44:47]
    ds_read_b128 v[76:79], v108 offset:44032
    s_waitcnt lgkmcnt(6)
    v_mfma_f32_16x16x32_bf16 v[48:51], v[80:83], v[100:103], v[48:51]
    v_mfma_f32_16x16x32_bf16 v[52:55], v[80:83], v[104:107], v[52:55]
    ds_read_b128 v[80:83], v108 offset:45056
    s_waitcnt lgkmcnt(6)
    v_mfma_f32_16x16x32_bf16 v[56:59], v[84:87], v[100:103], v[56:59]
    v_mfma_f32_16x16x32_bf16 v[60:63], v[84:87], v[104:107], v[60:63]
    ds_read_b128 v[84:87], v108 offset:46080
    s_waitcnt lgkmcnt(6)
    v_mfma_f32_16x16x32_bf16 v[64:67], v[88:91], v[100:103], v[64:67]
    v_mfma_f32_16x16x32_bf16 v[68:71], v[88:91], v[104:107], v[68:71]
    ds_read_b128 v[88:91], v108 offset:47104
    s_waitcnt lgkmcnt(4)
    v_mfma_f32_16x16x32_bf16 v[32:35], v[72:75], v[92:95], v[32:35]
    v_mfma_f32_16x16x32_bf16 v[36:39], v[72:75], v[96:99], v[36:39]
    s_barrier
    ds_read_b128 v[100:103], v112 offset:43008
    ds_read_b128 v[104:107], v112 offset:44032
    ds_read_b128 v[72:75], v108 offset:53248
    s_waitcnt lgkmcnt(6)
    v_mfma_f32_16x16x32_bf16 v[40:43], v[76:79], v[92:95], v[40:43]
    v_mfma_f32_16x16x32_bf16 v[44:47], v[76:79], v[96:99], v[44:47]
    ds_read_b128 v[76:79], v108 offset:54272
    s_waitcnt lgkmcnt(6)
    v_mfma_f32_16x16x32_bf16 v[48:51], v[80:83], v[92:95], v[48:51]
    v_mfma_f32_16x16x32_bf16 v[52:55], v[80:83], v[96:99], v[52:55]
    ds_read_b128 v[80:83], v108 offset:55296
    s_waitcnt lgkmcnt(6)
    v_mfma_f32_16x16x32_bf16 v[56:59], v[84:87], v[92:95], v[56:59]
    v_mfma_f32_16x16x32_bf16 v[60:63], v[84:87], v[96:99], v[60:63]
    ds_read_b128 v[84:87], v108 offset:56320
    s_waitcnt lgkmcnt(6)
    v_mfma_f32_16x16x32_bf16 v[64:67], v[88:91], v[92:95], v[64:67]
    v_mfma_f32_16x16x32_bf16 v[68:71], v[88:91], v[96:99], v[68:71]
    ds_read_b128 v[88:91], v108 offset:57344
    s_waitcnt lgkmcnt(4)
    v_mfma_f32_16x16x32_bf16 v[32:35], v[72:75], v[100:103], v[32:35]
    v_mfma_f32_16x16x32_bf16 v[36:39], v[72:75], v[104:107], v[36:39]
    s_barrier
    ds_read_b128 v[92:95], v112 offset:51200
    ds_read_b128 v[96:99], v112 offset:52224
    ds_read_b128 v[72:75], v108 offset:63488
    s_waitcnt lgkmcnt(6)
    v_mfma_f32_16x16x32_bf16 v[40:43], v[76:79], v[100:103], v[40:43]
    v_mfma_f32_16x16x32_bf16 v[44:47], v[76:79], v[104:107], v[44:47]
    ds_read_b128 v[76:79], v108 offset:64512
    s_waitcnt lgkmcnt(6)
    v_mfma_f32_16x16x32_bf16 v[48:51], v[80:83], v[100:103], v[48:51]
    v_mfma_f32_16x16x32_bf16 v[52:55], v[80:83], v[104:107], v[52:55]
    ds_read_b128 v[80:83], v109 offset:0
    s_waitcnt lgkmcnt(6)
    v_mfma_f32_16x16x32_bf16 v[56:59], v[84:87], v[100:103], v[56:59]
    v_mfma_f32_16x16x32_bf16 v[60:63], v[84:87], v[104:107], v[60:63]
    ds_read_b128 v[84:87], v109 offset:1024
    s_waitcnt lgkmcnt(6)
    v_mfma_f32_16x16x32_bf16 v[64:67], v[88:91], v[100:103], v[64:67]
    v_mfma_f32_16x16x32_bf16 v[68:71], v[88:91], v[104:107], v[68:71]
    ds_read_b128 v[88:91], v109 offset:2048
    s_waitcnt lgkmcnt(4)
    v_mfma_f32_16x16x32_bf16 v[32:35], v[72:75], v[92:95], v[32:35]
    v_mfma_f32_16x16x32_bf16 v[36:39], v[72:75], v[96:99], v[36:39]
    s_barrier
    ds_read_b128 v[100:103], v111 offset:0
    ds_read_b128 v[104:107], v111 offset:1024
    ds_read_b128 v[72:75], v109 offset:8192
    s_waitcnt lgkmcnt(6)
    v_mfma_f32_16x16x32_bf16 v[40:43], v[76:79], v[92:95], v[40:43]
    v_mfma_f32_16x16x32_bf16 v[44:47], v[76:79], v[96:99], v[44:47]
    ds_read_b128 v[76:79], v109 offset:9216
    s_waitcnt lgkmcnt(6)
    v_mfma_f32_16x16x32_bf16 v[48:51], v[80:83], v[92:95], v[48:51]
    v_mfma_f32_16x16x32_bf16 v[52:55], v[80:83], v[96:99], v[52:55]
    ds_read_b128 v[80:83], v109 offset:10240
    s_waitcnt lgkmcnt(6)
    v_mfma_f32_16x16x32_bf16 v[56:59], v[84:87], v[92:95], v[56:59]
    v_mfma_f32_16x16x32_bf16 v[60:63], v[84:87], v[96:99], v[60:63]
    ds_read_b128 v[84:87], v109 offset:11264
    s_waitcnt lgkmcnt(6)
    v_mfma_f32_16x16x32_bf16 v[64:67], v[88:91], v[92:95], v[64:67]
    v_mfma_f32_16x16x32_bf16 v[68:71], v[88:91], v[96:99], v[68:71]
    ds_read_b128 v[88:91], v109 offset:12288
    s_waitcnt lgkmcnt(4)
    v_mfma_f32_16x16x32_bf16 v[32:35], v[72:75], v[100:103], v[32:35]
    v_mfma_f32_16x16x32_bf16 v[36:39], v[72:75], v[104:107], v[36:39]
    s_barrier
    ds_read_b128 v[92:95], v111 offset:8192
    ds_read_b128 v[96:99], v111 offset:9216
    ds_read_b128 v[72:75], v110 offset:0
    s_waitcnt lgkmcnt(6)
    v_mfma_f32_16x16x32_bf16 v[40:43], v[76:79], v[100:103], v[40:43]
    v_mfma_f32_16x16x32_bf16 v[44:47], v[76:79], v[104:107], v[44:47]
    ds_read_b128 v[76:79], v110 offset:1024
    s_waitcnt lgkmcnt(6)
    v_mfma_f32_16x16x32_bf16 v[48:51], v[80:83], v[100:103], v[48:51]
    v_mfma_f32_16x16x32_bf16 v[52:55], v[80:83], v[104:107], v[52:55]
    ds_read_b128 v[80:83], v110 offset:2048
    s_waitcnt lgkmcnt(6)
    v_mfma_f32_16x16x32_bf16 v[56:59], v[84:87], v[100:103], v[56:59]
    v_mfma_f32_16x16x32_bf16 v[60:63], v[84:87], v[104:107], v[60:63]
    ds_read_b128 v[84:87], v110 offset:3072
    s_waitcnt lgkmcnt(6)
    v_mfma_f32_16x16x32_bf16 v[64:67], v[88:91], v[100:103], v[64:67]
    v_mfma_f32_16x16x32_bf16 v[68:71], v[88:91], v[104:107], v[68:71]
    ds_read_b128 v[88:91], v110 offset:4096
    s_waitcnt lgkmcnt(4)
    v_mfma_f32_16x16x32_bf16 v[32:35], v[72:75], v[92:95], v[32:35]
    v_mfma_f32_16x16x32_bf16 v[36:39], v[72:75], v[96:99], v[36:39]
    s_barrier
    ds_read_b128 v[100:103], v111 offset:16384
    ds_read_b128 v[104:107], v111 offset:17408
    ds_read_b128 v[72:75], v110 offset:10240
    s_waitcnt lgkmcnt(6)
    v_mfma_f32_16x16x32_bf16 v[40:43], v[76:79], v[92:95], v[40:43]
    v_mfma_f32_16x16x32_bf16 v[44:47], v[76:79], v[96:99], v[44:47]
    ds_read_b128 v[76:79], v110 offset:11264
    s_waitcnt lgkmcnt(6)
    v_mfma_f32_16x16x32_bf16 v[48:51], v[80:83], v[92:95], v[48:51]
    v_mfma_f32_16x16x32_bf16 v[52:55], v[80:83], v[96:99], v[52:55]
    ds_read_b128 v[80:83], v110 offset:12288
    s_waitcnt lgkmcnt(6)
    v_mfma_f32_16x16x32_bf16 v[56:59], v[84:87], v[92:95], v[56:59]
    v_mfma_f32_16x16x32_bf16 v[60:63], v[84:87], v[96:99], v[60:63]
    ds_read_b128 v[84:87], v110 offset:13312
    s_waitcnt lgkmcnt(6)
    v_mfma_f32_16x16x32_bf16 v[64:67], v[88:91], v[92:95], v[64:67]
    v_mfma_f32_16x16x32_bf16 v[68:71], v[88:91], v[96:99], v[68:71]
    ds_read_b128 v[88:91], v110 offset:14336
    s_waitcnt lgkmcnt(4)
    v_mfma_f32_16x16x32_bf16 v[32:35], v[72:75], v[100:103], v[32:35]
    v_mfma_f32_16x16x32_bf16 v[36:39], v[72:75], v[104:107], v[36:39]
    s_barrier
    ds_read_b128 v[92:95], v111 offset:24576
    ds_read_b128 v[96:99], v111 offset:25600
    ds_read_b128 v[72:75], v110 offset:20480
    s_waitcnt lgkmcnt(6)
    v_mfma_f32_16x16x32_bf16 v[40:43], v[76:79], v[100:103], v[40:43]
    v_mfma_f32_16x16x32_bf16 v[44:47], v[76:79], v[104:107], v[44:47]
    ds_read_b128 v[76:79], v110 offset:21504
    s_waitcnt lgkmcnt(6)
    v_mfma_f32_16x16x32_bf16 v[48:51], v[80:83], v[100:103], v[48:51]
    v_mfma_f32_16x16x32_bf16 v[52:55], v[80:83], v[104:107], v[52:55]
    ds_read_b128 v[80:83], v110 offset:22528
    s_waitcnt lgkmcnt(6)
    v_mfma_f32_16x16x32_bf16 v[56:59], v[84:87], v[100:103], v[56:59]
    v_mfma_f32_16x16x32_bf16 v[60:63], v[84:87], v[104:107], v[60:63]
    ds_read_b128 v[84:87], v110 offset:23552
    s_waitcnt lgkmcnt(6)
    v_mfma_f32_16x16x32_bf16 v[64:67], v[88:91], v[100:103], v[64:67]
    v_mfma_f32_16x16x32_bf16 v[68:71], v[88:91], v[104:107], v[68:71]
    ds_read_b128 v[88:91], v110 offset:24576
    s_waitcnt lgkmcnt(4)
    v_mfma_f32_16x16x32_bf16 v[32:35], v[72:75], v[92:95], v[32:35]
    v_mfma_f32_16x16x32_bf16 v[36:39], v[72:75], v[96:99], v[36:39]
    s_barrier
    s_waitcnt lgkmcnt(3)
    v_mfma_f32_16x16x32_bf16 v[40:43], v[76:79], v[92:95], v[40:43]
    v_mfma_f32_16x16x32_bf16 v[44:47], v[76:79], v[96:99], v[44:47]
    s_waitcnt lgkmcnt(2)
    v_mfma_f32_16x16x32_bf16 v[48:51], v[80:83], v[92:95], v[48:51]
    v_mfma_f32_16x16x32_bf16 v[52:55], v[80:83], v[96:99], v[52:55]
    s_waitcnt lgkmcnt(1)
    v_mfma_f32_16x16x32_bf16 v[56:59], v[84:87], v[92:95], v[56:59]
    v_mfma_f32_16x16x32_bf16 v[60:63], v[84:87], v[96:99], v[60:63]
    s_waitcnt lgkmcnt(0)
    v_mfma_f32_16x16x32_bf16 v[64:67], v[88:91], v[92:95], v[64:67]
    v_mfma_f32_16x16x32_bf16 v[68:71], v[88:91], v[96:99], v[68:71]
L_p5_fin:
    v_and_b32 v12, 15, v0
    s_lshl_b32 s14, s40, 5
    v_add_u32 v12, s14, v12
    v_mul_u32_u24 v12, 336, v12
    v_lshrrev_b32 v13, 4, v0
    v_lshl_add_u32 v12, v13, 4, v12
    s_mul_i32 s14, s41, 21504
    v_add_u32 v12, s14, v12
    s_waitcnt lgkmcnt(0)
    s_barrier
    ds_write_b128 v12, v[32:35] offset:0
    ds_write_b128 v12, v[36:39] offset:5376
    ds_write_b128 v12, v[40:43] offset:64
    ds_write_b128 v12, v[44:47] offset:5440
    ds_write_b128 v12, v[48:51] offset:128
    ds_write_b128 v12, v[52:55] offset:5504
    ds_write_b128 v12, v[56:59] offset:192
    ds_write_b128 v12, v[60:63] offset:5568
    ds_write_b128 v12, v[64:67] offset:256
    ds_write_b128 v12, v[68:71] offset:5632
    s_waitcnt lgkmcnt(0)
L_p5_epi:
    s_barrier
    ds_read_b128 v[32:35], v5 offset:0
    ds_read_b128 v[36:39], v5 offset:16
    ds_read_b128 v[40:43], v5 offset:21504
    ds_read_b128 v[44:47], v5 offset:21520
    ds_read_b128 v[48:51], v6 offset:0
    ds_read_b128 v[52:55], v6 offset:16
    ds_read_b128 v[56:59], v6 offset:21504
    ds_read_b128 v[60:63], v6 offset:21520
    s_mov_b32 s46, 0xffff0000
    s_mul_i32 s42, s16, 81920
    s_mul_i32 s15, s17, 160
    s_add_u32 s42, s42, s15
    s_waitcnt vmcnt(0) lgkmcnt(4)
    v_pk_add_f32 v[32:33], v[32:33], v[40:41]
    v_lshlrev_b32 v20, 16, v24
    v_and_b32 v21, s46, v24
    v_pk_add_f32 v[32:33], v[32:33], v[20:21]
    v_cvt_pk_bf16_f32 v64, v32, v33
    v_pk_add_f32 v[34:35], v[34:35], v[42:43]
    v_lshlrev_b32 v20, 16, v25
    v_and_b32 v21, s46, v25
    v_pk_add_f32 v[34:35], v[34:35], v[20:21]
    v_cvt_pk_bf16_f32 v65, v34, v35
    v_pk_add_f32 v[36:37], v[36:37], v[44:45]
    v_lshlrev_b32 v20, 16, v26
    v_and_b32 v21, s46, v26
    v_pk_add_f32 v[36:37], v[36:37], v[20:21]
    v_cvt_pk_bf16_f32 v66, v36, v37
    v_pk_add_f32 v[38:39], v[38:39], v[46:47]
    v_lshlrev_b32 v20, 16, v27
    v_and_b32 v21, s46, v27
    v_pk_add_f32 v[38:39], v[38:39], v[20:21]
    v_cvt_pk_bf16_f32 v67, v38, v39
    buffer_store_dwordx4 v[64:67], v9, s[28:31], s42 offen
    s_waitcnt lgkmcnt(0)
    v_pk_add_f32 v[48:49], v[48:49], v[56:57]
    v_lshlrev_b32 v20, 16, v28
    v_and_b32 v21, s46, v28
    v_pk_add_f32 v[48:49], v[48:49], v[20:21]
    v_cvt_pk_bf16_f32 v68, v48, v49
    v_pk_add_f32 v[50:51], v[50:51], v[58:59]
    v_lshlrev_b32 v20, 16, v29
    v_and_b32 v21, s46, v29
    v_pk_add_f32 v[50:51], v[50:51], v[20:21]
    v_cvt_pk_bf16_f32 v69, v50, v51
    v_pk_add_f32 v[52:53], v[52:53], v[60:61]
    v_lshlrev_b32 v20, 16, v30
    v_and_b32 v21, s46, v30
    v_pk_add_f32 v[52:53], v[52:53], v[20:21]
    v_cvt_pk_bf16_f32 v70, v52, v53
    v_pk_add_f32 v[54:55], v[54:55], v[62:63]
    v_lshlrev_b32 v20, 16, v31
    v_and_b32 v21, s46, v31
    v_pk_add_f32 v[54:55], v[54:55], v[20:21]
    v_cvt_pk_bf16_f32 v71, v54, v55
    buffer_store_dwordx4 v[68:71], v10, s[28:31], s42 offen
L_done:
    s_endpgm
.section .rodata,"a"
.p2align 6
.amdhsa_kernel sequential_preLN__sliding_block__geglu_ffn__prompt_kernel
  .amdhsa_next_free_vgpr 256
  .amdhsa_next_free_sgpr 102
  .amdhsa_accum_offset 256
  .amdhsa_group_segment_fixed_size 0
  .amdhsa_kernarg_size 80
  .amdhsa_user_sgpr_count 2
  .amdhsa_user_sgpr_kernarg_segment_ptr 1
  .amdhsa_system_sgpr_workgroup_id_x 1
.end_amdhsa_kernel
```
